```python
import torch

def _softmax(x, axis=-1):
    return torch.softmax(x, dim=axis)

def _gelu(x):
    return torch.nn.functional.gelu(x, approximate='tanh')

def _silu(x):
    return torch.nn.functional.silu(x)

def _sigmoid(x):
    return torch.sigmoid(x)

def _layernorm(x, axis=-1, eps=1e-05):
    m = x.mean(dim=axis, keepdim=True)
    v = x.var(dim=axis, keepdim=True, unbiased=False)
    return (x - m) / torch.sqrt(v + eps)

def _scatter_add(tgt, idx, src, axis=0):
    return tgt.clone().index_add_(axis, idx, src)

def _segment_sum(src, seg, n):
    out = torch.zeros((n,) + src.shape[1:], dtype=src.dtype)
    return out.index_add_(0, seg, src)

def _pad(x, pw):
    flat = tuple((v for pair in reversed(pw) for v in pair))
    return torch.nn.functional.pad(x, flat)
kernel_name = 'adaLN_cond__spectral_fnet__swiglu_ffn__prompt'

def setup_inputs():

    _w = lambda a: (lambda t: t.to(torch.bfloat16) if t.is_floating_point() else t)(torch.as_tensor(a))

    def _A_setup():
        B, S, D = (1, 2048, 512)
        ns = torch.arange(S)[:, None] * torch.arange(S)[None, :]
        nd = torch.arange(D)[:, None] * torch.arange(D)[None, :]
        Ws_re = torch.cos(-2.0 * torch.pi * ns / S).to(float)
        Ws_im = torch.sin(-2.0 * torch.pi * ns / S).to(float)
        Wd_re = torch.cos(-2.0 * torch.pi * nd / D).to(float)
        Wd_im = torch.sin(-2.0 * torch.pi * nd / D).to(float)
        return {'x': _w((lambda *s: torch.randn(*s, dtype=torch.bfloat16) * 0.05)(B, S, D)), 'dft_seq_re': _w(Ws_re), 'dft_seq_im': _w(Ws_im), 'dft_hid_re': _w(Wd_re), 'dft_hid_im': _w(Wd_im)}
    _A_in = _A_setup()

    def _B_setup():
        B, S, D, F = (1, 2048, 512, 1376)
        return {'x': _w((lambda *s: torch.randn(*s, dtype=torch.bfloat16) * 0.05)(B, S, D)), 'w_gate': _w((lambda *s: torch.randn(*s, dtype=torch.bfloat16) * 0.4)(D, F)), 'w_up': _w((lambda *s: torch.randn(*s, dtype=torch.bfloat16) * 0.4)(D, F)), 'w_down': _w((lambda *s: torch.randn(*s, dtype=torch.bfloat16) * 0.4)(F, D))}
    _B_in = _B_setup()
    return {'A_x': _A_in['x'], 'A_dft_seq_re': _A_in['dft_seq_re'], 'A_dft_seq_im': _A_in['dft_seq_im'], 'A_dft_hid_re': _A_in['dft_hid_re'], 'A_dft_hid_im': _A_in['dft_hid_im'], 'B_x': _B_in['x'], 'B_w_gate': _B_in['w_gate'], 'B_w_up': _B_in['w_up'], 'B_w_down': _B_in['w_down'], 'c': _w((lambda *s: torch.randn(*s, dtype=torch.bfloat16) * 0.2)(1, 512) * 8.0), 'w_mod': _w((lambda *s: torch.randn(*s, dtype=torch.bfloat16) * 0.2)(512, 6 * 512) * 512 ** (-0.5) * 8.0)}

def reference(A_x, A_dft_seq_re, A_dft_seq_im, A_dft_hid_re, A_dft_hid_im, B_x, B_w_gate, B_w_up, B_w_down, c, w_mod):

    def _A_ref(x, dft_seq_re, dft_seq_im, dft_hid_re, dft_hid_im):
        a = torch.einsum('bsd,ed->bse', x, dft_hid_re)
        b = torch.einsum('bsd,ed->bse', x, dft_hid_im)
        y = torch.einsum('ts,bse->bte', dft_seq_re, a) - torch.einsum('ts,bse->bte', dft_seq_im, b)
        return y

    def _B_ref(x, w_gate, w_up, w_down):
        g = _silu(x @ w_gate)
        u = x @ w_up
        return g * u @ w_down
    x = A_x
    mod = (_silu(c) @ w_mod).reshape(c.shape[0], 6, 1, -1)
    sa, ca, ga, sb, cb, gb = (mod[:, 0].clone(), mod[:, 1].clone(), mod[:, 2].clone(), mod[:, 3].clone(), mod[:, 4].clone(), mod[:, 5].clone())
    h = _layernorm(x, axis=-1) * (1 + ca) + sa
    x = x + ga * _A_ref(h, A_dft_seq_re, A_dft_seq_im, A_dft_hid_re, A_dft_hid_im)
    h = _layernorm(x, axis=-1) * (1 + cb) + sb
    x = x + gb * _B_ref(h, B_w_gate, B_w_up, B_w_down)
    return x
```

```asm
; @launch grid=(256,1,1) block=(256,1,1) lds=163840
.amdgcn_target "amdgcn-amd-amdhsa--gfx950"
.text
.globl adaLN_cond__spectral_fnet__swiglu_ffn__prompt_kernel
.p2align 8
.type adaLN_cond__spectral_fnet__swiglu_ffn__prompt_kernel,@function
adaLN_cond__spectral_fnet__swiglu_ffn__prompt_kernel:
    s_cmp_ge_u32 s2, 256
    s_cbranch_scc1 L_end
    s_load_dwordx2 s[4:5], s[0:1], 0
    s_load_dwordx2 s[20:21], s[0:1], 104
    s_load_dwordx4 s[8:11], s[0:1], 48
    s_load_dwordx4 s[12:15], s[0:1], 64
    s_load_dwordx4 s[16:19], s[0:1], 80
    v_lshrrev_b32 v2, 6, v0
    v_and_b32 v1, 63, v0
    v_mov_b32 v56, 0
    v_mov_b32 v176, 0
    v_readfirstlane_b32 s6, v2
    s_and_b32 s7, s2, 7
    s_lshr_b32 s3, s2, 3
    s_and_b32 s22, s3, 3
    s_lshl_b32 s22, s22, 3
    s_add_u32 s75, s22, s7
    s_lshr_b32 s74, s3, 2
    s_lshl_b32 s53, s6, 19
    s_lshl_b32 s23, s75, 10
    s_add_u32 s53, s53, s23
    v_lshrrev_b32 v2, 2, v1
    v_lshlrev_b32 v2, 15, v2
    v_and_b32 v3, 3, v1
    v_lshl_add_u32 v2, v3, 4, v2
    s_mov_b32 s26, 0x200000
    s_mov_b32 s27, 0x00020000
    s_mov_b32 s30, 0x1000000
    s_mov_b32 s31, 0x00020000
    s_waitcnt lgkmcnt(0)
    s_mov_b32 s24, s4
    s_mov_b32 s25, s5
    s_cmp_lt_u32 s3, 16
    s_cbranch_scc0 L_issue_other
    s_mov_b32 s73, 0
    buffer_load_dwordx4 v[64:67], v2, s[24:27], s53 offen offset:0
    buffer_load_dwordx4 v[68:71], v2, s[24:27], s53 offen offset:64
    buffer_load_dwordx4 v[72:75], v2, s[24:27], s53 offen offset:128
    buffer_load_dwordx4 v[76:79], v2, s[24:27], s53 offen offset:192
    buffer_load_dwordx4 v[80:83], v2, s[24:27], s53 offen offset:256
    buffer_load_dwordx4 v[84:87], v2, s[24:27], s53 offen offset:320
    buffer_load_dwordx4 v[88:91], v2, s[24:27], s53 offen offset:384
    buffer_load_dwordx4 v[92:95], v2, s[24:27], s53 offen offset:448
    buffer_load_dwordx4 v[96:99], v2, s[24:27], s53 offen offset:512
    buffer_load_dwordx4 v[100:103], v2, s[24:27], s53 offen offset:576
    buffer_load_dwordx4 v[104:107], v2, s[24:27], s53 offen offset:640
    buffer_load_dwordx4 v[108:111], v2, s[24:27], s53 offen offset:704
    buffer_load_dwordx4 v[112:115], v2, s[24:27], s53 offen offset:768
    buffer_load_dwordx4 v[116:119], v2, s[24:27], s53 offen offset:832
    buffer_load_dwordx4 v[120:123], v2, s[24:27], s53 offen offset:896
    buffer_load_dwordx4 v[124:127], v2, s[24:27], s53 offen offset:960
    s_branch L_setup
L_issue_other:
    s_lshr_b32 s22, s16, 7
    s_sub_u32 s22, 3, s22
    s_and_b32 s22, s22, 7
    s_mul_i32 s23, s7, 6
    s_add_u32 s23, s23, s3
    s_sub_u32 s23, s23, 16
    s_mul_i32 s51, s23, 37
    s_lshr_b32 s51, s51, 8
    s_mul_i32 s52, s51, 7
    s_sub_u32 s52, s23, s52
    s_cmp_ge_u32 s52, s22
    s_addc_u32 s52, s52, 0
    s_lshl_b32 s51, s51, 3
    s_add_u32 s74, s51, s52
    s_cmp_lt_u32 s23, 42
    s_cselect_b32 s73, 1, 2
    s_cmp_lt_u32 s3, 22
    s_cselect_b32 s73, s73, 2
    s_lshl_b32 s51, s7, 3
    s_add_u32 s51, s51, s22
    s_cmp_lt_u32 s7, 6
    s_cselect_b32 s52, 31, 99
    s_cmp_eq_u32 s3, s52
    s_cselect_b32 s74, s51, s74
    s_cselect_b32 s73, 1, s73
    s_cmp_eq_u32 s73, 1
    s_cbranch_scc0 L_issue_idle
    s_mov_b32 s36, s14
    s_mov_b32 s37, s15
    s_mov_b32 s38, 0x400
    s_mov_b32 s39, 0x00020000
    v_lshrrev_b32 v56, 3, v1
    s_lshl_b32 s22, s6, 7
    v_add_u32 v56, s22, v56
    v_lshlrev_b32 v3, 1, v56
    v_mul_u32_u24 v56, 6144, v56
    v_and_b32 v4, 7, v1
    v_lshl_add_u32 v56, v4, 4, v56
    buffer_load_ushort v128, v3, s[36:39], 0 offen offset:0
    buffer_load_ushort v129, v3, s[36:39], 0 offen offset:16
    buffer_load_ushort v130, v3, s[36:39], 0 offen offset:32
    buffer_load_ushort v131, v3, s[36:39], 0 offen offset:48
    buffer_load_ushort v132, v3, s[36:39], 0 offen offset:64
    buffer_load_ushort v133, v3, s[36:39], 0 offen offset:80
    buffer_load_ushort v134, v3, s[36:39], 0 offen offset:96
    buffer_load_ushort v135, v3, s[36:39], 0 offen offset:112
    buffer_load_ushort v136, v3, s[36:39], 0 offen offset:128
    buffer_load_ushort v137, v3, s[36:39], 0 offen offset:144
    buffer_load_ushort v138, v3, s[36:39], 0 offen offset:160
    buffer_load_ushort v139, v3, s[36:39], 0 offen offset:176
    buffer_load_ushort v140, v3, s[36:39], 0 offen offset:192
    buffer_load_ushort v141, v3, s[36:39], 0 offen offset:208
    buffer_load_ushort v142, v3, s[36:39], 0 offen offset:224
    buffer_load_ushort v143, v3, s[36:39], 0 offen offset:240
    s_branch L_setup
L_issue_idle:
    s_getpc_b64 s[52:53]
L_pc:
    s_sub_u32 s52, s52, L_pc-adaLN_cond__spectral_fnet__swiglu_ffn__prompt_kernel
    s_subb_u32 s53, s53, 0
    s_sub_u32 s22, s3, 22
    s_min_u32 s22, s22, 9
    s_lshl_b32 s22, s22, 2
    s_add_u32 s22, s22, s6
    s_mul_i32 s22, s22, 12
    v_min_u32 v2, 11, v1
    v_add_u32 v2, s22, v2
    v_lshlrev_b32 v2, 7, v2
    v_min_u32 v2, L_codeend-adaLN_cond__spectral_fnet__swiglu_ffn__prompt_kernel-4, v2
    global_load_dword v186, v2, s[52:53]
L_setup:
    s_mov_b32 s28, s20
    s_mov_b32 s29, s21
    s_load_dword s40, s[20:21], 0
    s_and_b32 s22, s6, 1
    s_cmp_eq_u32 s22, 0
    s_cselect_b32 s76, s8, s10
    s_cselect_b32 s77, s9, s11
    s_mov_b32 s78, 1409024
    s_mov_b32 s79, 0x00020000
    s_mov_b32 s20, 2146435072
    s_mov_b32 s21, 0
    s_mov_b32 s50, 2146435072
    s_cmp_eq_u32 s73, 0
    s_cbranch_scc0 L_proc_other
    s_getpc_b64 s[52:53]
L_pc_1:
    s_add_u32 s52, s52, L_table-L_pc_1
    s_addc_u32 s53, s53, 0
    v_lshlrev_b32 v4, 4, v1
    s_lshl_b32 s22, s6, 11
    s_add_u32 s22, s22, 14336
    v_add_u32 v5, s22, v4
    global_load_dwordx4 v[48:51], v5, s[52:53] offset:0
    global_load_dwordx4 v[52:55], v5, s[52:53] offset:1024
    s_and_b32 s22, s3, 3
    s_lshl_b32 s43, s7, 2
    s_add_u32 s43, s43, s22
    s_lshr_b32 s42, s3, 3
    s_sub_u32 s22, 64, s43
    s_cmp_eq_u32 s43, 0
    s_cselect_b32 s22, 32, s22
    s_bitcmp1_b32 s3, 2
    s_cselect_b32 s41, s22, s43
    s_lshl_b32 s22, s42, 9
    s_add_u32 s22, s22, s41
    v_bfe_u32 v4, v1, 1, 3
    v_lshlrev_b32 v4, 6, v4
    v_add_u32 v4, s22, v4
    v_cvt_f32_u32 v4, v4
    v_mul_f32 v4, 0x3a000000, v4
    v_lshrrev_b32 v5, 4, v1
    v_lshlrev_b32 v5, 3, v5
    v_cvt_f32_u32 v5, v5
    v_and_b32 v6, 1, v1
    v_cvt_f32_u32 v6, v6
    v_mul_f32 v6, 0x3e800000, v6
    v_fma_f32 v7, v4, v5, v6
    v_mov_b32 v8, v7
    v_cos_f32 v24, v8
    v_add_f32 v8, v8, v4
    v_cos_f32 v25, v8
    v_add_f32 v8, v8, v4
    v_cvt_pk_bf16_f32 v192, v24, v25
    v_cos_f32 v24, v8
    v_add_f32 v8, v8, v4
    v_cos_f32 v25, v8
    v_add_f32 v8, v8, v4
    v_cvt_pk_bf16_f32 v193, v24, v25
    v_cos_f32 v24, v8
    v_add_f32 v8, v8, v4
    v_cos_f32 v25, v8
    v_add_f32 v8, v8, v4
    v_cvt_pk_bf16_f32 v194, v24, v25
    v_cos_f32 v24, v8
    v_add_f32 v8, v8, v4
    v_cos_f32 v25, v8
    v_add_f32 v8, v8, v4
    v_cvt_pk_bf16_f32 v195, v24, v25
    s_mov_b32 s22, 0x3e800000
    s_cmp_lt_u32 s41, 32
    s_cselect_b32 s22, 0xbe800000, s22
    s_cmp_eq_u32 s41, 32
    s_cselect_b32 s22, 0, s22
    s_cselect_b32 s51, 0, -1
    s_cmp_eq_u32 s41, 0
    s_cselect_b32 s52, 0, -1
    v_add_f32 v8, s22, v7
    v_cos_f32 v24, v8
    v_add_f32 v8, v8, v4
    v_cos_f32 v25, v8
    v_add_f32 v8, v8, v4
    v_cvt_pk_bf16_f32 v196, v24, v25
    v_cos_f32 v24, v8
    v_add_f32 v8, v8, v4
    v_cos_f32 v25, v8
    v_add_f32 v8, v8, v4
    v_cvt_pk_bf16_f32 v197, v24, v25
    v_cos_f32 v24, v8
    v_add_f32 v8, v8, v4
    v_cos_f32 v25, v8
    v_add_f32 v8, v8, v4
    v_cvt_pk_bf16_f32 v198, v24, v25
    v_cos_f32 v24, v8
    v_add_f32 v8, v8, v4
    v_cos_f32 v25, v8
    v_add_f32 v8, v8, v4
    v_cvt_pk_bf16_f32 v199, v24, v25
    v_and_b32 v192, s51, v192
    v_and_b32 v196, s52, v196
    v_and_b32 v193, s51, v193
    v_and_b32 v197, s52, v197
    v_and_b32 v194, s51, v194
    v_and_b32 v198, s52, v198
    v_and_b32 v195, s51, v195
    v_and_b32 v199, s52, v199
    v_lshrrev_b32 v28, 2, v1
    v_and_b32 v29, 3, v28
    v_bfe_u32 v30, v28, 3, 1
    v_lshl_add_u32 v29, v30, 2, v29
    v_and_b32 v30, 3, v1
    v_lshlrev_b32 v30, 1, v30
    v_xor_b32 v29, v29, v30
    v_lshlrev_b32 v29, 5, v29
    v_lshl_add_u32 v29, v28, 8, v29
    s_lshl_b32 s22, s6, 12
    s_add_u32 s22, s22, 131072
    v_add_u32 v34, s22, v29
    v_xor_b32 v35, 32, v34
    v_lshrrev_b32 v28, 4, v1
    v_bfe_u32 v29, v1, 2, 2
    v_lshl_add_u32 v36, v28, 3, v29
    v_lshlrev_b32 v36, 8, v36
    v_and_b32 v28, 1, v28
    v_lshl_add_u32 v28, v28, 2, v29
    v_lshl_add_u32 v36, v28, 5, v36
    v_and_b32 v28, 3, v1
    v_lshl_add_u32 v36, v28, 3, v36
    v_add_u32 v36, 131072, v36
    v_xor_b32 v37, 32, v36
    v_xor_b32 v38, 64, v36
    v_xor_b32 v39, 96, v36
    v_xor_b32 v40, 128, v36
    v_xor_b32 v41, 160, v36
    v_xor_b32 v42, 192, v36
    v_xor_b32 v43, 224, v36
    v_lshrrev_b32 v28, 4, v1
    v_mul_u32_u24 v28, 132096, v28
    v_and_b32 v29, 15, v1
    v_lshl_add_u32 v44, v29, 4, v28
    s_mul_i32 s22, s6, 528384
    s_lshl_b32 s23, s75, 10
    s_add_u32 s22, s22, s23
    s_lshl_b32 s23, s74, 8
    s_add_u32 s22, s22, s23
    s_add_u32 s51, s22, 1048576
    s_lshl_b32 s22, s74, 5
    s_add_u32 s22, s22, s75
    s_lshl_b32 s22, s22, 2
    s_add_u32 s22, s22, s6
    s_mul_i32 s22, s22, 128
    s_add_u32 s50, s22, 393216
    s_mov_b32 s52, 0x3f803f80
    v_mov_b32 v26, 0
    v_mov_b32 v27, 0
    v_mov_b32 v28, 0
    v_mov_b32 v29, 0
    s_cmp_lt_u32 s74, 2
    s_cbranch_scc0 L_j_4
    s_cmp_eq_u32 s74, 0
    s_cbranch_scc0 L_j_3
L_j_2:
    s_waitcnt vmcnt(16)
    v_dot2c_f32_bf16 v26, s52, v64
    v_dot2c_f32_bf16 v28, v64, v64
    v_dot2c_f32_bf16 v27, s52, v65
    v_dot2c_f32_bf16 v29, v65, v65
    v_dot2c_f32_bf16 v26, s52, v66
    v_dot2c_f32_bf16 v28, v66, v66
    v_dot2c_f32_bf16 v27, s52, v67
    v_dot2c_f32_bf16 v29, v67, v67
    v_lshlrev_b32 v128, 16, v64
    v_and_b32 v129, 0xffff0000, v64
    v_dot2c_f32_bf16 v26, s52, v68
    v_dot2c_f32_bf16 v28, v68, v68
    v_dot2c_f32_bf16 v27, s52, v69
    v_dot2c_f32_bf16 v29, v69, v69
    v_dot2c_f32_bf16 v26, s52, v70
    v_dot2c_f32_bf16 v28, v70, v70
    v_dot2c_f32_bf16 v27, s52, v71
    v_dot2c_f32_bf16 v29, v71, v71
    v_lshlrev_b32 v130, 16, v68
    v_and_b32 v131, 0xffff0000, v68
    s_waitcnt vmcnt(14)
    v_dot2c_f32_bf16 v26, s52, v72
    v_dot2c_f32_bf16 v28, v72, v72
    v_dot2c_f32_bf16 v27, s52, v73
    v_dot2c_f32_bf16 v29, v73, v73
    v_dot2c_f32_bf16 v26, s52, v74
    v_dot2c_f32_bf16 v28, v74, v74
    v_dot2c_f32_bf16 v27, s52, v75
    v_dot2c_f32_bf16 v29, v75, v75
    v_lshlrev_b32 v132, 16, v72
    v_and_b32 v133, 0xffff0000, v72
    v_dot2c_f32_bf16 v26, s52, v76
    v_dot2c_f32_bf16 v28, v76, v76
    v_dot2c_f32_bf16 v27, s52, v77
    v_dot2c_f32_bf16 v29, v77, v77
    v_dot2c_f32_bf16 v26, s52, v78
    v_dot2c_f32_bf16 v28, v78, v78
    v_dot2c_f32_bf16 v27, s52, v79
    v_dot2c_f32_bf16 v29, v79, v79
    v_lshlrev_b32 v134, 16, v76
    v_and_b32 v135, 0xffff0000, v76
    s_waitcnt vmcnt(12)
    v_dot2c_f32_bf16 v26, s52, v80
    v_dot2c_f32_bf16 v28, v80, v80
    v_dot2c_f32_bf16 v27, s52, v81
    v_dot2c_f32_bf16 v29, v81, v81
    v_dot2c_f32_bf16 v26, s52, v82
    v_dot2c_f32_bf16 v28, v82, v82
    v_dot2c_f32_bf16 v27, s52, v83
    v_dot2c_f32_bf16 v29, v83, v83
    v_lshlrev_b32 v136, 16, v80
    v_and_b32 v137, 0xffff0000, v80
    v_dot2c_f32_bf16 v26, s52, v84
    v_dot2c_f32_bf16 v28, v84, v84
    v_dot2c_f32_bf16 v27, s52, v85
    v_dot2c_f32_bf16 v29, v85, v85
    v_dot2c_f32_bf16 v26, s52, v86
    v_dot2c_f32_bf16 v28, v86, v86
    v_dot2c_f32_bf16 v27, s52, v87
    v_dot2c_f32_bf16 v29, v87, v87
    v_lshlrev_b32 v138, 16, v84
    v_and_b32 v139, 0xffff0000, v84
    s_waitcnt vmcnt(10)
    v_dot2c_f32_bf16 v26, s52, v88
    v_dot2c_f32_bf16 v28, v88, v88
    v_dot2c_f32_bf16 v27, s52, v89
    v_dot2c_f32_bf16 v29, v89, v89
    v_dot2c_f32_bf16 v26, s52, v90
    v_dot2c_f32_bf16 v28, v90, v90
    v_dot2c_f32_bf16 v27, s52, v91
    v_dot2c_f32_bf16 v29, v91, v91
    v_lshlrev_b32 v140, 16, v88
    v_and_b32 v141, 0xffff0000, v88
    v_dot2c_f32_bf16 v26, s52, v92
    v_dot2c_f32_bf16 v28, v92, v92
    v_dot2c_f32_bf16 v27, s52, v93
    v_dot2c_f32_bf16 v29, v93, v93
    v_dot2c_f32_bf16 v26, s52, v94
    v_dot2c_f32_bf16 v28, v94, v94
    v_dot2c_f32_bf16 v27, s52, v95
    v_dot2c_f32_bf16 v29, v95, v95
    v_lshlrev_b32 v142, 16, v92
    v_and_b32 v143, 0xffff0000, v92
    s_waitcnt vmcnt(8)
    v_dot2c_f32_bf16 v26, s52, v96
    v_dot2c_f32_bf16 v28, v96, v96
    v_dot2c_f32_bf16 v27, s52, v97
    v_dot2c_f32_bf16 v29, v97, v97
    v_dot2c_f32_bf16 v26, s52, v98
    v_dot2c_f32_bf16 v28, v98, v98
    v_dot2c_f32_bf16 v27, s52, v99
    v_dot2c_f32_bf16 v29, v99, v99
    v_lshlrev_b32 v144, 16, v96
    v_and_b32 v145, 0xffff0000, v96
    v_dot2c_f32_bf16 v26, s52, v100
    v_dot2c_f32_bf16 v28, v100, v100
    v_dot2c_f32_bf16 v27, s52, v101
    v_dot2c_f32_bf16 v29, v101, v101
    v_dot2c_f32_bf16 v26, s52, v102
    v_dot2c_f32_bf16 v28, v102, v102
    v_dot2c_f32_bf16 v27, s52, v103
    v_dot2c_f32_bf16 v29, v103, v103
    v_lshlrev_b32 v146, 16, v100
    v_and_b32 v147, 0xffff0000, v100
    s_waitcnt vmcnt(6)
    v_dot2c_f32_bf16 v26, s52, v104
    v_dot2c_f32_bf16 v28, v104, v104
    v_dot2c_f32_bf16 v27, s52, v105
    v_dot2c_f32_bf16 v29, v105, v105
    v_dot2c_f32_bf16 v26, s52, v106
    v_dot2c_f32_bf16 v28, v106, v106
    v_dot2c_f32_bf16 v27, s52, v107
    v_dot2c_f32_bf16 v29, v107, v107
    v_lshlrev_b32 v148, 16, v104
    v_and_b32 v149, 0xffff0000, v104
    v_dot2c_f32_bf16 v26, s52, v108
    v_dot2c_f32_bf16 v28, v108, v108
    v_dot2c_f32_bf16 v27, s52, v109
    v_dot2c_f32_bf16 v29, v109, v109
    v_dot2c_f32_bf16 v26, s52, v110
    v_dot2c_f32_bf16 v28, v110, v110
    v_dot2c_f32_bf16 v27, s52, v111
    v_dot2c_f32_bf16 v29, v111, v111
    v_lshlrev_b32 v150, 16, v108
    v_and_b32 v151, 0xffff0000, v108
    s_waitcnt vmcnt(4)
    v_dot2c_f32_bf16 v26, s52, v112
    v_dot2c_f32_bf16 v28, v112, v112
    v_dot2c_f32_bf16 v27, s52, v113
    v_dot2c_f32_bf16 v29, v113, v113
    v_dot2c_f32_bf16 v26, s52, v114
    v_dot2c_f32_bf16 v28, v114, v114
    v_dot2c_f32_bf16 v27, s52, v115
    v_dot2c_f32_bf16 v29, v115, v115
    v_lshlrev_b32 v152, 16, v112
    v_and_b32 v153, 0xffff0000, v112
    v_dot2c_f32_bf16 v26, s52, v116
    v_dot2c_f32_bf16 v28, v116, v116
    v_dot2c_f32_bf16 v27, s52, v117
    v_dot2c_f32_bf16 v29, v117, v117
    v_dot2c_f32_bf16 v26, s52, v118
    v_dot2c_f32_bf16 v28, v118, v118
    v_dot2c_f32_bf16 v27, s52, v119
    v_dot2c_f32_bf16 v29, v119, v119
    v_lshlrev_b32 v154, 16, v116
    v_and_b32 v155, 0xffff0000, v116
    s_waitcnt vmcnt(2)
    v_dot2c_f32_bf16 v26, s52, v120
    v_dot2c_f32_bf16 v28, v120, v120
    v_dot2c_f32_bf16 v27, s52, v121
    v_dot2c_f32_bf16 v29, v121, v121
    v_dot2c_f32_bf16 v26, s52, v122
    v_dot2c_f32_bf16 v28, v122, v122
    v_dot2c_f32_bf16 v27, s52, v123
    v_dot2c_f32_bf16 v29, v123, v123
    v_lshlrev_b32 v156, 16, v120
    v_and_b32 v157, 0xffff0000, v120
    v_dot2c_f32_bf16 v26, s52, v124
    v_dot2c_f32_bf16 v28, v124, v124
    v_dot2c_f32_bf16 v27, s52, v125
    v_dot2c_f32_bf16 v29, v125, v125
    v_dot2c_f32_bf16 v26, s52, v126
    v_dot2c_f32_bf16 v28, v126, v126
    v_dot2c_f32_bf16 v27, s52, v127
    v_dot2c_f32_bf16 v29, v127, v127
    v_lshlrev_b32 v158, 16, v124
    v_and_b32 v159, 0xffff0000, v124
    s_branch L_jd_6
L_j_3:
    s_waitcnt vmcnt(16)
    v_dot2c_f32_bf16 v26, s52, v64
    v_dot2c_f32_bf16 v28, v64, v64
    v_dot2c_f32_bf16 v27, s52, v65
    v_dot2c_f32_bf16 v29, v65, v65
    v_dot2c_f32_bf16 v26, s52, v66
    v_dot2c_f32_bf16 v28, v66, v66
    v_dot2c_f32_bf16 v27, s52, v67
    v_dot2c_f32_bf16 v29, v67, v67
    v_lshlrev_b32 v128, 16, v65
    v_and_b32 v129, 0xffff0000, v65
    v_dot2c_f32_bf16 v26, s52, v68
    v_dot2c_f32_bf16 v28, v68, v68
    v_dot2c_f32_bf16 v27, s52, v69
    v_dot2c_f32_bf16 v29, v69, v69
    v_dot2c_f32_bf16 v26, s52, v70
    v_dot2c_f32_bf16 v28, v70, v70
    v_dot2c_f32_bf16 v27, s52, v71
    v_dot2c_f32_bf16 v29, v71, v71
    v_lshlrev_b32 v130, 16, v69
    v_and_b32 v131, 0xffff0000, v69
    s_waitcnt vmcnt(14)
    v_dot2c_f32_bf16 v26, s52, v72
    v_dot2c_f32_bf16 v28, v72, v72
    v_dot2c_f32_bf16 v27, s52, v73
    v_dot2c_f32_bf16 v29, v73, v73
    v_dot2c_f32_bf16 v26, s52, v74
    v_dot2c_f32_bf16 v28, v74, v74
    v_dot2c_f32_bf16 v27, s52, v75
    v_dot2c_f32_bf16 v29, v75, v75
    v_lshlrev_b32 v132, 16, v73
    v_and_b32 v133, 0xffff0000, v73
    v_dot2c_f32_bf16 v26, s52, v76
    v_dot2c_f32_bf16 v28, v76, v76
    v_dot2c_f32_bf16 v27, s52, v77
    v_dot2c_f32_bf16 v29, v77, v77
    v_dot2c_f32_bf16 v26, s52, v78
    v_dot2c_f32_bf16 v28, v78, v78
    v_dot2c_f32_bf16 v27, s52, v79
    v_dot2c_f32_bf16 v29, v79, v79
    v_lshlrev_b32 v134, 16, v77
    v_and_b32 v135, 0xffff0000, v77
    s_waitcnt vmcnt(12)
    v_dot2c_f32_bf16 v26, s52, v80
    v_dot2c_f32_bf16 v28, v80, v80
    v_dot2c_f32_bf16 v27, s52, v81
    v_dot2c_f32_bf16 v29, v81, v81
    v_dot2c_f32_bf16 v26, s52, v82
    v_dot2c_f32_bf16 v28, v82, v82
    v_dot2c_f32_bf16 v27, s52, v83
    v_dot2c_f32_bf16 v29, v83, v83
    v_lshlrev_b32 v136, 16, v81
    v_and_b32 v137, 0xffff0000, v81
    v_dot2c_f32_bf16 v26, s52, v84
    v_dot2c_f32_bf16 v28, v84, v84
    v_dot2c_f32_bf16 v27, s52, v85
    v_dot2c_f32_bf16 v29, v85, v85
    v_dot2c_f32_bf16 v26, s52, v86
    v_dot2c_f32_bf16 v28, v86, v86
    v_dot2c_f32_bf16 v27, s52, v87
    v_dot2c_f32_bf16 v29, v87, v87
    v_lshlrev_b32 v138, 16, v85
    v_and_b32 v139, 0xffff0000, v85
    s_waitcnt vmcnt(10)
    v_dot2c_f32_bf16 v26, s52, v88
    v_dot2c_f32_bf16 v28, v88, v88
    v_dot2c_f32_bf16 v27, s52, v89
    v_dot2c_f32_bf16 v29, v89, v89
    v_dot2c_f32_bf16 v26, s52, v90
    v_dot2c_f32_bf16 v28, v90, v90
    v_dot2c_f32_bf16 v27, s52, v91
    v_dot2c_f32_bf16 v29, v91, v91
    v_lshlrev_b32 v140, 16, v89
    v_and_b32 v141, 0xffff0000, v89
    v_dot2c_f32_bf16 v26, s52, v92
    v_dot2c_f32_bf16 v28, v92, v92
    v_dot2c_f32_bf16 v27, s52, v93
    v_dot2c_f32_bf16 v29, v93, v93
    v_dot2c_f32_bf16 v26, s52, v94
    v_dot2c_f32_bf16 v28, v94, v94
    v_dot2c_f32_bf16 v27, s52, v95
    v_dot2c_f32_bf16 v29, v95, v95
    v_lshlrev_b32 v142, 16, v93
    v_and_b32 v143, 0xffff0000, v93
    s_waitcnt vmcnt(8)
    v_dot2c_f32_bf16 v26, s52, v96
    v_dot2c_f32_bf16 v28, v96, v96
    v_dot2c_f32_bf16 v27, s52, v97
    v_dot2c_f32_bf16 v29, v97, v97
    v_dot2c_f32_bf16 v26, s52, v98
    v_dot2c_f32_bf16 v28, v98, v98
    v_dot2c_f32_bf16 v27, s52, v99
    v_dot2c_f32_bf16 v29, v99, v99
    v_lshlrev_b32 v144, 16, v97
    v_and_b32 v145, 0xffff0000, v97
    v_dot2c_f32_bf16 v26, s52, v100
    v_dot2c_f32_bf16 v28, v100, v100
    v_dot2c_f32_bf16 v27, s52, v101
    v_dot2c_f32_bf16 v29, v101, v101
    v_dot2c_f32_bf16 v26, s52, v102
    v_dot2c_f32_bf16 v28, v102, v102
    v_dot2c_f32_bf16 v27, s52, v103
    v_dot2c_f32_bf16 v29, v103, v103
    v_lshlrev_b32 v146, 16, v101
    v_and_b32 v147, 0xffff0000, v101
    s_waitcnt vmcnt(6)
    v_dot2c_f32_bf16 v26, s52, v104
    v_dot2c_f32_bf16 v28, v104, v104
    v_dot2c_f32_bf16 v27, s52, v105
    v_dot2c_f32_bf16 v29, v105, v105
    v_dot2c_f32_bf16 v26, s52, v106
    v_dot2c_f32_bf16 v28, v106, v106
    v_dot2c_f32_bf16 v27, s52, v107
    v_dot2c_f32_bf16 v29, v107, v107
    v_lshlrev_b32 v148, 16, v105
    v_and_b32 v149, 0xffff0000, v105
    v_dot2c_f32_bf16 v26, s52, v108
    v_dot2c_f32_bf16 v28, v108, v108
    v_dot2c_f32_bf16 v27, s52, v109
    v_dot2c_f32_bf16 v29, v109, v109
    v_dot2c_f32_bf16 v26, s52, v110
    v_dot2c_f32_bf16 v28, v110, v110
    v_dot2c_f32_bf16 v27, s52, v111
    v_dot2c_f32_bf16 v29, v111, v111
    v_lshlrev_b32 v150, 16, v109
    v_and_b32 v151, 0xffff0000, v109
    s_waitcnt vmcnt(4)
    v_dot2c_f32_bf16 v26, s52, v112
    v_dot2c_f32_bf16 v28, v112, v112
    v_dot2c_f32_bf16 v27, s52, v113
    v_dot2c_f32_bf16 v29, v113, v113
    v_dot2c_f32_bf16 v26, s52, v114
    v_dot2c_f32_bf16 v28, v114, v114
    v_dot2c_f32_bf16 v27, s52, v115
    v_dot2c_f32_bf16 v29, v115, v115
    v_lshlrev_b32 v152, 16, v113
    v_and_b32 v153, 0xffff0000, v113
    v_dot2c_f32_bf16 v26, s52, v116
    v_dot2c_f32_bf16 v28, v116, v116
    v_dot2c_f32_bf16 v27, s52, v117
    v_dot2c_f32_bf16 v29, v117, v117
    v_dot2c_f32_bf16 v26, s52, v118
    v_dot2c_f32_bf16 v28, v118, v118
    v_dot2c_f32_bf16 v27, s52, v119
    v_dot2c_f32_bf16 v29, v119, v119
    v_lshlrev_b32 v154, 16, v117
    v_and_b32 v155, 0xffff0000, v117
    s_waitcnt vmcnt(2)
    v_dot2c_f32_bf16 v26, s52, v120
    v_dot2c_f32_bf16 v28, v120, v120
    v_dot2c_f32_bf16 v27, s52, v121
    v_dot2c_f32_bf16 v29, v121, v121
    v_dot2c_f32_bf16 v26, s52, v122
    v_dot2c_f32_bf16 v28, v122, v122
    v_dot2c_f32_bf16 v27, s52, v123
    v_dot2c_f32_bf16 v29, v123, v123
    v_lshlrev_b32 v156, 16, v121
    v_and_b32 v157, 0xffff0000, v121
    v_dot2c_f32_bf16 v26, s52, v124
    v_dot2c_f32_bf16 v28, v124, v124
    v_dot2c_f32_bf16 v27, s52, v125
    v_dot2c_f32_bf16 v29, v125, v125
    v_dot2c_f32_bf16 v26, s52, v126
    v_dot2c_f32_bf16 v28, v126, v126
    v_dot2c_f32_bf16 v27, s52, v127
    v_dot2c_f32_bf16 v29, v127, v127
    v_lshlrev_b32 v158, 16, v125
    v_and_b32 v159, 0xffff0000, v125
    s_branch L_jd_6
L_j_4:
    s_cmp_eq_u32 s74, 2
    s_cbranch_scc0 L_j_5
    s_waitcnt vmcnt(16)
    v_dot2c_f32_bf16 v26, s52, v64
    v_dot2c_f32_bf16 v28, v64, v64
    v_dot2c_f32_bf16 v27, s52, v65
    v_dot2c_f32_bf16 v29, v65, v65
    v_dot2c_f32_bf16 v26, s52, v66
    v_dot2c_f32_bf16 v28, v66, v66
    v_dot2c_f32_bf16 v27, s52, v67
    v_dot2c_f32_bf16 v29, v67, v67
    v_lshlrev_b32 v128, 16, v66
    v_and_b32 v129, 0xffff0000, v66
    v_dot2c_f32_bf16 v26, s52, v68
    v_dot2c_f32_bf16 v28, v68, v68
    v_dot2c_f32_bf16 v27, s52, v69
    v_dot2c_f32_bf16 v29, v69, v69
    v_dot2c_f32_bf16 v26, s52, v70
    v_dot2c_f32_bf16 v28, v70, v70
    v_dot2c_f32_bf16 v27, s52, v71
    v_dot2c_f32_bf16 v29, v71, v71
    v_lshlrev_b32 v130, 16, v70
    v_and_b32 v131, 0xffff0000, v70
    s_waitcnt vmcnt(14)
    v_dot2c_f32_bf16 v26, s52, v72
    v_dot2c_f32_bf16 v28, v72, v72
    v_dot2c_f32_bf16 v27, s52, v73
    v_dot2c_f32_bf16 v29, v73, v73
    v_dot2c_f32_bf16 v26, s52, v74
    v_dot2c_f32_bf16 v28, v74, v74
    v_dot2c_f32_bf16 v27, s52, v75
    v_dot2c_f32_bf16 v29, v75, v75
    v_lshlrev_b32 v132, 16, v74
    v_and_b32 v133, 0xffff0000, v74
    v_dot2c_f32_bf16 v26, s52, v76
    v_dot2c_f32_bf16 v28, v76, v76
    v_dot2c_f32_bf16 v27, s52, v77
    v_dot2c_f32_bf16 v29, v77, v77
    v_dot2c_f32_bf16 v26, s52, v78
    v_dot2c_f32_bf16 v28, v78, v78
    v_dot2c_f32_bf16 v27, s52, v79
    v_dot2c_f32_bf16 v29, v79, v79
    v_lshlrev_b32 v134, 16, v78
    v_and_b32 v135, 0xffff0000, v78
    s_waitcnt vmcnt(12)
    v_dot2c_f32_bf16 v26, s52, v80
    v_dot2c_f32_bf16 v28, v80, v80
    v_dot2c_f32_bf16 v27, s52, v81
    v_dot2c_f32_bf16 v29, v81, v81
    v_dot2c_f32_bf16 v26, s52, v82
    v_dot2c_f32_bf16 v28, v82, v82
    v_dot2c_f32_bf16 v27, s52, v83
    v_dot2c_f32_bf16 v29, v83, v83
    v_lshlrev_b32 v136, 16, v82
    v_and_b32 v137, 0xffff0000, v82
    v_dot2c_f32_bf16 v26, s52, v84
    v_dot2c_f32_bf16 v28, v84, v84
    v_dot2c_f32_bf16 v27, s52, v85
    v_dot2c_f32_bf16 v29, v85, v85
    v_dot2c_f32_bf16 v26, s52, v86
    v_dot2c_f32_bf16 v28, v86, v86
    v_dot2c_f32_bf16 v27, s52, v87
    v_dot2c_f32_bf16 v29, v87, v87
    v_lshlrev_b32 v138, 16, v86
    v_and_b32 v139, 0xffff0000, v86
    s_waitcnt vmcnt(10)
    v_dot2c_f32_bf16 v26, s52, v88
    v_dot2c_f32_bf16 v28, v88, v88
    v_dot2c_f32_bf16 v27, s52, v89
    v_dot2c_f32_bf16 v29, v89, v89
    v_dot2c_f32_bf16 v26, s52, v90
    v_dot2c_f32_bf16 v28, v90, v90
    v_dot2c_f32_bf16 v27, s52, v91
    v_dot2c_f32_bf16 v29, v91, v91
    v_lshlrev_b32 v140, 16, v90
    v_and_b32 v141, 0xffff0000, v90
    v_dot2c_f32_bf16 v26, s52, v92
    v_dot2c_f32_bf16 v28, v92, v92
    v_dot2c_f32_bf16 v27, s52, v93
    v_dot2c_f32_bf16 v29, v93, v93
    v_dot2c_f32_bf16 v26, s52, v94
    v_dot2c_f32_bf16 v28, v94, v94
    v_dot2c_f32_bf16 v27, s52, v95
    v_dot2c_f32_bf16 v29, v95, v95
    v_lshlrev_b32 v142, 16, v94
    v_and_b32 v143, 0xffff0000, v94
    s_waitcnt vmcnt(8)
    v_dot2c_f32_bf16 v26, s52, v96
    v_dot2c_f32_bf16 v28, v96, v96
    v_dot2c_f32_bf16 v27, s52, v97
    v_dot2c_f32_bf16 v29, v97, v97
    v_dot2c_f32_bf16 v26, s52, v98
    v_dot2c_f32_bf16 v28, v98, v98
    v_dot2c_f32_bf16 v27, s52, v99
    v_dot2c_f32_bf16 v29, v99, v99
    v_lshlrev_b32 v144, 16, v98
    v_and_b32 v145, 0xffff0000, v98
    v_dot2c_f32_bf16 v26, s52, v100
    v_dot2c_f32_bf16 v28, v100, v100
    v_dot2c_f32_bf16 v27, s52, v101
    v_dot2c_f32_bf16 v29, v101, v101
    v_dot2c_f32_bf16 v26, s52, v102
    v_dot2c_f32_bf16 v28, v102, v102
    v_dot2c_f32_bf16 v27, s52, v103
    v_dot2c_f32_bf16 v29, v103, v103
    v_lshlrev_b32 v146, 16, v102
    v_and_b32 v147, 0xffff0000, v102
    s_waitcnt vmcnt(6)
    v_dot2c_f32_bf16 v26, s52, v104
    v_dot2c_f32_bf16 v28, v104, v104
    v_dot2c_f32_bf16 v27, s52, v105
    v_dot2c_f32_bf16 v29, v105, v105
    v_dot2c_f32_bf16 v26, s52, v106
    v_dot2c_f32_bf16 v28, v106, v106
    v_dot2c_f32_bf16 v27, s52, v107
    v_dot2c_f32_bf16 v29, v107, v107
    v_lshlrev_b32 v148, 16, v106
    v_and_b32 v149, 0xffff0000, v106
    v_dot2c_f32_bf16 v26, s52, v108
    v_dot2c_f32_bf16 v28, v108, v108
    v_dot2c_f32_bf16 v27, s52, v109
    v_dot2c_f32_bf16 v29, v109, v109
    v_dot2c_f32_bf16 v26, s52, v110
    v_dot2c_f32_bf16 v28, v110, v110
    v_dot2c_f32_bf16 v27, s52, v111
    v_dot2c_f32_bf16 v29, v111, v111
    v_lshlrev_b32 v150, 16, v110
    v_and_b32 v151, 0xffff0000, v110
    s_waitcnt vmcnt(4)
    v_dot2c_f32_bf16 v26, s52, v112
    v_dot2c_f32_bf16 v28, v112, v112
    v_dot2c_f32_bf16 v27, s52, v113
    v_dot2c_f32_bf16 v29, v113, v113
    v_dot2c_f32_bf16 v26, s52, v114
    v_dot2c_f32_bf16 v28, v114, v114
    v_dot2c_f32_bf16 v27, s52, v115
    v_dot2c_f32_bf16 v29, v115, v115
    v_lshlrev_b32 v152, 16, v114
    v_and_b32 v153, 0xffff0000, v114
    v_dot2c_f32_bf16 v26, s52, v116
    v_dot2c_f32_bf16 v28, v116, v116
    v_dot2c_f32_bf16 v27, s52, v117
    v_dot2c_f32_bf16 v29, v117, v117
    v_dot2c_f32_bf16 v26, s52, v118
    v_dot2c_f32_bf16 v28, v118, v118
    v_dot2c_f32_bf16 v27, s52, v119
    v_dot2c_f32_bf16 v29, v119, v119
    v_lshlrev_b32 v154, 16, v118
    v_and_b32 v155, 0xffff0000, v118
    s_waitcnt vmcnt(2)
    v_dot2c_f32_bf16 v26, s52, v120
    v_dot2c_f32_bf16 v28, v120, v120
    v_dot2c_f32_bf16 v27, s52, v121
    v_dot2c_f32_bf16 v29, v121, v121
    v_dot2c_f32_bf16 v26, s52, v122
    v_dot2c_f32_bf16 v28, v122, v122
    v_dot2c_f32_bf16 v27, s52, v123
    v_dot2c_f32_bf16 v29, v123, v123
    v_lshlrev_b32 v156, 16, v122
    v_and_b32 v157, 0xffff0000, v122
    v_dot2c_f32_bf16 v26, s52, v124
    v_dot2c_f32_bf16 v28, v124, v124
    v_dot2c_f32_bf16 v27, s52, v125
    v_dot2c_f32_bf16 v29, v125, v125
    v_dot2c_f32_bf16 v26, s52, v126
    v_dot2c_f32_bf16 v28, v126, v126
    v_dot2c_f32_bf16 v27, s52, v127
    v_dot2c_f32_bf16 v29, v127, v127
    v_lshlrev_b32 v158, 16, v126
    v_and_b32 v159, 0xffff0000, v126
    s_branch L_jd_6
L_j_5:
    s_waitcnt vmcnt(16)
    v_dot2c_f32_bf16 v26, s52, v64
    v_dot2c_f32_bf16 v28, v64, v64
    v_dot2c_f32_bf16 v27, s52, v65
    v_dot2c_f32_bf16 v29, v65, v65
    v_dot2c_f32_bf16 v26, s52, v66
    v_dot2c_f32_bf16 v28, v66, v66
    v_dot2c_f32_bf16 v27, s52, v67
    v_dot2c_f32_bf16 v29, v67, v67
    v_lshlrev_b32 v128, 16, v67
    v_and_b32 v129, 0xffff0000, v67
    v_dot2c_f32_bf16 v26, s52, v68
    v_dot2c_f32_bf16 v28, v68, v68
    v_dot2c_f32_bf16 v27, s52, v69
    v_dot2c_f32_bf16 v29, v69, v69
    v_dot2c_f32_bf16 v26, s52, v70
    v_dot2c_f32_bf16 v28, v70, v70
    v_dot2c_f32_bf16 v27, s52, v71
    v_dot2c_f32_bf16 v29, v71, v71
    v_lshlrev_b32 v130, 16, v71
    v_and_b32 v131, 0xffff0000, v71
    s_waitcnt vmcnt(14)
    v_dot2c_f32_bf16 v26, s52, v72
    v_dot2c_f32_bf16 v28, v72, v72
    v_dot2c_f32_bf16 v27, s52, v73
    v_dot2c_f32_bf16 v29, v73, v73
    v_dot2c_f32_bf16 v26, s52, v74
    v_dot2c_f32_bf16 v28, v74, v74
    v_dot2c_f32_bf16 v27, s52, v75
    v_dot2c_f32_bf16 v29, v75, v75
    v_lshlrev_b32 v132, 16, v75
    v_and_b32 v133, 0xffff0000, v75
    v_dot2c_f32_bf16 v26, s52, v76
    v_dot2c_f32_bf16 v28, v76, v76
    v_dot2c_f32_bf16 v27, s52, v77
    v_dot2c_f32_bf16 v29, v77, v77
    v_dot2c_f32_bf16 v26, s52, v78
    v_dot2c_f32_bf16 v28, v78, v78
    v_dot2c_f32_bf16 v27, s52, v79
    v_dot2c_f32_bf16 v29, v79, v79
    v_lshlrev_b32 v134, 16, v79
    v_and_b32 v135, 0xffff0000, v79
    s_waitcnt vmcnt(12)
    v_dot2c_f32_bf16 v26, s52, v80
    v_dot2c_f32_bf16 v28, v80, v80
    v_dot2c_f32_bf16 v27, s52, v81
    v_dot2c_f32_bf16 v29, v81, v81
    v_dot2c_f32_bf16 v26, s52, v82
    v_dot2c_f32_bf16 v28, v82, v82
    v_dot2c_f32_bf16 v27, s52, v83
    v_dot2c_f32_bf16 v29, v83, v83
    v_lshlrev_b32 v136, 16, v83
    v_and_b32 v137, 0xffff0000, v83
    v_dot2c_f32_bf16 v26, s52, v84
    v_dot2c_f32_bf16 v28, v84, v84
    v_dot2c_f32_bf16 v27, s52, v85
    v_dot2c_f32_bf16 v29, v85, v85
    v_dot2c_f32_bf16 v26, s52, v86
    v_dot2c_f32_bf16 v28, v86, v86
    v_dot2c_f32_bf16 v27, s52, v87
    v_dot2c_f32_bf16 v29, v87, v87
    v_lshlrev_b32 v138, 16, v87
    v_and_b32 v139, 0xffff0000, v87
    s_waitcnt vmcnt(10)
    v_dot2c_f32_bf16 v26, s52, v88
    v_dot2c_f32_bf16 v28, v88, v88
    v_dot2c_f32_bf16 v27, s52, v89
    v_dot2c_f32_bf16 v29, v89, v89
    v_dot2c_f32_bf16 v26, s52, v90
    v_dot2c_f32_bf16 v28, v90, v90
    v_dot2c_f32_bf16 v27, s52, v91
    v_dot2c_f32_bf16 v29, v91, v91
    v_lshlrev_b32 v140, 16, v91
    v_and_b32 v141, 0xffff0000, v91
    v_dot2c_f32_bf16 v26, s52, v92
    v_dot2c_f32_bf16 v28, v92, v92
    v_dot2c_f32_bf16 v27, s52, v93
    v_dot2c_f32_bf16 v29, v93, v93
    v_dot2c_f32_bf16 v26, s52, v94
    v_dot2c_f32_bf16 v28, v94, v94
    v_dot2c_f32_bf16 v27, s52, v95
    v_dot2c_f32_bf16 v29, v95, v95
    v_lshlrev_b32 v142, 16, v95
    v_and_b32 v143, 0xffff0000, v95
    s_waitcnt vmcnt(8)
    v_dot2c_f32_bf16 v26, s52, v96
    v_dot2c_f32_bf16 v28, v96, v96
    v_dot2c_f32_bf16 v27, s52, v97
    v_dot2c_f32_bf16 v29, v97, v97
    v_dot2c_f32_bf16 v26, s52, v98
    v_dot2c_f32_bf16 v28, v98, v98
    v_dot2c_f32_bf16 v27, s52, v99
    v_dot2c_f32_bf16 v29, v99, v99
    v_lshlrev_b32 v144, 16, v99
    v_and_b32 v145, 0xffff0000, v99
    v_dot2c_f32_bf16 v26, s52, v100
    v_dot2c_f32_bf16 v28, v100, v100
    v_dot2c_f32_bf16 v27, s52, v101
    v_dot2c_f32_bf16 v29, v101, v101
    v_dot2c_f32_bf16 v26, s52, v102
    v_dot2c_f32_bf16 v28, v102, v102
    v_dot2c_f32_bf16 v27, s52, v103
    v_dot2c_f32_bf16 v29, v103, v103
    v_lshlrev_b32 v146, 16, v103
    v_and_b32 v147, 0xffff0000, v103
    s_waitcnt vmcnt(6)
    v_dot2c_f32_bf16 v26, s52, v104
    v_dot2c_f32_bf16 v28, v104, v104
    v_dot2c_f32_bf16 v27, s52, v105
    v_dot2c_f32_bf16 v29, v105, v105
    v_dot2c_f32_bf16 v26, s52, v106
    v_dot2c_f32_bf16 v28, v106, v106
    v_dot2c_f32_bf16 v27, s52, v107
    v_dot2c_f32_bf16 v29, v107, v107
    v_lshlrev_b32 v148, 16, v107
    v_and_b32 v149, 0xffff0000, v107
    v_dot2c_f32_bf16 v26, s52, v108
    v_dot2c_f32_bf16 v28, v108, v108
    v_dot2c_f32_bf16 v27, s52, v109
    v_dot2c_f32_bf16 v29, v109, v109
    v_dot2c_f32_bf16 v26, s52, v110
    v_dot2c_f32_bf16 v28, v110, v110
    v_dot2c_f32_bf16 v27, s52, v111
    v_dot2c_f32_bf16 v29, v111, v111
    v_lshlrev_b32 v150, 16, v111
    v_and_b32 v151, 0xffff0000, v111
    s_waitcnt vmcnt(4)
    v_dot2c_f32_bf16 v26, s52, v112
    v_dot2c_f32_bf16 v28, v112, v112
    v_dot2c_f32_bf16 v27, s52, v113
    v_dot2c_f32_bf16 v29, v113, v113
    v_dot2c_f32_bf16 v26, s52, v114
    v_dot2c_f32_bf16 v28, v114, v114
    v_dot2c_f32_bf16 v27, s52, v115
    v_dot2c_f32_bf16 v29, v115, v115
    v_lshlrev_b32 v152, 16, v115
    v_and_b32 v153, 0xffff0000, v115
    v_dot2c_f32_bf16 v26, s52, v116
    v_dot2c_f32_bf16 v28, v116, v116
    v_dot2c_f32_bf16 v27, s52, v117
    v_dot2c_f32_bf16 v29, v117, v117
    v_dot2c_f32_bf16 v26, s52, v118
    v_dot2c_f32_bf16 v28, v118, v118
    v_dot2c_f32_bf16 v27, s52, v119
    v_dot2c_f32_bf16 v29, v119, v119
    v_lshlrev_b32 v154, 16, v119
    v_and_b32 v155, 0xffff0000, v119
    s_waitcnt vmcnt(2)
    v_dot2c_f32_bf16 v26, s52, v120
    v_dot2c_f32_bf16 v28, v120, v120
    v_dot2c_f32_bf16 v27, s52, v121
    v_dot2c_f32_bf16 v29, v121, v121
    v_dot2c_f32_bf16 v26, s52, v122
    v_dot2c_f32_bf16 v28, v122, v122
    v_dot2c_f32_bf16 v27, s52, v123
    v_dot2c_f32_bf16 v29, v123, v123
    v_lshlrev_b32 v156, 16, v123
    v_and_b32 v157, 0xffff0000, v123
    v_dot2c_f32_bf16 v26, s52, v124
    v_dot2c_f32_bf16 v28, v124, v124
    v_dot2c_f32_bf16 v27, s52, v125
    v_dot2c_f32_bf16 v29, v125, v125
    v_dot2c_f32_bf16 v26, s52, v126
    v_dot2c_f32_bf16 v28, v126, v126
    v_dot2c_f32_bf16 v27, s52, v127
    v_dot2c_f32_bf16 v29, v127, v127
    v_lshlrev_b32 v158, 16, v127
    v_and_b32 v159, 0xffff0000, v127
L_jd_6:
    s_nop 1
    v_add_f32 v26, v26, v27
    v_add_f32 v28, v28, v29
    s_nop 0
    v_add_f32_dpp v26, v26, v26 quad_perm:[1,0,3,2] row_mask:0xf bank_mask:0xf
    v_add_f32_dpp v28, v28, v28 quad_perm:[1,0,3,2] row_mask:0xf bank_mask:0xf
    s_nop 0
    v_add_f32_dpp v26, v26, v26 quad_perm:[2,3,0,1] row_mask:0xf bank_mask:0xf
    v_add_f32_dpp v28, v28, v28 quad_perm:[2,3,0,1] row_mask:0xf bank_mask:0xf
    v_mul_f32 v26, 0x3b000000, v26
    v_mul_f32 v28, 0x3b000000, v28
    v_fma_f32 v28, -v26, v26, v28
    v_max_f32 v28, 0, v28
    v_add_f32 v28, 0x3727c5ac, v28
    v_rsq_f32 v30, v28
    s_nop 0
    v_mul_f32 v32, -v26, v30
    v_pk_fma_f32 v[128:129], v[128:129], v[30:31], v[32:33] op_sel_hi:[1,0,0]
    v_cvt_pk_bf16_f32 v160, v128, v129
    v_pk_fma_f32 v[130:131], v[130:131], v[30:31], v[32:33] op_sel_hi:[1,0,0]
    v_cvt_pk_bf16_f32 v161, v130, v131
    v_pk_fma_f32 v[132:133], v[132:133], v[30:31], v[32:33] op_sel_hi:[1,0,0]
    v_cvt_pk_bf16_f32 v162, v132, v133
    v_pk_fma_f32 v[134:135], v[134:135], v[30:31], v[32:33] op_sel_hi:[1,0,0]
    v_cvt_pk_bf16_f32 v163, v134, v135
    ds_write_b128 v34, v[160:163] offset:0
    v_pk_fma_f32 v[136:137], v[136:137], v[30:31], v[32:33] op_sel_hi:[1,0,0]
    v_cvt_pk_bf16_f32 v164, v136, v137
    v_pk_fma_f32 v[138:139], v[138:139], v[30:31], v[32:33] op_sel_hi:[1,0,0]
    v_cvt_pk_bf16_f32 v165, v138, v139
    v_pk_fma_f32 v[140:141], v[140:141], v[30:31], v[32:33] op_sel_hi:[1,0,0]
    v_cvt_pk_bf16_f32 v166, v140, v141
    v_pk_fma_f32 v[142:143], v[142:143], v[30:31], v[32:33] op_sel_hi:[1,0,0]
    v_cvt_pk_bf16_f32 v167, v142, v143
    ds_write_b128 v34, v[164:167] offset:16
    v_pk_fma_f32 v[144:145], v[144:145], v[30:31], v[32:33] op_sel_hi:[1,0,0]
    v_cvt_pk_bf16_f32 v168, v144, v145
    v_pk_fma_f32 v[146:147], v[146:147], v[30:31], v[32:33] op_sel_hi:[1,0,0]
    v_cvt_pk_bf16_f32 v169, v146, v147
    v_pk_fma_f32 v[148:149], v[148:149], v[30:31], v[32:33] op_sel_hi:[1,0,0]
    v_cvt_pk_bf16_f32 v170, v148, v149
    v_pk_fma_f32 v[150:151], v[150:151], v[30:31], v[32:33] op_sel_hi:[1,0,0]
    v_cvt_pk_bf16_f32 v171, v150, v151
    ds_write_b128 v35, v[168:171] offset:0
    v_pk_fma_f32 v[152:153], v[152:153], v[30:31], v[32:33] op_sel_hi:[1,0,0]
    v_cvt_pk_bf16_f32 v172, v152, v153
    v_pk_fma_f32 v[154:155], v[154:155], v[30:31], v[32:33] op_sel_hi:[1,0,0]
    v_cvt_pk_bf16_f32 v173, v154, v155
    v_pk_fma_f32 v[156:157], v[156:157], v[30:31], v[32:33] op_sel_hi:[1,0,0]
    v_cvt_pk_bf16_f32 v174, v156, v157
    v_pk_fma_f32 v[158:159], v[158:159], v[30:31], v[32:33] op_sel_hi:[1,0,0]
    v_cvt_pk_bf16_f32 v175, v158, v159
    ds_write_b128 v35, v[172:175] offset:16
    s_waitcnt lgkmcnt(0)
    s_waitcnt vmcnt(0)
    s_barrier
    ds_read_b64_tr_b16 v[64:65], v36 offset:0
    ds_read_b64_tr_b16 v[66:67], v36 offset:1024
    ds_read_b64_tr_b16 v[68:69], v36 offset:8192
    ds_read_b64_tr_b16 v[70:71], v36 offset:9216
    ds_read_b64_tr_b16 v[72:73], v37 offset:0
    ds_read_b64_tr_b16 v[74:75], v37 offset:1024
    ds_read_b64_tr_b16 v[76:77], v37 offset:8192
    ds_read_b64_tr_b16 v[78:79], v37 offset:9216
    ds_read_b64_tr_b16 v[80:81], v38 offset:0
    ds_read_b64_tr_b16 v[82:83], v38 offset:1024
    ds_read_b64_tr_b16 v[84:85], v38 offset:8192
    ds_read_b64_tr_b16 v[86:87], v38 offset:9216
    s_waitcnt lgkmcnt(8)
    v_mfma_f32_16x16x32_bf16 v[128:131], v[48:51], v[64:67], 0
    v_mfma_f32_16x16x32_bf16 v[128:131], v[52:55], v[68:71], v[128:131]
    ds_read_b64_tr_b16 v[88:89], v39 offset:0
    ds_read_b64_tr_b16 v[90:91], v39 offset:1024
    ds_read_b64_tr_b16 v[92:93], v39 offset:8192
    ds_read_b64_tr_b16 v[94:95], v39 offset:9216
    s_waitcnt lgkmcnt(8)
    v_mfma_f32_16x16x32_bf16 v[132:135], v[48:51], v[72:75], 0
    v_mfma_f32_16x16x32_bf16 v[132:135], v[52:55], v[76:79], v[132:135]
    ds_read_b64_tr_b16 v[64:65], v40 offset:0
    ds_read_b64_tr_b16 v[66:67], v40 offset:1024
    ds_read_b64_tr_b16 v[68:69], v40 offset:8192
    ds_read_b64_tr_b16 v[70:71], v40 offset:9216
    s_waitcnt lgkmcnt(8)
    v_mfma_f32_16x16x32_bf16 v[136:139], v[48:51], v[80:83], 0
    v_mfma_f32_16x16x32_bf16 v[136:139], v[52:55], v[84:87], v[136:139]
    ds_read_b64_tr_b16 v[72:73], v41 offset:0
    ds_read_b64_tr_b16 v[74:75], v41 offset:1024
    ds_read_b64_tr_b16 v[76:77], v41 offset:8192
    ds_read_b64_tr_b16 v[78:79], v41 offset:9216
    s_waitcnt lgkmcnt(8)
    v_mfma_f32_16x16x32_bf16 v[140:143], v[48:51], v[88:91], 0
    v_mfma_f32_16x16x32_bf16 v[140:143], v[52:55], v[92:95], v[140:143]
    ds_read_b64_tr_b16 v[80:81], v42 offset:0
    ds_read_b64_tr_b16 v[82:83], v42 offset:1024
    ds_read_b64_tr_b16 v[84:85], v42 offset:8192
    ds_read_b64_tr_b16 v[86:87], v42 offset:9216
    s_waitcnt lgkmcnt(8)
    v_mfma_f32_16x16x32_bf16 v[144:147], v[48:51], v[64:67], 0
    v_mfma_f32_16x16x32_bf16 v[144:147], v[52:55], v[68:71], v[144:147]
    ds_read_b64_tr_b16 v[88:89], v43 offset:0
    ds_read_b64_tr_b16 v[90:91], v43 offset:1024
    ds_read_b64_tr_b16 v[92:93], v43 offset:8192
    ds_read_b64_tr_b16 v[94:95], v43 offset:9216
    s_waitcnt lgkmcnt(8)
    v_mfma_f32_16x16x32_bf16 v[148:151], v[48:51], v[72:75], 0
    v_mfma_f32_16x16x32_bf16 v[148:151], v[52:55], v[76:79], v[148:151]
    s_waitcnt lgkmcnt(4)
    v_mfma_f32_16x16x32_bf16 v[152:155], v[48:51], v[80:83], 0
    v_mfma_f32_16x16x32_bf16 v[152:155], v[52:55], v[84:87], v[152:155]
    s_waitcnt lgkmcnt(0)
    v_mfma_f32_16x16x32_bf16 v[156:159], v[48:51], v[88:91], 0
    v_mfma_f32_16x16x32_bf16 v[156:159], v[52:55], v[92:95], v[156:159]
    v_cvt_pk_bf16_f32 v160, v128, v132
    v_cvt_pk_bf16_f32 v161, v136, v140
    v_cvt_pk_bf16_f32 v162, v144, v148
    s_nop 4
    v_cvt_pk_bf16_f32 v163, v152, v156
    s_add_u32 s22, s51, 0
    buffer_store_dwordx4 v[160:163], v44, s[28:31], s22 offen sc1
    v_cvt_pk_bf16_f32 v164, v129, v133
    v_cvt_pk_bf16_f32 v165, v137, v141
    v_cvt_pk_bf16_f32 v166, v145, v149
    v_cvt_pk_bf16_f32 v167, v153, v157
    s_add_u32 s22, s51, 33024
    buffer_store_dwordx4 v[164:167], v44, s[28:31], s22 offen sc1
    v_cvt_pk_bf16_f32 v168, v130, v134
    v_cvt_pk_bf16_f32 v169, v138, v142
    v_cvt_pk_bf16_f32 v170, v146, v150
    v_cvt_pk_bf16_f32 v171, v154, v158
    s_add_u32 s22, s51, 66048
    buffer_store_dwordx4 v[168:171], v44, s[28:31], s22 offen sc1
    v_cvt_pk_bf16_f32 v172, v131, v135
    v_cvt_pk_bf16_f32 v173, v139, v143
    v_cvt_pk_bf16_f32 v174, v147, v151
    v_cvt_pk_bf16_f32 v175, v155, v159
    s_add_u32 s22, s51, 99072
    buffer_store_dwordx4 v[172:175], v44, s[28:31], s22 offen sc1
    s_branch L_common1
L_proc_other:
    s_cmp_eq_u32 s73, 1
    s_cbranch_scc0 L_proc_idle
    s_mov_b32 s32, s16
    s_mov_b32 s33, s17
    s_mov_b32 s34, 0x300000
    s_mov_b32 s35, 0x00020000
    s_lshl_b32 s22, s74, 7
    buffer_load_dwordx4 v[64:67], v56, s[32:35], s22 offen
    s_add_u32 s22, s22, 49152
    buffer_load_dwordx4 v[68:71], v56, s[32:35], s22 offen
    s_add_u32 s22, s22, 49152
    buffer_load_dwordx4 v[72:75], v56, s[32:35], s22 offen
    s_add_u32 s22, s22, 49152
    buffer_load_dwordx4 v[76:79], v56, s[32:35], s22 offen
    s_add_u32 s22, s22, 49152
    buffer_load_dwordx4 v[80:83], v56, s[32:35], s22 offen
    s_add_u32 s22, s22, 49152
    buffer_load_dwordx4 v[84:87], v56, s[32:35], s22 offen
    s_add_u32 s22, s22, 49152
    buffer_load_dwordx4 v[88:91], v56, s[32:35], s22 offen
    s_add_u32 s22, s22, 49152
    buffer_load_dwordx4 v[92:95], v56, s[32:35], s22 offen
    s_add_u32 s22, s22, 49152
    buffer_load_dwordx4 v[96:99], v56, s[32:35], s22 offen
    s_add_u32 s22, s22, 49152
    buffer_load_dwordx4 v[100:103], v56, s[32:35], s22 offen
    s_add_u32 s22, s22, 49152
    buffer_load_dwordx4 v[104:107], v56, s[32:35], s22 offen
    s_add_u32 s22, s22, 49152
    buffer_load_dwordx4 v[108:111], v56, s[32:35], s22 offen
    s_add_u32 s22, s22, 49152
    buffer_load_dwordx4 v[112:115], v56, s[32:35], s22 offen
    s_add_u32 s22, s22, 49152
    buffer_load_dwordx4 v[116:119], v56, s[32:35], s22 offen
    s_add_u32 s22, s22, 49152
    buffer_load_dwordx4 v[120:123], v56, s[32:35], s22 offen
    s_add_u32 s22, s22, 49152
    buffer_load_dwordx4 v[124:127], v56, s[32:35], s22 offen
    s_waitcnt vmcnt(16)
    s_and_b32 s22, s3, 3
    s_lshl_b32 s43, s7, 2
    s_add_u32 s43, s43, s22
    s_lshr_b32 s42, s3, 3
    s_sub_u32 s22, 64, s43
    s_cmp_eq_u32 s43, 0
    s_cselect_b32 s22, 32, s22
    s_bitcmp1_b32 s3, 2
    s_cselect_b32 s41, s22, s43
    s_lshl_b32 s22, s42, 9
    s_add_u32 s22, s22, s41
    v_bfe_u32 v4, v1, 1, 3
    v_lshlrev_b32 v4, 6, v4
    v_add_u32 v4, s22, v4
    v_cvt_f32_u32 v4, v4
    v_mul_f32 v4, 0x3a000000, v4
    v_lshrrev_b32 v5, 4, v1
    v_lshlrev_b32 v5, 3, v5
    v_cvt_f32_u32 v5, v5
    v_and_b32 v6, 1, v1
    v_cvt_f32_u32 v6, v6
    v_mul_f32 v6, 0x3e800000, v6
    v_fma_f32 v7, v4, v5, v6
    v_mov_b32 v8, v7
    v_cos_f32 v24, v8
    v_add_f32 v8, v8, v4
    v_cos_f32 v25, v8
    v_add_f32 v8, v8, v4
    v_cvt_pk_bf16_f32 v192, v24, v25
    v_cos_f32 v24, v8
    v_add_f32 v8, v8, v4
    v_cos_f32 v25, v8
    v_add_f32 v8, v8, v4
    v_cvt_pk_bf16_f32 v193, v24, v25
    v_cos_f32 v24, v8
    v_add_f32 v8, v8, v4
    v_cos_f32 v25, v8
    v_add_f32 v8, v8, v4
    v_cvt_pk_bf16_f32 v194, v24, v25
    v_cos_f32 v24, v8
    v_add_f32 v8, v8, v4
    v_cos_f32 v25, v8
    v_add_f32 v8, v8, v4
    v_cvt_pk_bf16_f32 v195, v24, v25
    s_mov_b32 s22, 0x3e800000
    s_cmp_lt_u32 s41, 32
    s_cselect_b32 s22, 0xbe800000, s22
    s_cmp_eq_u32 s41, 32
    s_cselect_b32 s22, 0, s22
    s_cselect_b32 s51, 0, -1
    s_cmp_eq_u32 s41, 0
    s_cselect_b32 s52, 0, -1
    v_add_f32 v8, s22, v7
    v_cos_f32 v24, v8
    v_add_f32 v8, v8, v4
    v_cos_f32 v25, v8
    v_add_f32 v8, v8, v4
    v_cvt_pk_bf16_f32 v196, v24, v25
    v_cos_f32 v24, v8
    v_add_f32 v8, v8, v4
    v_cos_f32 v25, v8
    v_add_f32 v8, v8, v4
    v_cvt_pk_bf16_f32 v197, v24, v25
    v_cos_f32 v24, v8
    v_add_f32 v8, v8, v4
    v_cos_f32 v25, v8
    v_add_f32 v8, v8, v4
    v_cvt_pk_bf16_f32 v198, v24, v25
    v_cos_f32 v24, v8
    v_add_f32 v8, v8, v4
    v_cos_f32 v25, v8
    v_add_f32 v8, v8, v4
    v_cvt_pk_bf16_f32 v199, v24, v25
    v_and_b32 v192, s51, v192
    v_and_b32 v196, s52, v196
    v_and_b32 v193, s51, v193
    v_and_b32 v197, s52, v197
    v_and_b32 v194, s51, v194
    v_and_b32 v198, s52, v198
    v_and_b32 v195, s51, v195
    v_and_b32 v199, s52, v199
    v_lshlrev_b32 v128, 16, v128
    v_lshlrev_b32 v129, 16, v129
    v_lshlrev_b32 v130, 16, v130
    v_lshlrev_b32 v131, 16, v131
    v_lshlrev_b32 v132, 16, v132
    v_lshlrev_b32 v133, 16, v133
    v_lshlrev_b32 v134, 16, v134
    v_lshlrev_b32 v135, 16, v135
    v_lshlrev_b32 v136, 16, v136
    v_lshlrev_b32 v137, 16, v137
    v_lshlrev_b32 v138, 16, v138
    v_lshlrev_b32 v139, 16, v139
    v_lshlrev_b32 v140, 16, v140
    v_lshlrev_b32 v141, 16, v141
    v_lshlrev_b32 v142, 16, v142
    v_lshlrev_b32 v143, 16, v143
    v_mul_f32 v144, 0xbfb8aa3b, v128
    v_mul_f32 v145, 0xbfb8aa3b, v129
    v_mul_f32 v146, 0xbfb8aa3b, v130
    v_mul_f32 v147, 0xbfb8aa3b, v131
    v_mul_f32 v148, 0xbfb8aa3b, v132
    v_mul_f32 v149, 0xbfb8aa3b, v133
    v_mul_f32 v150, 0xbfb8aa3b, v134
    v_mul_f32 v151, 0xbfb8aa3b, v135
    v_mul_f32 v152, 0xbfb8aa3b, v136
    v_mul_f32 v153, 0xbfb8aa3b, v137
    v_mul_f32 v154, 0xbfb8aa3b, v138
    v_mul_f32 v155, 0xbfb8aa3b, v139
    v_mul_f32 v156, 0xbfb8aa3b, v140
    v_mul_f32 v157, 0xbfb8aa3b, v141
    v_mul_f32 v158, 0xbfb8aa3b, v142
    v_mul_f32 v159, 0xbfb8aa3b, v143
    v_exp_f32 v144, v144
    v_exp_f32 v145, v145
    v_exp_f32 v146, v146
    v_exp_f32 v147, v147
    v_exp_f32 v148, v148
    v_exp_f32 v149, v149
    v_exp_f32 v150, v150
    v_exp_f32 v151, v151
    v_exp_f32 v152, v152
    v_exp_f32 v153, v153
    v_exp_f32 v154, v154
    v_exp_f32 v155, v155
    v_exp_f32 v156, v156
    v_exp_f32 v157, v157
    v_exp_f32 v158, v158
    v_exp_f32 v159, v159
    v_add_f32 v144, 1.0, v144
    v_add_f32 v145, 1.0, v145
    v_add_f32 v146, 1.0, v146
    v_add_f32 v147, 1.0, v147
    v_add_f32 v148, 1.0, v148
    v_add_f32 v149, 1.0, v149
    v_add_f32 v150, 1.0, v150
    v_add_f32 v151, 1.0, v151
    v_add_f32 v152, 1.0, v152
    v_add_f32 v153, 1.0, v153
    v_add_f32 v154, 1.0, v154
    v_add_f32 v155, 1.0, v155
    v_add_f32 v156, 1.0, v156
    v_add_f32 v157, 1.0, v157
    v_add_f32 v158, 1.0, v158
    v_add_f32 v159, 1.0, v159
    v_rcp_f32 v144, v144
    v_rcp_f32 v145, v145
    v_rcp_f32 v146, v146
    v_rcp_f32 v147, v147
    v_rcp_f32 v148, v148
    v_rcp_f32 v149, v149
    v_rcp_f32 v150, v150
    v_rcp_f32 v151, v151
    v_rcp_f32 v152, v152
    v_rcp_f32 v153, v153
    v_rcp_f32 v154, v154
    v_rcp_f32 v155, v155
    v_rcp_f32 v156, v156
    v_rcp_f32 v157, v157
    v_rcp_f32 v158, v158
    v_rcp_f32 v159, v159
    v_mul_f32 v128, v144, v128
    v_mul_f32 v129, v145, v129
    v_mul_f32 v130, v146, v130
    v_mul_f32 v131, v147, v131
    v_mul_f32 v132, v148, v132
    v_mul_f32 v133, v149, v133
    v_mul_f32 v134, v150, v134
    v_mul_f32 v135, v151, v135
    v_mul_f32 v136, v152, v136
    v_mul_f32 v137, v153, v137
    v_mul_f32 v138, v154, v138
    v_mul_f32 v139, v155, v139
    v_mul_f32 v140, v156, v140
    v_mul_f32 v141, v157, v141
    v_mul_f32 v142, v158, v142
    v_mul_f32 v143, v159, v143
    v_cvt_pk_bf16_f32 v144, v128, 0
    v_cvt_pk_bf16_f32 v160, 0, v128
    v_cvt_pk_bf16_f32 v145, v129, 0
    v_cvt_pk_bf16_f32 v161, 0, v129
    v_cvt_pk_bf16_f32 v146, v130, 0
    v_cvt_pk_bf16_f32 v162, 0, v130
    v_cvt_pk_bf16_f32 v147, v131, 0
    v_cvt_pk_bf16_f32 v163, 0, v131
    v_cvt_pk_bf16_f32 v148, v132, 0
    v_cvt_pk_bf16_f32 v164, 0, v132
    v_cvt_pk_bf16_f32 v149, v133, 0
    v_cvt_pk_bf16_f32 v165, 0, v133
    v_cvt_pk_bf16_f32 v150, v134, 0
    v_cvt_pk_bf16_f32 v166, 0, v134
    v_cvt_pk_bf16_f32 v151, v135, 0
    v_cvt_pk_bf16_f32 v167, 0, v135
    v_cvt_pk_bf16_f32 v152, v136, 0
    v_cvt_pk_bf16_f32 v168, 0, v136
    v_cvt_pk_bf16_f32 v153, v137, 0
    v_cvt_pk_bf16_f32 v169, 0, v137
    v_cvt_pk_bf16_f32 v154, v138, 0
    v_cvt_pk_bf16_f32 v170, 0, v138
    v_cvt_pk_bf16_f32 v155, v139, 0
    v_cvt_pk_bf16_f32 v171, 0, v139
    v_cvt_pk_bf16_f32 v156, v140, 0
    v_cvt_pk_bf16_f32 v172, 0, v140
    v_cvt_pk_bf16_f32 v157, v141, 0
    v_cvt_pk_bf16_f32 v173, 0, v141
    v_cvt_pk_bf16_f32 v158, v142, 0
    v_cvt_pk_bf16_f32 v174, 0, v142
    v_cvt_pk_bf16_f32 v159, v143, 0
    v_cvt_pk_bf16_f32 v175, 0, v143
    s_lshr_b32 s22, s74, 3
    s_cmp_eq_u32 s22, 1
    s_cselect_b32 s52, 1.0, 0
    s_cmp_eq_u32 s22, 4
    s_cselect_b32 s52, 1.0, s52
    s_cmp_eq_u32 s22, 0
    s_cselect_b32 s51, 0x45000000, 1.0
    s_and_b32 s23, s74, 7
    s_lshl_b32 s23, s23, 6
    v_add_u32 v34, s23, v1
    v_bfe_u32 v32, v34, 1, 2
    v_lshlrev_b32 v33, 7, v32
    v_bfe_u32 v32, v34, 0, 1
    v_lshl_add_u32 v33, v32, 6, v33
    v_bfe_u32 v32, v34, 4, 1
    v_lshl_add_u32 v33, v32, 5, v33
    v_bfe_u32 v32, v34, 5, 3
    v_lshl_add_u32 v33, v32, 2, v33
    v_bfe_u32 v32, v34, 3, 1
    v_lshl_add_u32 v33, v32, 1, v33
    v_bfe_u32 v32, v34, 8, 1
    v_add_u32 v33, v32, v33
    v_bfe_u32 v32, v34, 2, 2
    v_lshlrev_b32 v35, 7, v32
    v_bfe_u32 v32, v34, 4, 1
    v_lshl_add_u32 v35, v32, 6, v35
    v_lshrrev_b32 v32, 5, v34
    v_lshl_add_u32 v35, v32, 2, v35
    v_and_b32 v32, 3, v34
    v_add_u32 v35, v32, v35
    s_cmp_lt_u32 s22, 5
    s_cselect_b64 vcc, -1, 0
    v_cndmask_b32 v34, v34, v35, vcc
    s_cmp_lt_u32 s22, 2
    s_cselect_b64 vcc, -1, 0
    v_cndmask_b32 v34, v34, v33, vcc
    v_lshlrev_b32 v34, 2, v34
    s_lshl_b32 s22, s22, 11
    s_add_u32 s22, s22, 327680
    s_mul_i32 s23, s74, 128
    s_add_u32 s50, s23, 20480
    s_cmp_eq_u32 s6, 0
    s_cselect_b32 s50, s50, 2146435072
    v_lshrrev_b32 v36, 3, v0
    v_lshlrev_b32 v36, 8, v36
    v_and_b32 v37, 7, v1
    v_lshl_add_u32 v36, v37, 5, v36
    v_add_u32 v36, 131072, v36
    v_lshlrev_b32 v37, 2, v1
    v_add_u32 v37, 131072, v37
    v_mov_b32 v24, 0
    v_mov_b32 v25, 0
    v_mov_b32 v26, 0
    v_mov_b32 v27, 0
    v_mov_b32 v28, 0
    v_mov_b32 v29, 0
    v_mov_b32 v30, 0
    v_mov_b32 v31, 0
    s_waitcnt vmcnt(14)
    v_dot2c_f32_bf16 v24, v64, v144
    v_dot2c_f32_bf16 v25, v64, v160
    v_dot2c_f32_bf16 v26, v65, v144
    v_dot2c_f32_bf16 v27, v65, v160
    v_dot2c_f32_bf16 v28, v66, v144
    v_dot2c_f32_bf16 v29, v66, v160
    v_dot2c_f32_bf16 v30, v67, v144
    v_dot2c_f32_bf16 v31, v67, v160
    v_dot2c_f32_bf16 v24, v68, v145
    v_dot2c_f32_bf16 v25, v68, v161
    v_dot2c_f32_bf16 v26, v69, v145
    v_dot2c_f32_bf16 v27, v69, v161
    v_dot2c_f32_bf16 v28, v70, v145
    v_dot2c_f32_bf16 v29, v70, v161
    v_dot2c_f32_bf16 v30, v71, v145
    v_dot2c_f32_bf16 v31, v71, v161
    s_waitcnt vmcnt(12)
    v_dot2c_f32_bf16 v24, v72, v146
    v_dot2c_f32_bf16 v25, v72, v162
    v_dot2c_f32_bf16 v26, v73, v146
    v_dot2c_f32_bf16 v27, v73, v162
    v_dot2c_f32_bf16 v28, v74, v146
    v_dot2c_f32_bf16 v29, v74, v162
    v_dot2c_f32_bf16 v30, v75, v146
    v_dot2c_f32_bf16 v31, v75, v162
    v_dot2c_f32_bf16 v24, v76, v147
    v_dot2c_f32_bf16 v25, v76, v163
    v_dot2c_f32_bf16 v26, v77, v147
    v_dot2c_f32_bf16 v27, v77, v163
    v_dot2c_f32_bf16 v28, v78, v147
    v_dot2c_f32_bf16 v29, v78, v163
    v_dot2c_f32_bf16 v30, v79, v147
    v_dot2c_f32_bf16 v31, v79, v163
    s_waitcnt vmcnt(10)
    v_dot2c_f32_bf16 v24, v80, v148
    v_dot2c_f32_bf16 v25, v80, v164
    v_dot2c_f32_bf16 v26, v81, v148
    v_dot2c_f32_bf16 v27, v81, v164
    v_dot2c_f32_bf16 v28, v82, v148
    v_dot2c_f32_bf16 v29, v82, v164
    v_dot2c_f32_bf16 v30, v83, v148
    v_dot2c_f32_bf16 v31, v83, v164
    v_dot2c_f32_bf16 v24, v84, v149
    v_dot2c_f32_bf16 v25, v84, v165
    v_dot2c_f32_bf16 v26, v85, v149
    v_dot2c_f32_bf16 v27, v85, v165
    v_dot2c_f32_bf16 v28, v86, v149
    v_dot2c_f32_bf16 v29, v86, v165
    v_dot2c_f32_bf16 v30, v87, v149
    v_dot2c_f32_bf16 v31, v87, v165
    s_waitcnt vmcnt(8)
    v_dot2c_f32_bf16 v24, v88, v150
    v_dot2c_f32_bf16 v25, v88, v166
    v_dot2c_f32_bf16 v26, v89, v150
    v_dot2c_f32_bf16 v27, v89, v166
    v_dot2c_f32_bf16 v28, v90, v150
    v_dot2c_f32_bf16 v29, v90, v166
    v_dot2c_f32_bf16 v30, v91, v150
    v_dot2c_f32_bf16 v31, v91, v166
    v_dot2c_f32_bf16 v24, v92, v151
    v_dot2c_f32_bf16 v25, v92, v167
    v_dot2c_f32_bf16 v26, v93, v151
    v_dot2c_f32_bf16 v27, v93, v167
    v_dot2c_f32_bf16 v28, v94, v151
    v_dot2c_f32_bf16 v29, v94, v167
    v_dot2c_f32_bf16 v30, v95, v151
    v_dot2c_f32_bf16 v31, v95, v167
    s_waitcnt vmcnt(6)
    v_dot2c_f32_bf16 v24, v96, v152
    v_dot2c_f32_bf16 v25, v96, v168
    v_dot2c_f32_bf16 v26, v97, v152
    v_dot2c_f32_bf16 v27, v97, v168
    v_dot2c_f32_bf16 v28, v98, v152
    v_dot2c_f32_bf16 v29, v98, v168
    v_dot2c_f32_bf16 v30, v99, v152
    v_dot2c_f32_bf16 v31, v99, v168
    v_dot2c_f32_bf16 v24, v100, v153
    v_dot2c_f32_bf16 v25, v100, v169
    v_dot2c_f32_bf16 v26, v101, v153
    v_dot2c_f32_bf16 v27, v101, v169
    v_dot2c_f32_bf16 v28, v102, v153
    v_dot2c_f32_bf16 v29, v102, v169
    v_dot2c_f32_bf16 v30, v103, v153
    v_dot2c_f32_bf16 v31, v103, v169
    s_waitcnt vmcnt(4)
    v_dot2c_f32_bf16 v24, v104, v154
    v_dot2c_f32_bf16 v25, v104, v170
    v_dot2c_f32_bf16 v26, v105, v154
    v_dot2c_f32_bf16 v27, v105, v170
    v_dot2c_f32_bf16 v28, v106, v154
    v_dot2c_f32_bf16 v29, v106, v170
    v_dot2c_f32_bf16 v30, v107, v154
    v_dot2c_f32_bf16 v31, v107, v170
    v_dot2c_f32_bf16 v24, v108, v155
    v_dot2c_f32_bf16 v25, v108, v171
    v_dot2c_f32_bf16 v26, v109, v155
    v_dot2c_f32_bf16 v27, v109, v171
    v_dot2c_f32_bf16 v28, v110, v155
    v_dot2c_f32_bf16 v29, v110, v171
    v_dot2c_f32_bf16 v30, v111, v155
    v_dot2c_f32_bf16 v31, v111, v171
    s_waitcnt vmcnt(2)
    v_dot2c_f32_bf16 v24, v112, v156
    v_dot2c_f32_bf16 v25, v112, v172
    v_dot2c_f32_bf16 v26, v113, v156
    v_dot2c_f32_bf16 v27, v113, v172
    v_dot2c_f32_bf16 v28, v114, v156
    v_dot2c_f32_bf16 v29, v114, v172
    v_dot2c_f32_bf16 v30, v115, v156
    v_dot2c_f32_bf16 v31, v115, v172
    v_dot2c_f32_bf16 v24, v116, v157
    v_dot2c_f32_bf16 v25, v116, v173
    v_dot2c_f32_bf16 v26, v117, v157
    v_dot2c_f32_bf16 v27, v117, v173
    v_dot2c_f32_bf16 v28, v118, v157
    v_dot2c_f32_bf16 v29, v118, v173
    v_dot2c_f32_bf16 v30, v119, v157
    v_dot2c_f32_bf16 v31, v119, v173
    s_waitcnt vmcnt(0)
    v_dot2c_f32_bf16 v24, v120, v158
    v_dot2c_f32_bf16 v25, v120, v174
    v_dot2c_f32_bf16 v26, v121, v158
    v_dot2c_f32_bf16 v27, v121, v174
    v_dot2c_f32_bf16 v28, v122, v158
    v_dot2c_f32_bf16 v29, v122, v174
    v_dot2c_f32_bf16 v30, v123, v158
    v_dot2c_f32_bf16 v31, v123, v174
    v_dot2c_f32_bf16 v24, v124, v159
    v_dot2c_f32_bf16 v25, v124, v175
    v_dot2c_f32_bf16 v26, v125, v159
    v_dot2c_f32_bf16 v27, v125, v175
    v_dot2c_f32_bf16 v28, v126, v159
    v_dot2c_f32_bf16 v29, v126, v175
    v_dot2c_f32_bf16 v30, v127, v159
    v_dot2c_f32_bf16 v31, v127, v175
    ds_write_b128 v36, v[24:27]
    s_nop 1
    ds_write_b128 v36, v[28:31] offset:16
    s_waitcnt lgkmcnt(0)
    s_barrier
    s_cmp_lg_u32 s6, 0
    s_cbranch_scc1 L_gv_7
    ds_read2st64_b32 v[64:65], v37 offset0:0 offset1:1
    ds_read2st64_b32 v[66:67], v37 offset0:2 offset1:3
    ds_read2st64_b32 v[68:69], v37 offset0:4 offset1:5
    ds_read2st64_b32 v[70:71], v37 offset0:6 offset1:7
    ds_read2st64_b32 v[72:73], v37 offset0:8 offset1:9
    ds_read2st64_b32 v[74:75], v37 offset0:10 offset1:11
    ds_read2st64_b32 v[76:77], v37 offset0:12 offset1:13
    ds_read2st64_b32 v[78:79], v37 offset0:14 offset1:15
    ds_read2st64_b32 v[80:81], v37 offset0:16 offset1:17
    ds_read2st64_b32 v[82:83], v37 offset0:18 offset1:19
    ds_read2st64_b32 v[84:85], v37 offset0:20 offset1:21
    ds_read2st64_b32 v[86:87], v37 offset0:22 offset1:23
    s_waitcnt lgkmcnt(8)
    ds_read2st64_b32 v[88:89], v37 offset0:24 offset1:25
    ds_read2st64_b32 v[90:91], v37 offset0:26 offset1:27
    ds_read2st64_b32 v[92:93], v37 offset0:28 offset1:29
    ds_read2st64_b32 v[94:95], v37 offset0:30 offset1:31
    s_waitcnt lgkmcnt(0)
    v_pk_add_f32 v[64:65], v[64:65], v[80:81]
    v_pk_add_f32 v[66:67], v[66:67], v[82:83]
    v_pk_add_f32 v[68:69], v[68:69], v[84:85]
    v_pk_add_f32 v[70:71], v[70:71], v[86:87]
    v_pk_add_f32 v[72:73], v[72:73], v[88:89]
    v_pk_add_f32 v[74:75], v[74:75], v[90:91]
    v_pk_add_f32 v[76:77], v[76:77], v[92:93]
    v_pk_add_f32 v[78:79], v[78:79], v[94:95]
    v_pk_add_f32 v[64:65], v[64:65], v[72:73]
    v_pk_add_f32 v[66:67], v[66:67], v[74:75]
    v_pk_add_f32 v[68:69], v[68:69], v[76:77]
    v_pk_add_f32 v[70:71], v[70:71], v[78:79]
    v_pk_add_f32 v[64:65], v[64:65], v[68:69]
    v_pk_add_f32 v[66:67], v[66:67], v[70:71]
    v_pk_add_f32 v[64:65], v[64:65], v[66:67]
    v_add_f32 v64, v64, v65
    v_cvt_pk_bf16_f32 v64, 0, v64
    v_add_f32 v64, s52, v64
    v_cvt_pk_bf16_f32 v64, 0, v64
    v_mul_f32 v64, s51, v64
    buffer_store_dword v64, v34, s[28:31], s22 offen sc1
L_gv_7:
    s_branch L_common1
L_proc_idle:
    s_mov_b32 s32, s12
    s_mov_b32 s33, s13
    s_mov_b32 s34, 0x158000
    s_mov_b32 s35, 0x00020000
    s_sub_u32 s23, s3, 22
    s_mul_i32 s22, s7, 9
    s_add_u32 s22, s22, s23
    s_lshl_b32 s22, s22, 2
    s_add_u32 s56, s22, s6
    s_cmp_lt_u32 s23, 9
    s_cselect_b32 s56, s56, 0x4000
    s_add_u32 s57, s56, 288
    v_lshrrev_b32 v26, 4, v1
    v_and_b32 v27, 15, v1
    v_lshlrev_b32 v27, 4, v27
    v_lshl_add_u32 v26, v26, 10, v27
    s_lshl_b32 s52, s6, 13
    s_add_u32 s52, s52, 65536
    v_lshrrev_b32 v27, 5, v1
    v_bfe_u32 v28, v1, 2, 2
    v_lshl_add_u32 v27, v27, 2, v28
    v_lshlrev_b32 v27, 8, v27
    v_bfe_u32 v28, v1, 4, 1
    v_lshl_add_u32 v27, v28, 5, v27
    v_and_b32 v28, 3, v1
    v_lshl_add_u32 v27, v28, 3, v27
    v_add_u32 v27, s52, v27
    v_lshlrev_b32 v28, 4, v1
    s_and_b32 s22, s3, 3
    s_lshl_b32 s43, s7, 2
    s_add_u32 s43, s43, s22
    s_lshr_b32 s42, s3, 3
    s_sub_u32 s22, 64, s43
    s_cmp_eq_u32 s43, 0
    s_cselect_b32 s22, 32, s22
    s_bitcmp1_b32 s3, 2
    s_cselect_b32 s41, s22, s43
    s_lshl_b32 s22, s42, 9
    s_add_u32 s22, s22, s41
    v_bfe_u32 v4, v1, 1, 3
    v_lshlrev_b32 v4, 6, v4
    v_add_u32 v4, s22, v4
    v_cvt_f32_u32 v4, v4
    v_mul_f32 v4, 0x3a000000, v4
    v_lshrrev_b32 v5, 4, v1
    v_lshlrev_b32 v5, 3, v5
    v_cvt_f32_u32 v5, v5
    v_and_b32 v6, 1, v1
    v_cvt_f32_u32 v6, v6
    v_mul_f32 v6, 0x3e800000, v6
    v_fma_f32 v7, v4, v5, v6
    v_mov_b32 v8, v7
    v_cos_f32 v24, v8
    v_add_f32 v8, v8, v4
    v_cos_f32 v25, v8
    v_add_f32 v8, v8, v4
    v_cvt_pk_bf16_f32 v192, v24, v25
    v_cos_f32 v24, v8
    v_add_f32 v8, v8, v4
    v_cos_f32 v25, v8
    v_add_f32 v8, v8, v4
    v_cvt_pk_bf16_f32 v193, v24, v25
    v_cos_f32 v24, v8
    v_add_f32 v8, v8, v4
    v_cos_f32 v25, v8
    v_add_f32 v8, v8, v4
    v_cvt_pk_bf16_f32 v194, v24, v25
    v_cos_f32 v24, v8
    v_add_f32 v8, v8, v4
    v_cos_f32 v25, v8
    v_add_f32 v8, v8, v4
    v_cvt_pk_bf16_f32 v195, v24, v25
    s_mov_b32 s22, 0x3e800000
    s_cmp_lt_u32 s41, 32
    s_cselect_b32 s22, 0xbe800000, s22
    s_cmp_eq_u32 s41, 32
    s_cselect_b32 s22, 0, s22
    s_cselect_b32 s51, 0, -1
    s_cmp_eq_u32 s41, 0
    s_cselect_b32 s52, 0, -1
    v_add_f32 v8, s22, v7
    v_cos_f32 v24, v8
    v_add_f32 v8, v8, v4
    v_cos_f32 v25, v8
    v_add_f32 v8, v8, v4
    v_cvt_pk_bf16_f32 v196, v24, v25
    v_cos_f32 v24, v8
    v_add_f32 v8, v8, v4
    v_cos_f32 v25, v8
    v_add_f32 v8, v8, v4
    v_cvt_pk_bf16_f32 v197, v24, v25
    v_cos_f32 v24, v8
    v_add_f32 v8, v8, v4
    v_cos_f32 v25, v8
    v_add_f32 v8, v8, v4
    v_cvt_pk_bf16_f32 v198, v24, v25
    v_cos_f32 v24, v8
    v_add_f32 v8, v8, v4
    v_cos_f32 v25, v8
    v_add_f32 v8, v8, v4
    v_cvt_pk_bf16_f32 v199, v24, v25
    v_and_b32 v192, s51, v192
    v_and_b32 v196, s52, v196
    v_and_b32 v193, s51, v193
    v_and_b32 v197, s52, v197
    v_and_b32 v194, s51, v194
    v_and_b32 v198, s52, v198
    v_and_b32 v195, s51, v195
    v_and_b32 v199, s52, v199
    s_and_b32 s22, s7, 1
    s_bfe_u32 s23, s7, 0x10001
    s_add_u32 s51, s23, 5
    s_mul_i32 s51, s51, s22
    s_sub_u32 s52, 6, s22
    s_mul_i32 s52, s52, s23
    s_lshr_b32 s53, s7, 2
    s_mul_i32 s53, s53, 11
    s_add_u32 s52, s52, s53
    s_cmp_eq_u32 s22, s23
    s_cselect_b32 s22, 43, 52
    s_cselect_b32 s23, 6, 5
    s_mul_i32 s22, s22, s3
    s_lshr_b32 s22, s22, 8
    s_mul_i32 s23, s23, s22
    s_sub_u32 s23, s3, s23
    s_cmp_lt_u32 s3, 30
    s_cselect_b32 s46, 1, 0
    s_cselect_b32 s22, s22, 0
    s_cselect_b32 s23, s23, 0
    s_and_b32 s53, s7, 3
    s_lshl_b32 s53, s53, 5
    s_add_u32 s53, s53, s3
    s_cmp_eq_u32 s53, 62
    s_cselect_b32 s46, 1, s46
    s_cselect_b32 s23, 5, s23
    s_add_u32 s44, s51, s22
    s_add_u32 s45, s52, s23
    s_mul_i32 s68, s22, 2736
    s_lshr_b32 s68, s68, 9
    s_and_b32 s47, s3, 3
    s_and_b32 s23, s7, 1
    s_lshl_b32 s23, s23, 2
    s_add_u32 s47, s47, s23
    s_lshr_b32 s22, s3, 2
    s_lshr_b32 s23, s7, 1
    s_lshl_b32 s23, s23, 3
    s_add_u32 s22, s22, s23
    s_mul_i32 s49, s22, 171
    s_lshr_b32 s49, s49, 9
    s_mul_i32 s23, s49, 3
    s_sub_u32 s48, s22, s23
    s_and_b32 s22, s6, 1
    v_lshrrev_b32 v2, 3, v1
    v_bfe_u32 v3, v1, 4, 1
    v_lshlrev_b32 v3, 1, v3
    v_add_u32 v3, s22, v3
    v_bfe_u32 v4, v1, 1, 2
    v_xor_b32 v3, v3, v4
    v_lshlrev_b32 v3, 1, v3
    v_and_b32 v4, 1, v1
    v_add_u32 v3, v3, v4
    v_mul_u32_u24 v2, 2752, v2
    v_lshl_add_u32 v176, v3, 4, v2
    s_lshr_b32 s23, s6, 1
    s_mul_i32 s51, s23, 352256
    s_lshl_b32 s52, s45, 7
    s_add_u32 s20, s51, s52
    s_lshl_b32 s22, s22, 15
    s_lshl_b32 s23, s23, 14
    s_add_u32 s21, s22, s23
    v_bfe_u32 v2, v1, 1, 1
    v_lshlrev_b32 v3, 15, v2
    v_bfe_u32 v4, v1, 3, 1
    v_lshl_add_u32 v2, v4, 1, v2
    v_xor_b32 v2, s6, v2
    v_lshl_add_u32 v3, v2, 5, v3
    v_lshrrev_b32 v2, 5, v1
    v_bfe_u32 v4, v1, 2, 2
    v_lshl_add_u32 v2, v2, 3, v4
    v_lshl_add_u32 v3, v2, 7, v3
    v_bfe_u32 v2, v1, 4, 1
    v_lshl_add_u32 v3, v2, 4, v3
    v_and_b32 v2, 1, v1
    v_lshl_add_u32 v177, v2, 3, v3
    v_accvgpr_write_b32 a120, -1
    v_accvgpr_write_b32 a121, -1
    v_accvgpr_write_b32 a122, -1
    v_accvgpr_write_b32 a123, -1
    v_accvgpr_write_b32 a124, v176
    v_accvgpr_write_b32 a125, v177
    s_waitcnt lgkmcnt(0)
    s_lshl_b32 s52, s6, 13
    s_add_u32 s52, s52, 65536
    s_lshr_b32 s22, s56, 2
    s_lshl_b32 s22, s22, 14
    s_and_b32 s23, s56, 3
    s_lshl_b32 s23, s23, 8
    s_add_u32 s22, s22, s23
    s_add_u32 m0, s52, 0
    s_add_u32 s23, s22, 0
    buffer_load_dwordx4 v26, s[32:35], s23 offen lds
    s_add_u32 m0, s52, 1024
    s_add_u32 s23, s22, 4096
    buffer_load_dwordx4 v26, s[32:35], s23 offen lds
    s_add_u32 m0, s52, 2048
    s_add_u32 s23, s22, 8192
    buffer_load_dwordx4 v26, s[32:35], s23 offen lds
    s_add_u32 m0, s52, 3072
    s_add_u32 s23, s22, 12288
    buffer_load_dwordx4 v26, s[32:35], s23 offen lds
    s_mul_i32 s58, s56, 128
    s_add_u32 s58, s58, 458752
    s_cmp_lt_u32 s56, 344
    s_cselect_b32 s58, s58, 2146435072
    s_lshl_b32 s22, s56, 12
    s_add_u32 s22, s22, 13631488
    s_cselect_b32 s56, s22, 2146435072
    s_cmp_lt_u32 s58, 2146435072
    s_cselect_b32 s56, s22, 2146435072
    s_lshr_b32 s22, s57, 2
    s_lshl_b32 s22, s22, 14
    s_and_b32 s23, s57, 3
    s_lshl_b32 s23, s23, 8
    s_add_u32 s22, s22, s23
    s_add_u32 m0, s52, 4096
    s_add_u32 s23, s22, 0
    buffer_load_dwordx4 v26, s[32:35], s23 offen lds
    s_add_u32 m0, s52, 5120
    s_add_u32 s23, s22, 4096
    buffer_load_dwordx4 v26, s[32:35], s23 offen lds
    s_add_u32 m0, s52, 6144
    s_add_u32 s23, s22, 8192
    buffer_load_dwordx4 v26, s[32:35], s23 offen lds
    s_add_u32 m0, s52, 7168
    s_add_u32 s23, s22, 12288
    buffer_load_dwordx4 v26, s[32:35], s23 offen lds
    s_mul_i32 s59, s57, 128
    s_add_u32 s59, s59, 458752
    s_cmp_lt_u32 s57, 344
    s_cselect_b32 s59, s59, 2146435072
    s_lshl_b32 s22, s57, 12
    s_add_u32 s22, s22, 13631488
    s_cselect_b32 s57, s22, 2146435072
    s_cmp_lt_u32 s59, 2146435072
    s_cselect_b32 s57, s22, 2146435072
    s_sub_u32 s23, s3, 22
    s_cmp_lt_u32 s23, 9
    s_cselect_b32 s23, s23, 0x1000
    s_lshl_b32 s23, s23, 1
    s_lshr_b32 s51, s6, 1
    s_add_u32 s23, s23, s51
    s_mul_i32 s22, s7, 18
    s_add_u32 s22, s22, s23
    s_mul_i32 s23, s22, 4992
    s_add_u32 s23, s23, 704512
    v_min_u32 v24, 38, v1
    v_lshlrev_b32 v24, 7, v24
    buffer_load_dword v186, v24, s[76:79], s23 offen
    s_waitcnt vmcnt(5)
    ds_read_b64_tr_b16 v[64:65], v27 offset:0
    ds_read_b64_tr_b16 v[66:67], v27 offset:2048
    ds_read_b64_tr_b16 v[68:69], v27 offset:64
    ds_read_b64_tr_b16 v[70:71], v27 offset:2112
    ds_read_b64_tr_b16 v[72:73], v27 offset:128
    ds_read_b64_tr_b16 v[74:75], v27 offset:2176
    ds_read_b64_tr_b16 v[76:77], v27 offset:192
    ds_read_b64_tr_b16 v[78:79], v27 offset:2240
    s_waitcnt vmcnt(1)
    ds_read_b64_tr_b16 v[80:81], v27 offset:4096
    ds_read_b64_tr_b16 v[82:83], v27 offset:6144
    ds_read_b64_tr_b16 v[84:85], v27 offset:4160
    ds_read_b64_tr_b16 v[86:87], v27 offset:6208
    ds_read_b64_tr_b16 v[88:89], v27 offset:4224
    ds_read_b64_tr_b16 v[90:91], v27 offset:6272
    ds_read_b64_tr_b16 v[92:93], v27 offset:4288
    s_waitcnt lgkmcnt(11)
    ds_read_b64_tr_b16 v[94:95], v27 offset:6336
    s_waitcnt lgkmcnt(8)
    buffer_store_dwordx4 v[64:67], v28, s[28:31], s56 offen offset:0 sc1
    buffer_store_dwordx4 v[68:71], v28, s[28:31], s56 offen offset:1024 sc1
    buffer_store_dwordx4 v[72:75], v28, s[28:31], s56 offen offset:2048 sc1
    buffer_store_dwordx4 v[76:79], v28, s[28:31], s56 offen offset:3072 sc1
    s_waitcnt lgkmcnt(0)
    buffer_store_dwordx4 v[80:83], v28, s[28:31], s57 offen offset:0 sc1
    buffer_store_dwordx4 v[84:87], v28, s[28:31], s57 offen offset:1024 sc1
    buffer_store_dwordx4 v[88:91], v28, s[28:31], s57 offen offset:2048 sc1
    buffer_store_dwordx4 v[92:95], v28, s[28:31], s57 offen offset:3072 sc1
    s_mul_i32 s40, s40, 0x9E3779B1
    s_add_u32 s40, s40, 0x7F4A7C15
    v_mov_b32 v29, s40
    v_mov_b32 v30, 0
    s_waitcnt vmcnt(0)
    buffer_store_dword v29, v30, s[28:31], s58 offen sc1
    buffer_store_dword v29, v30, s[28:31], s59 offen sc1
    s_cmp_eq_u32 s46, 0
    s_cbranch_scc1 L_idle_nob1_8
    s_add_u32 m0, s21, 0
    s_nop 0
    buffer_load_dwordx4 v176, s[76:79], s20 offen lds
    s_add_u32 m0, m0, 1024
    s_add_u32 s20, s20, 22016
    buffer_load_dwordx4 v176, s[76:79], s20 offen lds
    s_add_u32 m0, m0, 1024
    s_add_u32 s20, s20, 22016
    buffer_load_dwordx4 v176, s[76:79], s20 offen lds
    s_add_u32 m0, m0, 1024
    s_add_u32 s20, s20, 22016
    buffer_load_dwordx4 v176, s[76:79], s20 offen lds
    s_add_u32 m0, m0, 1024
    s_add_u32 s20, s20, 22016
    buffer_load_dwordx4 v176, s[76:79], s20 offen lds
    s_add_u32 m0, m0, 1024
    s_add_u32 s20, s20, 22016
    buffer_load_dwordx4 v176, s[76:79], s20 offen lds
    s_add_u32 m0, m0, 1024
    s_add_u32 s20, s20, 22016
    buffer_load_dwordx4 v176, s[76:79], s20 offen lds
    s_add_u32 m0, m0, 1024
    s_add_u32 s20, s20, 22016
    buffer_load_dwordx4 v176, s[76:79], s20 offen lds
    s_add_u32 m0, m0, 1024
    s_add_u32 s20, s20, 22016
    buffer_load_dwordx4 v176, s[76:79], s20 offen lds
    s_add_u32 m0, m0, 1024
    s_add_u32 s20, s20, 22016
    buffer_load_dwordx4 v176, s[76:79], s20 offen lds
    s_add_u32 m0, m0, 1024
    s_add_u32 s20, s20, 22016
    buffer_load_dwordx4 v176, s[76:79], s20 offen lds
    s_add_u32 m0, m0, 1024
    s_add_u32 s20, s20, 22016
    buffer_load_dwordx4 v176, s[76:79], s20 offen lds
    s_add_u32 m0, m0, 1024
    s_add_u32 s20, s20, 22016
    buffer_load_dwordx4 v176, s[76:79], s20 offen lds
    s_add_u32 m0, m0, 1024
    s_add_u32 s20, s20, 22016
    buffer_load_dwordx4 v176, s[76:79], s20 offen lds
    s_add_u32 m0, m0, 1024
    s_add_u32 s20, s20, 22016
    buffer_load_dwordx4 v176, s[76:79], s20 offen lds
    s_add_u32 m0, m0, 1024
    s_add_u32 s20, s20, 22016
    buffer_load_dwordx4 v176, s[76:79], s20 offen lds
L_idle_nob1_8:
L_common1:
    s_cmp_eq_u32 s73, 2
    s_cbranch_scc1 L_nosetup_9
    s_and_b32 s22, s7, 1
    s_bfe_u32 s23, s7, 0x10001
    s_add_u32 s51, s23, 5
    s_mul_i32 s51, s51, s22
    s_sub_u32 s52, 6, s22
    s_mul_i32 s52, s52, s23
    s_lshr_b32 s53, s7, 2
    s_mul_i32 s53, s53, 11
    s_add_u32 s52, s52, s53
    s_cmp_eq_u32 s22, s23
    s_cselect_b32 s22, 43, 52
    s_cselect_b32 s23, 6, 5
    s_mul_i32 s22, s22, s3
    s_lshr_b32 s22, s22, 8
    s_mul_i32 s23, s23, s22
    s_sub_u32 s23, s3, s23
    s_cmp_lt_u32 s3, 30
    s_cselect_b32 s46, 1, 0
    s_cselect_b32 s22, s22, 0
    s_cselect_b32 s23, s23, 0
    s_and_b32 s53, s7, 3
    s_lshl_b32 s53, s53, 5
    s_add_u32 s53, s53, s3
    s_cmp_eq_u32 s53, 62
    s_cselect_b32 s46, 1, s46
    s_cselect_b32 s23, 5, s23
    s_add_u32 s44, s51, s22
    s_add_u32 s45, s52, s23
    s_mul_i32 s68, s22, 2736
    s_lshr_b32 s68, s68, 9
    s_and_b32 s47, s3, 3
    s_and_b32 s23, s7, 1
    s_lshl_b32 s23, s23, 2
    s_add_u32 s47, s47, s23
    s_lshr_b32 s22, s3, 2
    s_lshr_b32 s23, s7, 1
    s_lshl_b32 s23, s23, 3
    s_add_u32 s22, s22, s23
    s_mul_i32 s49, s22, 171
    s_lshr_b32 s49, s49, 9
    s_mul_i32 s23, s49, 3
    s_sub_u32 s48, s22, s23
    s_and_b32 s22, s6, 1
    v_lshrrev_b32 v2, 3, v1
    v_bfe_u32 v3, v1, 4, 1
    v_lshlrev_b32 v3, 1, v3
    v_add_u32 v3, s22, v3
    v_bfe_u32 v4, v1, 1, 2
    v_xor_b32 v3, v3, v4
    v_lshlrev_b32 v3, 1, v3
    v_and_b32 v4, 1, v1
    v_add_u32 v3, v3, v4
    v_mul_u32_u24 v2, 2752, v2
    v_lshl_add_u32 v176, v3, 4, v2
    s_lshr_b32 s23, s6, 1
    s_mul_i32 s51, s23, 352256
    s_lshl_b32 s52, s45, 7
    s_add_u32 s20, s51, s52
    s_lshl_b32 s22, s22, 15
    s_lshl_b32 s23, s23, 14
    s_add_u32 s21, s22, s23
    v_bfe_u32 v2, v1, 1, 1
    v_lshlrev_b32 v3, 15, v2
    v_bfe_u32 v4, v1, 3, 1
    v_lshl_add_u32 v2, v4, 1, v2
    v_xor_b32 v2, s6, v2
    v_lshl_add_u32 v3, v2, 5, v3
    v_lshrrev_b32 v2, 5, v1
    v_bfe_u32 v4, v1, 2, 2
    v_lshl_add_u32 v2, v2, 3, v4
    v_lshl_add_u32 v3, v2, 7, v3
    v_bfe_u32 v2, v1, 4, 1
    v_lshl_add_u32 v3, v2, 4, v3
    v_and_b32 v2, 1, v1
    v_lshl_add_u32 v177, v2, 3, v3
    v_accvgpr_write_b32 a120, -1
    v_accvgpr_write_b32 a121, -1
    v_accvgpr_write_b32 a122, -1
    v_accvgpr_write_b32 a123, -1
    v_accvgpr_write_b32 a124, v176
    v_accvgpr_write_b32 a125, v177
L_nosetup_9:
    s_lshl_b32 s22, s6, 7
    s_lshr_b32 s23, s43, 3
    s_add_u32 s22, s22, s23
    s_mul_i32 s22, s22, 128
    s_add_u32 s22, s22, 393216
    v_and_b32 v2, 31, v1
    v_mul_u32_u24 v2, 512, v2
    v_add_u32 v2, s22, v2
    s_mul_i32 s22, s6, 12
    s_and_b32 s22, s22, 0x38
    s_mul_i32 s22, s22, 128
    s_add_u32 s22, s22, 20480
    v_and_b32 v3, 15, v1
    v_mul_u32_u24 v3, 128, v3
    v_add_u32 v15, s22, v3
    v_lshlrev_b32 v4, 4, v1
    v_subrev_u32 v3, 16, v1
    v_lshl_add_u32 v3, v3, 2, s6
    v_min_u32 v3, 85, v3
    s_lshr_b32 s22, s47, 1
    v_lshl_add_u32 v3, v3, 2, s22
    v_mul_u32_u24 v3, 128, v3
    v_add_u32 v3, 458752, v3
    v_cmp_lt_u32 vcc, 15, v1
    s_nop 1
    v_cndmask_b32 v15, v15, v3, vcc
    v_lshrrev_b32 v7, 4, v1
    v_bfe_u32 v8, v1, 1, 3
    v_xor_b32 v8, v8, v7
    v_lshlrev_b32 v8, 5, v8
    v_and_b32 v9, 1, v1
    v_lshl_add_u32 v8, v9, 4, v8
    v_lshl_add_u32 v5, v7, 10, v8
    v_xor_b32 v6, 128, v5
    v_bfe_u32 v8, v1, 4, 1
    s_lshl_b32 s22, s6, 1
    v_add_u32 v8, s22, v8
    v_and_b32 v9, 15, v1
    v_lshlrev_b32 v9, 6, v9
    v_lshrrev_b32 v10, 5, v1
    v_lshl_add_u32 v9, v10, 5, v9
    v_lshl_add_u32 v7, v8, 16, v9
    v_lshlrev_b32 v10, 8, v10
    v_and_b32 v9, 15, v1
    v_lshl_add_u32 v8, v9, 4, v10
    v_add_u32 v8, 147456, v8
    v_lshrrev_b32 v9, 4, v1
    s_lshl_b32 s22, s6, 9
    s_add_u32 s22, s22, 147456
    v_lshl_add_u32 v9, v9, 7, s22
    v_lshrrev_b32 v10, 4, v1
    v_bfe_u32 v11, v1, 2, 2
    v_lshl_add_u32 v16, v10, 3, v11
    v_lshlrev_b32 v16, 8, v16
    v_and_b32 v10, 1, v10
    v_lshl_add_u32 v10, v10, 2, v11
    v_lshl_add_u32 v16, v10, 5, v16
    v_and_b32 v10, 3, v1
    v_lshl_add_u32 v16, v10, 3, v16
    s_lshl_b32 s22, s6, 14
    s_add_u32 s22, s22, 65536
    v_add_u32 v16, s22, v16
    v_xor_b32 v17, 32, v16
    v_xor_b32 v18, 64, v16
    v_xor_b32 v19, 96, v16
    v_xor_b32 v20, 128, v16
    v_xor_b32 v21, 160, v16
    v_xor_b32 v22, 192, v16
    v_xor_b32 v23, 224, v16
    v_and_b32 v11, 15, v1
    v_lshrrev_b32 v12, 5, v1
    s_lshl_b32 s22, s6, 1
    v_add_u32 v12, s22, v12
    v_and_b32 v13, 7, v1
    v_xor_b32 v12, v12, v13
    v_lshlrev_b32 v12, 4, v12
    v_lshl_add_u32 v12, v11, 10, v12
    v_bfe_u32 v13, v1, 4, 1
    v_lshl_add_u32 v12, v13, 8, v12
    v_add_u32 v10, 131072, v12
    s_lshl_b32 s22, s6, 2
    v_lshl_add_u32 v13, v13, 1, s22
    v_and_b32 v14, 7, v13
    v_xor_b32 v14, v14, v11
    v_lshlrev_b32 v14, 4, v14
    v_lshl_add_u32 v14, v13, 10, v14
    v_lshrrev_b32 v13, 5, v1
    v_lshl_add_u32 v14, v13, 8, v14
    v_add_u32 v11, 131072, v14
    v_xor_b32 v12, 16, v11
    v_add_u32 v12, 1024, v12
    v_and_b32 v13, 15, v1
    v_lshlrev_b32 v13, 6, v13
    v_lshrrev_b32 v14, 5, v1
    v_lshl_add_u32 v13, v14, 5, v13
    v_bfe_u32 v14, v1, 4, 1
    v_lshl_add_u32 v13, v14, 4, v13
    s_lshl_b32 s22, s41, 15
    s_lshl_b32 s51, s42, 13
    s_add_u32 s22, s22, s51
    s_lshl_b32 s51, s6, 11
    s_add_u32 s22, s22, s51
    s_add_u32 s56, s22, 3276800
    s_add_u32 s57, s22, 5373952
    s_lshl_b32 s22, s41, 2
    s_add_u32 s22, s22, s42
    s_mul_i32 s22, s22, 128
    s_add_u32 s58, s22, 32768
    s_mul_i32 s59, s43, 66048
    s_lshl_b32 s22, s6, 8
    s_add_u32 s59, s59, s22
    s_add_u32 s59, s59, 1048576
    s_lshl_b32 s60, s42, 19
    s_lshl_b32 s22, s41, 10
    s_add_u32 s60, s60, s22
    s_or_b32 s61, s41, s42
    s_cmp_eq_u32 s73, 2
    s_cbranch_scc1 L_noflag_10
    s_waitcnt lgkmcnt(0)
    s_mul_i32 s40, s40, 0x9E3779B1
    s_add_u32 s40, s40, 0x7F4A7C15
    v_mov_b32 v3, s40
    v_mov_b32 v24, 0
    s_waitcnt vmcnt(0)
    buffer_store_dword v3, v24, s[28:31], s50 offen sc1
    s_cmp_eq_u32 s46, 0
    s_cbranch_scc1 L_noflag_10
    s_add_u32 m0, s21, 0
    s_nop 0
    buffer_load_dwordx4 v176, s[76:79], s20 offen lds
    s_add_u32 m0, m0, 1024
    s_add_u32 s20, s20, 22016
    buffer_load_dwordx4 v176, s[76:79], s20 offen lds
    s_add_u32 m0, m0, 1024
    s_add_u32 s20, s20, 22016
    buffer_load_dwordx4 v176, s[76:79], s20 offen lds
    s_add_u32 m0, m0, 1024
    s_add_u32 s20, s20, 22016
    buffer_load_dwordx4 v176, s[76:79], s20 offen lds
    s_add_u32 m0, m0, 1024
    s_add_u32 s20, s20, 22016
    buffer_load_dwordx4 v176, s[76:79], s20 offen lds
    s_add_u32 m0, m0, 1024
    s_add_u32 s20, s20, 22016
    buffer_load_dwordx4 v176, s[76:79], s20 offen lds
    s_add_u32 m0, m0, 1024
    s_add_u32 s20, s20, 22016
    buffer_load_dwordx4 v176, s[76:79], s20 offen lds
    s_add_u32 m0, m0, 1024
    s_add_u32 s20, s20, 22016
    buffer_load_dwordx4 v176, s[76:79], s20 offen lds
    s_add_u32 m0, m0, 1024
    s_add_u32 s20, s20, 22016
    buffer_load_dwordx4 v176, s[76:79], s20 offen lds
    s_add_u32 m0, m0, 1024
    s_add_u32 s20, s20, 22016
    buffer_load_dwordx4 v176, s[76:79], s20 offen lds
    s_add_u32 m0, m0, 1024
    s_add_u32 s20, s20, 22016
    buffer_load_dwordx4 v176, s[76:79], s20 offen lds
    s_add_u32 m0, m0, 1024
    s_add_u32 s20, s20, 22016
    buffer_load_dwordx4 v176, s[76:79], s20 offen lds
    s_add_u32 m0, m0, 1024
    s_add_u32 s20, s20, 22016
    buffer_load_dwordx4 v176, s[76:79], s20 offen lds
    s_add_u32 m0, m0, 1024
    s_add_u32 s20, s20, 22016
    buffer_load_dwordx4 v176, s[76:79], s20 offen lds
    s_add_u32 m0, m0, 1024
    s_add_u32 s20, s20, 22016
    buffer_load_dwordx4 v176, s[76:79], s20 offen lds
    s_add_u32 m0, m0, 1024
    s_add_u32 s20, s20, 22016
    buffer_load_dwordx4 v176, s[76:79], s20 offen lds
L_noflag_10:
    s_getpc_b64 s[52:53]
L_pc_11:
    s_add_u32 s52, s52, L_table-L_pc_11
    s_addc_u32 s53, s53, 0
    v_lshlrev_b32 v4, 4, v1
    s_min_u32 s22, s6, 2
    s_lshl_b32 s22, s22, 12
    s_cmp_eq_u32 s6, 3
    s_cselect_b32 s22, 10240, s22
    s_add_u32 m0, s22, 147456
    v_add_u32 v25, s22, v4
    global_load_lds_dwordx4 v25, s[52:53] offset:0
    global_load_lds_dwordx4 v25, s[52:53] offset:1024
    global_load_lds_dwordx4 v25, s[52:53] offset:2048
    global_load_lds_dwordx4 v25, s[52:53] offset:3072
    buffer_load_dword v3, v2, s[28:31], 0 offen sc1
    s_mov_b32 s36, s18
    s_mov_b32 s37, s19
    s_mov_b32 s38, 0x200000
    s_mov_b32 s39, 0x00020000
    s_add_u32 s22, s48, 2
    s_cmp_ge_u32 s22, 3
    s_cselect_b32 s23, 3, 0
    s_sub_u32 s8, s22, s23
    s_add_u32 s22, s48, 1
    s_cmp_ge_u32 s22, 3
    s_cselect_b32 s23, 3, 0
    s_sub_u32 s9, s22, s23
    s_lshl_b32 s22, s6, 14
    s_lshl_b32 s23, s47, 11
    s_add_u32 s22, s22, s23
    s_add_u32 s10, s22, 13631488
    s_mul_i32 s22, s49, 6
    s_lshl_b32 s23, s48, 1
    s_add_u32 s11, s22, s23
    s_mul_i32 s22, s11, 86
    s_add_u32 s22, s22, s6
    s_lshl_b32 s22, s22, 10
    s_add_u32 s14, s22, 7471104
    s_mov_b32 s16, 0xbfb8aa3b
    s_mul_i32 s22, s58, 1
    s_lshl_b32 s23, s6, 2
    s_add_u32 s22, s22, s23
    s_add_u32 s17, s22, 229376
    s_lshl_b32 s22, s45, 2
    s_add_u32 s53, s22, s6
    s_cmp_lt_u32 s53, 86
    s_cselect_b32 s55, s46, 0
    s_lshl_b32 s53, s53, 10
    s_add_u32 s53, s53, 7471104
    s_mul_i32 s22, s44, 22
    s_add_u32 s22, s22, s45
    s_lshl_b32 s22, s22, 2
    s_add_u32 s22, s22, s6
    s_mul_i32 s22, s22, 128
    s_add_u32 s69, s22, 65536
    s_cmp_lg_u32 s46, 0
    s_cselect_b32 s69, s69, 2146435072
    s_mul_i32 s22, s45, 171
    s_lshr_b32 s22, s22, 9
    s_mul_i32 s22, s22, 3
    s_sub_u32 s51, s45, s22
    s_mul_i32 s52, s44, 6
    s_add_u32 s22, s51, 0
    s_cmp_ge_u32 s22, 3
    s_cselect_b32 s23, 3, 0
    s_sub_u32 s22, s22, s23
    s_lshl_b32 s22, s22, 1
    s_add_u32 s54, s22, s52
    s_mul_i32 s23, s54, 88064
    s_add_u32 s62, s23, s53
    s_cmp_lg_u32 s55, 0
    s_cselect_b32 s62, s62, 2146435072
    s_cmp_lt_u32 s54, 64
    s_cselect_b32 s62, s62, 2146435072
    s_add_u32 s54, s54, 1
    s_mul_i32 s23, s54, 88064
    s_add_u32 s63, s23, s53
    s_cmp_lg_u32 s55, 0
    s_cselect_b32 s63, s63, 2146435072
    s_cmp_lt_u32 s54, 64
    s_cselect_b32 s63, s63, 2146435072
    s_add_u32 s22, s51, 1
    s_cmp_ge_u32 s22, 3
    s_cselect_b32 s23, 3, 0
    s_sub_u32 s22, s22, s23
    s_lshl_b32 s22, s22, 1
    s_add_u32 s54, s22, s52
    s_mul_i32 s23, s54, 88064
    s_add_u32 s64, s23, s53
    s_cmp_lg_u32 s55, 0
    s_cselect_b32 s64, s64, 2146435072
    s_cmp_lt_u32 s54, 64
    s_cselect_b32 s64, s64, 2146435072
    s_add_u32 s54, s54, 1
    s_mul_i32 s23, s54, 88064
    s_add_u32 s65, s23, s53
    s_cmp_lg_u32 s55, 0
    s_cselect_b32 s65, s65, 2146435072
    s_cmp_lt_u32 s54, 64
    s_cselect_b32 s65, s65, 2146435072
    s_add_u32 s22, s51, 2
    s_cmp_ge_u32 s22, 3
    s_cselect_b32 s23, 3, 0
    s_sub_u32 s22, s22, s23
    s_lshl_b32 s22, s22, 1
    s_add_u32 s54, s22, s52
    s_mul_i32 s23, s54, 88064
    s_add_u32 s66, s23, s53
    s_cmp_lg_u32 s55, 0
    s_cselect_b32 s66, s66, 2146435072
    s_cmp_lt_u32 s54, 64
    s_cselect_b32 s66, s66, 2146435072
    s_add_u32 s54, s54, 1
    s_mul_i32 s23, s54, 88064
    s_add_u32 s67, s23, s53
    s_cmp_lg_u32 s55, 0
    s_cselect_b32 s67, s67, 2146435072
    s_cmp_lt_u32 s54, 64
    s_cselect_b32 s67, s67, 2146435072
    s_waitcnt vmcnt(0)
    v_cmp_ne_u32 vcc, s40, v3
    s_nop 0
    s_cbranch_vccnz L_slow_p1_12
L_ok_p1_13:
    s_lshl_b32 s52, s6, 14
    s_add_u32 m0, s52, 65536
    s_nop 0
    buffer_load_dwordx4 v5, s[28:31], s59 offen sc1 lds
    s_add_u32 m0, m0, 1024
    s_add_u32 s59, s59, 4096
    buffer_load_dwordx4 v5, s[28:31], s59 offen sc1 lds
    s_add_u32 m0, m0, 1024
    s_add_u32 s59, s59, 4096
    buffer_load_dwordx4 v6, s[28:31], s59 offen sc1 lds
    s_add_u32 m0, m0, 1024
    s_add_u32 s59, s59, 4096
    buffer_load_dwordx4 v6, s[28:31], s59 offen sc1 lds
    s_add_u32 m0, m0, 1024
    s_add_u32 s59, s59, 4096
    buffer_load_dwordx4 v5, s[28:31], s59 offen sc1 lds
    s_add_u32 m0, m0, 1024
    s_add_u32 s59, s59, 4096
    buffer_load_dwordx4 v5, s[28:31], s59 offen sc1 lds
    s_add_u32 m0, m0, 1024
    s_add_u32 s59, s59, 4096
    buffer_load_dwordx4 v6, s[28:31], s59 offen sc1 lds
    s_add_u32 m0, m0, 1024
    s_add_u32 s59, s59, 4096
    buffer_load_dwordx4 v6, s[28:31], s59 offen sc1 lds
    s_add_u32 m0, m0, 1024
    s_add_u32 s59, s59, 4352
    buffer_load_dwordx4 v5, s[28:31], s59 offen sc1 lds
    s_add_u32 m0, m0, 1024
    s_add_u32 s59, s59, 4096
    buffer_load_dwordx4 v5, s[28:31], s59 offen sc1 lds
    s_add_u32 m0, m0, 1024
    s_add_u32 s59, s59, 4096
    buffer_load_dwordx4 v6, s[28:31], s59 offen sc1 lds
    s_add_u32 m0, m0, 1024
    s_add_u32 s59, s59, 4096
    buffer_load_dwordx4 v6, s[28:31], s59 offen sc1 lds
    s_add_u32 m0, m0, 1024
    s_add_u32 s59, s59, 4096
    buffer_load_dwordx4 v5, s[28:31], s59 offen sc1 lds
    s_add_u32 m0, m0, 1024
    s_add_u32 s59, s59, 4096
    buffer_load_dwordx4 v5, s[28:31], s59 offen sc1 lds
    s_add_u32 m0, m0, 1024
    s_add_u32 s59, s59, 4096
    buffer_load_dwordx4 v6, s[28:31], s59 offen sc1 lds
    s_add_u32 m0, m0, 1024
    s_add_u32 s59, s59, 4096
    buffer_load_dwordx4 v6, s[28:31], s59 offen sc1 lds
    buffer_load_dword v3, v15, s[28:31], 0 offen sc1
    buffer_load_dwordx4 v[24:27], v7, s[24:27], s60 offen offset:0
    buffer_load_dwordx4 v[28:31], v7, s[24:27], s60 offen offset:16
    s_barrier
    s_cmp_eq_u32 s46, 0
    s_cbranch_scc1 L_nob1r_14
    ds_read_b64_tr_b16 a[0:1], v177 offset:0
    ds_read_b64_tr_b16 a[2:3], v177 offset:512
    ds_read_b64_tr_b16 a[4:5], v177 offset:2048
    ds_read_b64_tr_b16 a[6:7], v177 offset:2560
    ds_read_b64_tr_b16 a[8:9], v177 offset:4096
    ds_read_b64_tr_b16 a[10:11], v177 offset:4608
    ds_read_b64_tr_b16 a[12:13], v177 offset:6144
    ds_read_b64_tr_b16 a[14:15], v177 offset:6656
    ds_read_b64_tr_b16 a[16:17], v177 offset:8192
    ds_read_b64_tr_b16 a[18:19], v177 offset:8704
    ds_read_b64_tr_b16 a[20:21], v177 offset:10240
    ds_read_b64_tr_b16 a[22:23], v177 offset:10752
    ds_read_b64_tr_b16 a[24:25], v177 offset:12288
    ds_read_b64_tr_b16 a[26:27], v177 offset:12800
    ds_read_b64_tr_b16 a[28:29], v177 offset:14336
    s_waitcnt lgkmcnt(11)
    ds_read_b64_tr_b16 a[30:31], v177 offset:14848
    ds_read_b64_tr_b16 a[32:33], v177 offset:16384
    ds_read_b64_tr_b16 a[34:35], v177 offset:16896
    ds_read_b64_tr_b16 a[36:37], v177 offset:18432
    s_waitcnt lgkmcnt(11)
    ds_read_b64_tr_b16 a[38:39], v177 offset:18944
    ds_read_b64_tr_b16 a[40:41], v177 offset:20480
    ds_read_b64_tr_b16 a[42:43], v177 offset:20992
    ds_read_b64_tr_b16 a[44:45], v177 offset:22528
    s_waitcnt lgkmcnt(11)
    ds_read_b64_tr_b16 a[46:47], v177 offset:23040
    ds_read_b64_tr_b16 a[48:49], v177 offset:24576
    ds_read_b64_tr_b16 a[50:51], v177 offset:25088
    ds_read_b64_tr_b16 a[52:53], v177 offset:26624
    s_waitcnt lgkmcnt(11)
    ds_read_b64_tr_b16 a[54:55], v177 offset:27136
    ds_read_b64_tr_b16 a[56:57], v177 offset:28672
    ds_read_b64_tr_b16 a[58:59], v177 offset:29184
    ds_read_b64_tr_b16 a[60:61], v177 offset:30720
    s_waitcnt lgkmcnt(11)
    ds_read_b64_tr_b16 a[62:63], v177 offset:31232
    s_waitcnt lgkmcnt(0)
L_nob1r_14:
    v_add_u32 v64, 147456, v4
    ds_read_b128 v[200:203], v64 offset:0
    ds_read_b128 v[204:207], v64 offset:1024
    ds_read_b128 v[208:211], v64 offset:2048
    ds_read_b128 v[212:215], v64 offset:3072
    ds_read_b128 v[216:219], v64 offset:4096
    ds_read_b128 v[220:223], v64 offset:5120
    ds_read_b128 v[224:227], v64 offset:6144
    ds_read_b128 v[228:231], v64 offset:7168
    ds_read_b128 v[232:235], v64 offset:8192
    ds_read_b128 v[236:239], v64 offset:9216
    ds_read_b128 v[240:243], v64 offset:10240
    ds_read_b128 v[244:247], v64 offset:11264
    ds_read_b128 v[248:251], v64 offset:12288
    ds_read_b128 v[252:255], v64 offset:13312
    s_waitcnt lgkmcnt(0)
    s_barrier
    v_accvgpr_read_b32 v14, a124
    s_mul_i32 s52, s6, 3072
    s_add_u32 s51, s52, 147456
    s_add_u32 s52, s52, 327680
    s_waitcnt vmcnt(2)
    v_cmp_ne_u32 vcc, s40, v3
    s_nop 0
    s_cbranch_vccnz L_slow_pm_15
L_ok_pm_16:
    s_mov_b32 m0, s51
    s_nop 0
    buffer_load_dwordx4 v4, s[28:31], s52 offen offset:0 sc1 lds
    buffer_load_dwordx4 v4, s[28:31], s52 offen offset:1024 sc1 lds
    buffer_load_dwordx4 v4, s[28:31], s52 offen offset:2048 sc1 lds
    ds_read_b64_tr_b16 v[64:65], v16 offset:0
    ds_read_b64_tr_b16 v[66:67], v16 offset:1024
    ds_read_b64_tr_b16 v[68:69], v16 offset:8192
    ds_read_b64_tr_b16 v[70:71], v16 offset:9216
    ds_read_b64_tr_b16 v[72:73], v17 offset:0
    ds_read_b64_tr_b16 v[74:75], v17 offset:1024
    ds_read_b64_tr_b16 v[76:77], v17 offset:8192
    ds_read_b64_tr_b16 v[78:79], v17 offset:9216
    ds_read_b64_tr_b16 v[80:81], v18 offset:0
    ds_read_b64_tr_b16 v[82:83], v18 offset:1024
    ds_read_b64_tr_b16 v[84:85], v18 offset:8192
    ds_read_b64_tr_b16 v[86:87], v18 offset:9216
    s_waitcnt lgkmcnt(8)
    v_mfma_f32_16x16x32_bf16 v[128:131], v[64:67], v[192:195], 0
    v_mfma_f32_16x16x32_bf16 v[128:131], v[68:71], v[196:199], v[128:131]
    ds_read_b64_tr_b16 v[88:89], v19 offset:0
    ds_read_b64_tr_b16 v[90:91], v19 offset:1024
    ds_read_b64_tr_b16 v[92:93], v19 offset:8192
    ds_read_b64_tr_b16 v[94:95], v19 offset:9216
    s_add_u32 m0, s21, 0
    s_add_u32 s20, s20, 374272
    buffer_load_dwordx4 v14, s[76:79], s20 offen lds
    buffer_store_dwordx4 a[120:123], v4, s[28:31], s62 offen sc1
    s_waitcnt lgkmcnt(8)
    v_mfma_f32_16x16x32_bf16 v[132:135], v[72:75], v[192:195], 0
    v_mfma_f32_16x16x32_bf16 v[132:135], v[76:79], v[196:199], v[132:135]
    ds_read_b64_tr_b16 v[64:65], v20 offset:0
    ds_read_b64_tr_b16 v[66:67], v20 offset:1024
    ds_read_b64_tr_b16 v[68:69], v20 offset:8192
    ds_read_b64_tr_b16 v[70:71], v20 offset:9216
    s_add_u32 m0, m0, 1024
    s_add_u32 s20, s20, 22016
    buffer_load_dwordx4 v14, s[76:79], s20 offen lds
    s_waitcnt lgkmcnt(8)
    v_mfma_f32_16x16x32_bf16 v[136:139], v[80:83], v[192:195], 0
    v_mfma_f32_16x16x32_bf16 v[136:139], v[84:87], v[196:199], v[136:139]
    ds_read_b64_tr_b16 v[72:73], v21 offset:0
    ds_read_b64_tr_b16 v[74:75], v21 offset:1024
    ds_read_b64_tr_b16 v[76:77], v21 offset:8192
    ds_read_b64_tr_b16 v[78:79], v21 offset:9216
    s_add_u32 m0, m0, 1024
    s_add_u32 s20, s20, 22016
    buffer_load_dwordx4 v14, s[76:79], s20 offen lds
    s_waitcnt lgkmcnt(8)
    v_mfma_f32_16x16x32_bf16 v[140:143], v[88:91], v[192:195], 0
    v_mfma_f32_16x16x32_bf16 v[140:143], v[92:95], v[196:199], v[140:143]
    ds_read_b64_tr_b16 v[80:81], v22 offset:0
    ds_read_b64_tr_b16 v[82:83], v22 offset:1024
    ds_read_b64_tr_b16 v[84:85], v22 offset:8192
    ds_read_b64_tr_b16 v[86:87], v22 offset:9216
    s_add_u32 m0, m0, 1024
    s_add_u32 s20, s20, 22016
    buffer_load_dwordx4 v14, s[76:79], s20 offen lds
    s_waitcnt lgkmcnt(8)
    v_mfma_f32_16x16x32_bf16 v[144:147], v[64:67], v[192:195], 0
    v_mfma_f32_16x16x32_bf16 v[144:147], v[68:71], v[196:199], v[144:147]
    ds_read_b64_tr_b16 v[88:89], v23 offset:0
    ds_read_b64_tr_b16 v[90:91], v23 offset:1024
    ds_read_b64_tr_b16 v[92:93], v23 offset:8192
    ds_read_b64_tr_b16 v[94:95], v23 offset:9216
    s_add_u32 m0, m0, 1024
    s_add_u32 s20, s20, 22016
    buffer_load_dwordx4 v14, s[76:79], s20 offen lds
    buffer_store_dwordx4 a[120:123], v4, s[28:31], s63 offen sc1
    s_waitcnt lgkmcnt(8)
    v_mfma_f32_16x16x32_bf16 v[148:151], v[72:75], v[192:195], 0
    v_mfma_f32_16x16x32_bf16 v[148:151], v[76:79], v[196:199], v[148:151]
    s_add_u32 m0, m0, 1024
    s_add_u32 s20, s20, 22016
    buffer_load_dwordx4 v14, s[76:79], s20 offen lds
    s_waitcnt lgkmcnt(4)
    v_mfma_f32_16x16x32_bf16 v[152:155], v[80:83], v[192:195], 0
    v_mfma_f32_16x16x32_bf16 v[152:155], v[84:87], v[196:199], v[152:155]
    s_add_u32 m0, m0, 1024
    s_add_u32 s20, s20, 22016
    buffer_load_dwordx4 v14, s[76:79], s20 offen lds
    s_waitcnt lgkmcnt(0)
    v_mfma_f32_16x16x32_bf16 v[156:159], v[88:91], v[192:195], 0
    v_mfma_f32_16x16x32_bf16 v[156:159], v[92:95], v[196:199], v[156:159]
    s_add_u32 m0, m0, 1024
    s_add_u32 s20, s20, 22016
    buffer_load_dwordx4 v14, s[76:79], s20 offen lds
    s_waitcnt vmcnt(10)
    s_barrier
    ds_read_b128 v[160:163], v9 offset:2048
    ds_read_b128 v[164:167], v9 offset:2064
    ds_read_b128 v[168:171], v9 offset:2080
    ds_read_b128 v[172:175], v9 offset:2096
    ds_read_b128 v[176:179], v9 offset:2112
    ds_read_b128 v[180:183], v9 offset:2128
    ds_read_b128 v[184:187], v9 offset:2144
    ds_read_b128 v[188:191], v9 offset:2160
    buffer_store_dwordx4 a[120:123], v4, s[28:31], s64 offen sc1
    s_cmp_eq_u32 s61, 0
    s_cbranch_scc0 L_nosa_17
    s_waitcnt lgkmcnt(0)
    ds_read_b128 v[96:99], v9 offset:0
    ds_read_b128 v[100:103], v9 offset:16
    ds_read_b128 v[104:107], v9 offset:32
    ds_read_b128 v[108:111], v9 offset:48
    ds_read_b128 v[112:115], v9 offset:64
    ds_read_b128 v[116:119], v9 offset:80
    ds_read_b128 v[120:123], v9 offset:96
    ds_read_b128 v[124:127], v9 offset:112
    s_waitcnt lgkmcnt(0)
L_nosa_17:
    s_waitcnt lgkmcnt(6)
    v_pk_mul_f32 v[128:129], v[128:129], v[160:161]
    v_pk_mul_f32 v[130:131], v[130:131], v[162:163]
    v_pk_mul_f32 v[132:133], v[132:133], v[164:165]
    v_pk_mul_f32 v[134:135], v[134:135], v[166:167]
    s_waitcnt lgkmcnt(4)
    v_pk_mul_f32 v[136:137], v[136:137], v[168:169]
    v_pk_mul_f32 v[138:139], v[138:139], v[170:171]
    v_pk_mul_f32 v[140:141], v[140:141], v[172:173]
    v_pk_mul_f32 v[142:143], v[142:143], v[174:175]
    s_waitcnt lgkmcnt(2)
    v_pk_mul_f32 v[144:145], v[144:145], v[176:177]
    v_pk_mul_f32 v[146:147], v[146:147], v[178:179]
    v_pk_mul_f32 v[148:149], v[148:149], v[180:181]
    v_pk_mul_f32 v[150:151], v[150:151], v[182:183]
    s_waitcnt lgkmcnt(0)
    v_pk_mul_f32 v[152:153], v[152:153], v[184:185]
    v_pk_mul_f32 v[154:155], v[154:155], v[186:187]
    v_pk_mul_f32 v[156:157], v[156:157], v[188:189]
    v_pk_mul_f32 v[158:159], v[158:159], v[190:191]
    s_cmp_eq_u32 s61, 0
    s_cbranch_scc0 L_nosa2_18
    s_mov_b32 exec_lo, 0x10001
    s_mov_b32 exec_hi, 0x10001
    v_pk_add_f32 v[128:129], v[128:129], v[96:97]
    v_pk_add_f32 v[130:131], v[130:131], v[98:99]
    v_pk_add_f32 v[132:133], v[132:133], v[100:101]
    v_pk_add_f32 v[134:135], v[134:135], v[102:103]
    v_pk_add_f32 v[136:137], v[136:137], v[104:105]
    v_pk_add_f32 v[138:139], v[138:139], v[106:107]
    v_pk_add_f32 v[140:141], v[140:141], v[108:109]
    v_pk_add_f32 v[142:143], v[142:143], v[110:111]
    v_pk_add_f32 v[144:145], v[144:145], v[112:113]
    v_pk_add_f32 v[146:147], v[146:147], v[114:115]
    v_pk_add_f32 v[148:149], v[148:149], v[116:117]
    v_pk_add_f32 v[150:151], v[150:151], v[118:119]
    v_pk_add_f32 v[152:153], v[152:153], v[120:121]
    v_pk_add_f32 v[154:155], v[154:155], v[122:123]
    v_pk_add_f32 v[156:157], v[156:157], v[124:125]
    v_pk_add_f32 v[158:159], v[158:159], v[126:127]
    s_mov_b64 exec, -1
L_nosa2_18:
    v_cvt_pk_bf16_f32 v64, v128, v132
    v_cvt_pk_bf16_f32 v65, v136, v140
    v_cvt_pk_bf16_f32 v66, v144, v148
    v_cvt_pk_bf16_f32 v67, v152, v156
    ds_write_b128 v10, v[64:67] offset:0
    v_cvt_pk_bf16_f32 v68, v129, v133
    v_cvt_pk_bf16_f32 v69, v137, v141
    v_cvt_pk_bf16_f32 v70, v145, v149
    v_cvt_pk_bf16_f32 v71, v153, v157
    ds_write_b128 v10, v[68:71] offset:512
    v_cvt_pk_bf16_f32 v72, v130, v134
    v_cvt_pk_bf16_f32 v73, v138, v142
    v_cvt_pk_bf16_f32 v74, v146, v150
    v_cvt_pk_bf16_f32 v75, v154, v158
    ds_write_b128 v10, v[72:75] offset:128
    v_cvt_pk_bf16_f32 v76, v131, v135
    v_cvt_pk_bf16_f32 v77, v139, v143
    v_cvt_pk_bf16_f32 v78, v147, v151
    v_cvt_pk_bf16_f32 v79, v155, v159
    ds_write_b128 v10, v[76:79] offset:640
    ds_read_b128 v[32:35], v8 offset:4096
    ds_read_b128 v[36:39], v8 offset:4608
    ds_read_b128 v[40:43], v8 offset:5120
    ds_read_b128 v[44:47], v8 offset:5632
    ds_read_b128 v[48:51], v8 offset:8192
    ds_read_b128 v[52:55], v8 offset:8704
    ds_read_b128 v[56:59], v8 offset:9216
    ds_read_b128 v[60:63], v8 offset:9728
    buffer_store_dwordx4 a[120:123], v4, s[28:31], s65 offen sc1
    s_waitcnt lgkmcnt(8)
    s_barrier
    ds_read_b128 v[64:67], v11 offset:0
    ds_read_b128 v[72:75], v12 offset:0
    ds_read_b128 v[68:71], v11 offset:512
    ds_read_b128 v[76:79], v12 offset:512
    s_waitcnt lgkmcnt(2)
    v_mfma_f32_32x32x16_bf16 v[80:95], v[64:67], v[200:203], 0
    s_add_u32 m0, m0, 1024
    s_add_u32 s20, s20, 22016
    buffer_load_dwordx4 v14, s[76:79], s20 offen lds
    v_mfma_f32_32x32x16_bf16 v[96:111], v[72:75], v[200:203], 0
    s_add_u32 m0, m0, 1024
    s_add_u32 s20, s20, 22016
    buffer_load_dwordx4 v14, s[76:79], s20 offen lds
    s_waitcnt lgkmcnt(0)
    ds_read_b128 v[160:163], v8 offset:6144
    ds_read_b128 v[164:167], v8 offset:6656
    ds_read_b128 v[168:171], v8 offset:7168
    ds_read_b128 v[172:175], v8 offset:7680
    v_mfma_f32_32x32x16_bf16 v[80:95], v[72:75], v[208:211], v[80:95]
    s_add_u32 m0, m0, 1024
    s_add_u32 s20, s20, 22016
    buffer_load_dwordx4 v14, s[76:79], s20 offen lds
    buffer_store_dwordx4 a[120:123], v4, s[28:31], s66 offen sc1
    v_mfma_f32_32x32x16_bf16 v[96:111], v[64:67], v[216:219], v[96:111]
    s_add_u32 m0, m0, 1024
    s_add_u32 s20, s20, 22016
    buffer_load_dwordx4 v14, s[76:79], s20 offen lds
    v_mfma_f32_32x32x16_bf16 v[80:95], v[68:71], v[204:207], v[80:95]
    s_add_u32 m0, m0, 1024
    s_add_u32 s20, s20, 22016
    buffer_load_dwordx4 v14, s[76:79], s20 offen lds
    v_mfma_f32_32x32x16_bf16 v[96:111], v[76:79], v[204:207], v[96:111]
    s_add_u32 m0, m0, 1024
    s_add_u32 s20, s20, 22016
    buffer_load_dwordx4 v14, s[76:79], s20 offen lds
    v_mfma_f32_32x32x16_bf16 v[80:95], v[76:79], v[212:215], v[80:95]
    s_add_u32 m0, m0, 1024
    s_add_u32 s20, s20, 22016
    buffer_load_dwordx4 v14, s[76:79], s20 offen lds
    v_mfma_f32_32x32x16_bf16 v[96:111], v[68:71], v[220:223], v[96:111]
    s_add_u32 m0, m0, 1024
    s_add_u32 s20, s20, 22016
    buffer_load_dwordx4 v14, s[76:79], s20 offen lds
    buffer_store_dwordx4 a[120:123], v4, s[28:31], s67 offen sc1
    v_lshlrev_b32 v176, 16, v24
    v_and_b32 v177, 0xffff0000, v24
    v_lshlrev_b32 v178, 16, v25
    v_and_b32 v179, 0xffff0000, v25
    v_lshlrev_b32 v180, 16, v26
    v_and_b32 v181, 0xffff0000, v26
    v_lshlrev_b32 v182, 16, v27
    v_and_b32 v183, 0xffff0000, v27
    v_lshlrev_b32 v184, 16, v28
    v_and_b32 v185, 0xffff0000, v28
    v_lshlrev_b32 v186, 16, v29
    v_and_b32 v187, 0xffff0000, v29
    v_lshlrev_b32 v188, 16, v30
    v_and_b32 v189, 0xffff0000, v30
    v_lshlrev_b32 v190, 16, v31
    v_and_b32 v191, 0xffff0000, v31
    v_pk_mul_f32 v[112:113], v[80:81], v[224:225]
    v_pk_mul_f32 v[128:129], v[96:97], v[224:225]
    v_pk_fma_f32 v[112:113], v[96:97], v[232:233], v[112:113]
    v_pk_fma_f32 v[128:129], v[80:81], v[232:233], v[128:129] neg_lo:[1,0,0] neg_hi:[1,0,0]
    v_pk_mul_f32 v[114:115], v[82:83], v[226:227]
    v_pk_mul_f32 v[130:131], v[98:99], v[226:227]
    v_pk_fma_f32 v[114:115], v[98:99], v[234:235], v[114:115]
    v_pk_fma_f32 v[130:131], v[82:83], v[234:235], v[130:131] neg_lo:[1,0,0] neg_hi:[1,0,0]
    v_pk_mul_f32 v[116:117], v[84:85], v[228:229]
    v_pk_mul_f32 v[132:133], v[100:101], v[228:229]
    v_pk_fma_f32 v[116:117], v[100:101], v[236:237], v[116:117]
    v_pk_fma_f32 v[132:133], v[84:85], v[236:237], v[132:133] neg_lo:[1,0,0] neg_hi:[1,0,0]
    v_pk_mul_f32 v[118:119], v[86:87], v[230:231]
    v_pk_mul_f32 v[134:135], v[102:103], v[230:231]
    v_pk_fma_f32 v[118:119], v[102:103], v[238:239], v[118:119]
    v_pk_fma_f32 v[134:135], v[86:87], v[238:239], v[134:135] neg_lo:[1,0,0] neg_hi:[1,0,0]
    v_cvt_pk_bf16_f32 v144, v112, v113
    v_cvt_pk_bf16_f32 v145, v114, v115
    v_cvt_pk_bf16_f32 v146, v116, v117
    v_cvt_pk_bf16_f32 v147, v118, v119
    v_cvt_pk_bf16_f32 v148, v128, v129
    v_cvt_pk_bf16_f32 v149, v130, v131
    v_cvt_pk_bf16_f32 v150, v132, v133
    v_cvt_pk_bf16_f32 v151, v134, v135
    v_mfma_f32_32x32x16_bf16 v[64:79], v[144:147], v[240:243], 0
    s_nop 0
    v_mfma_f32_32x32x16_bf16 v[64:79], v[148:151], v[244:247], v[64:79]
    v_pk_mul_f32 v[120:121], v[88:89], v[224:225]
    v_pk_mul_f32 v[136:137], v[104:105], v[224:225]
    v_pk_fma_f32 v[120:121], v[104:105], v[232:233], v[120:121]
    v_pk_fma_f32 v[136:137], v[88:89], v[232:233], v[136:137] neg_lo:[1,0,0] neg_hi:[1,0,0]
    v_pk_mul_f32 v[122:123], v[90:91], v[226:227]
    v_pk_mul_f32 v[138:139], v[106:107], v[226:227]
    v_pk_fma_f32 v[122:123], v[106:107], v[234:235], v[122:123]
    v_pk_fma_f32 v[138:139], v[90:91], v[234:235], v[138:139] neg_lo:[1,0,0] neg_hi:[1,0,0]
    v_pk_mul_f32 v[124:125], v[92:93], v[228:229]
    v_pk_mul_f32 v[140:141], v[108:109], v[228:229]
    v_pk_fma_f32 v[124:125], v[108:109], v[236:237], v[124:125]
    v_pk_fma_f32 v[140:141], v[92:93], v[236:237], v[140:141] neg_lo:[1,0,0] neg_hi:[1,0,0]
    v_pk_mul_f32 v[126:127], v[94:95], v[230:231]
    v_pk_mul_f32 v[142:143], v[110:111], v[230:231]
    v_pk_fma_f32 v[126:127], v[110:111], v[238:239], v[126:127]
    v_pk_fma_f32 v[142:143], v[94:95], v[238:239], v[142:143] neg_lo:[1,0,0] neg_hi:[1,0,0]
    v_cvt_pk_bf16_f32 v152, v120, v121
    v_cvt_pk_bf16_f32 v153, v122, v123
    v_cvt_pk_bf16_f32 v154, v124, v125
    v_cvt_pk_bf16_f32 v155, v126, v127
    v_cvt_pk_bf16_f32 v156, v136, v137
    v_cvt_pk_bf16_f32 v157, v138, v139
    v_cvt_pk_bf16_f32 v158, v140, v141
    v_cvt_pk_bf16_f32 v159, v142, v143
    v_mfma_f32_32x32x16_bf16 v[64:79], v[152:155], v[248:251], v[64:79]
    s_nop 0
    v_mfma_f32_32x32x16_bf16 v[64:79], v[156:159], v[252:255], v[64:79]
    s_nop 11
    v_pk_fma_f32 v[176:177], v[64:65], v[32:33], v[176:177]
    v_pk_fma_f32 v[178:179], v[66:67], v[34:35], v[178:179]
    v_pk_fma_f32 v[180:181], v[68:69], v[36:37], v[180:181]
    v_pk_fma_f32 v[182:183], v[70:71], v[38:39], v[182:183]
    v_pk_fma_f32 v[184:185], v[72:73], v[40:41], v[184:185]
    v_pk_fma_f32 v[186:187], v[74:75], v[42:43], v[186:187]
    v_pk_fma_f32 v[188:189], v[76:77], v[44:45], v[188:189]
    v_pk_fma_f32 v[190:191], v[78:79], v[46:47], v[190:191]
    v_pk_add_f32 v[96:97], v[176:177], v[178:179]
    v_pk_mul_f32 v[98:99], v[176:177], v[176:177]
    v_pk_fma_f32 v[98:99], v[178:179], v[178:179], v[98:99]
    v_pk_add_f32 v[96:97], v[96:97], v[180:181]
    v_pk_fma_f32 v[98:99], v[180:181], v[180:181], v[98:99]
    v_pk_add_f32 v[96:97], v[96:97], v[182:183]
    v_pk_fma_f32 v[98:99], v[182:183], v[182:183], v[98:99]
    v_pk_add_f32 v[96:97], v[96:97], v[184:185]
    v_pk_fma_f32 v[98:99], v[184:185], v[184:185], v[98:99]
    v_pk_add_f32 v[96:97], v[96:97], v[186:187]
    v_pk_fma_f32 v[98:99], v[186:187], v[186:187], v[98:99]
    v_pk_add_f32 v[96:97], v[96:97], v[188:189]
    v_pk_fma_f32 v[98:99], v[188:189], v[188:189], v[98:99]
    v_pk_add_f32 v[96:97], v[96:97], v[190:191]
    v_pk_fma_f32 v[98:99], v[190:191], v[190:191], v[98:99]
    v_add_f32 v96, v96, v97
    v_add_f32 v98, v98, v99
    v_cvt_pk_bf16_f32 v104, v176, v177
    v_add_f32_dpp v96, v96, v96 quad_perm:[1,0,3,2] row_mask:0xf bank_mask:0xf
    v_add_f32_dpp v98, v98, v98 quad_perm:[1,0,3,2] row_mask:0xf bank_mask:0xf
    v_cvt_pk_bf16_f32 v105, v178, v179
    v_add_f32_dpp v96, v96, v96 quad_perm:[2,3,0,1] row_mask:0xf bank_mask:0xf
    v_add_f32_dpp v98, v98, v98 quad_perm:[2,3,0,1] row_mask:0xf bank_mask:0xf
    v_cvt_pk_bf16_f32 v106, v180, v181
    v_add_f32_dpp v96, v96, v96 row_half_mirror row_mask:0xf bank_mask:0xf
    v_add_f32_dpp v98, v98, v98 row_half_mirror row_mask:0xf bank_mask:0xf
    v_cvt_pk_bf16_f32 v107, v182, v183
    v_add_f32_dpp v96, v96, v96 row_mirror row_mask:0xf bank_mask:0xf
    v_add_f32_dpp v98, v98, v98 row_mirror row_mask:0xf bank_mask:0xf
    v_cvt_pk_bf16_f32 v108, v184, v185
    v_mov_b32 v97, v96
    v_mov_b32 v99, v98
    v_cvt_pk_bf16_f32 v109, v186, v187
    v_permlane32_swap_b32 v96, v97
    v_permlane32_swap_b32 v98, v99
    v_add_f32 v96, v96, v97
    v_add_f32 v98, v98, v99
    v_mul_f32 v96, 0x3b000000, v96
    v_mul_f32 v98, 0x3b000000, v98
    v_fma_f32 v98, -v96, v96, v98
    v_max_f32 v98, 0, v98
    v_add_f32 v98, 0x3727c5ac, v98
    v_rsq_f32 v100, v98
    v_cvt_pk_bf16_f32 v110, v188, v189
    v_mul_f32 v102, -v96, v100
    v_cvt_pk_bf16_f32 v111, v190, v191
    v_pk_fma_f32 v[176:177], v[176:177], v[100:101], v[102:103] op_sel_hi:[1,0,0]
    v_pk_fma_f32 v[178:179], v[178:179], v[100:101], v[102:103] op_sel_hi:[1,0,0]
    v_pk_fma_f32 v[180:181], v[180:181], v[100:101], v[102:103] op_sel_hi:[1,0,0]
    v_pk_fma_f32 v[182:183], v[182:183], v[100:101], v[102:103] op_sel_hi:[1,0,0]
    v_pk_fma_f32 v[184:185], v[184:185], v[100:101], v[102:103] op_sel_hi:[1,0,0]
    v_pk_fma_f32 v[186:187], v[186:187], v[100:101], v[102:103] op_sel_hi:[1,0,0]
    v_pk_fma_f32 v[188:189], v[188:189], v[100:101], v[102:103] op_sel_hi:[1,0,0]
    v_pk_fma_f32 v[190:191], v[190:191], v[100:101], v[102:103] op_sel_hi:[1,0,0]
    s_waitcnt lgkmcnt(0)
    v_pk_fma_f32 v[176:177], v[176:177], v[48:49], v[160:161]
    v_pk_fma_f32 v[178:179], v[178:179], v[50:51], v[162:163]
    v_pk_fma_f32 v[180:181], v[180:181], v[52:53], v[164:165]
    v_pk_fma_f32 v[182:183], v[182:183], v[54:55], v[166:167]
    v_pk_fma_f32 v[184:185], v[184:185], v[56:57], v[168:169]
    v_pk_fma_f32 v[186:187], v[186:187], v[58:59], v[170:171]
    v_pk_fma_f32 v[188:189], v[188:189], v[60:61], v[172:173]
    v_pk_fma_f32 v[190:191], v[190:191], v[62:63], v[174:175]
    v_cvt_pk_bf16_f32 v112, v176, v177
    v_cvt_pk_bf16_f32 v113, v178, v179
    v_cvt_pk_bf16_f32 v114, v180, v181
    v_cvt_pk_bf16_f32 v115, v182, v183
    v_cvt_pk_bf16_f32 v116, v184, v185
    v_cvt_pk_bf16_f32 v117, v186, v187
    v_cvt_pk_bf16_f32 v118, v188, v189
    v_cvt_pk_bf16_f32 v119, v190, v191
    v_permlane16_swap_b32 v112, v116
    v_permlane16_swap_b32 v113, v117
    v_permlane16_swap_b32 v114, v118
    v_permlane16_swap_b32 v115, v119
    buffer_store_dwordx4 v[112:115], v13, s[28:31], s56 offen sc1
    buffer_store_dwordx4 v[116:119], v13, s[28:31], s56 offen offset:1024 sc1
    v_permlane16_swap_b32 v104, v108
    v_permlane16_swap_b32 v105, v109
    v_permlane16_swap_b32 v106, v110
    v_permlane16_swap_b32 v107, v111
    buffer_store_dwordx4 v[104:107], v13, s[28:31], s57 offen sc1
    buffer_store_dwordx4 v[108:111], v13, s[28:31], s57 offen offset:1024 sc1
    s_mov_b32 s50, s58
    v_accvgpr_read_b32 v177, a125
    s_lshl_b32 s53, s6, 13
    s_add_u32 s53, s53, 3276800
    s_mul_i32 s22, s45, 171
    s_lshr_b32 s22, s22, 9
    s_mul_i32 s22, s22, 3
    s_sub_u32 s51, s45, s22
    s_mul_i32 s52, s44, 6
    s_add_u32 s22, s51, 0
    s_cmp_ge_u32 s22, 3
    s_cselect_b32 s23, 3, 0
    s_sub_u32 s22, s22, s23
    s_lshl_b32 s22, s22, 1
    s_add_u32 s54, s22, s52
    s_min_u32 s56, s54, 63
    s_lshl_b32 s23, s56, 2
    s_add_u32 s23, s23, s6
    s_mul_i32 s23, s23, 128
    s_add_u32 s23, s23, 32768
    v_mov_b32 v2, s23
    s_lshl_b32 s56, s56, 15
    s_add_u32 s56, s56, s53
    s_add_u32 s54, s54, 1
    s_min_u32 s57, s54, 63
    s_lshl_b32 s23, s57, 2
    s_add_u32 s23, s23, s6
    s_mul_i32 s23, s23, 128
    s_add_u32 s23, s23, 32768
    v_writelane_b32 v2, s23, 1
    s_lshl_b32 s57, s57, 15
    s_add_u32 s57, s57, s53
    s_add_u32 s22, s51, 1
    s_cmp_ge_u32 s22, 3
    s_cselect_b32 s23, 3, 0
    s_sub_u32 s22, s22, s23
    s_lshl_b32 s22, s22, 1
    s_add_u32 s54, s22, s52
    s_min_u32 s58, s54, 63
    s_lshl_b32 s23, s58, 2
    s_add_u32 s23, s23, s6
    s_mul_i32 s23, s23, 128
    s_add_u32 s23, s23, 32768
    v_writelane_b32 v2, s23, 2
    s_lshl_b32 s58, s58, 15
    s_add_u32 s58, s58, s53
    s_add_u32 s54, s54, 1
    s_min_u32 s59, s54, 63
    s_lshl_b32 s23, s59, 2
    s_add_u32 s23, s23, s6
    s_mul_i32 s23, s23, 128
    s_add_u32 s23, s23, 32768
    v_writelane_b32 v2, s23, 3
    s_lshl_b32 s59, s59, 15
    s_add_u32 s59, s59, s53
    s_add_u32 s22, s51, 2
    s_cmp_ge_u32 s22, 3
    s_cselect_b32 s23, 3, 0
    s_sub_u32 s22, s22, s23
    s_lshl_b32 s22, s22, 1
    s_add_u32 s54, s22, s52
    s_min_u32 s60, s54, 63
    s_lshl_b32 s23, s60, 2
    s_add_u32 s23, s23, s6
    s_mul_i32 s23, s23, 128
    s_add_u32 s23, s23, 32768
    v_writelane_b32 v2, s23, 4
    s_lshl_b32 s60, s60, 15
    s_add_u32 s60, s60, s53
    s_add_u32 s54, s54, 1
    s_min_u32 s61, s54, 63
    s_lshl_b32 s23, s61, 2
    s_add_u32 s23, s23, s6
    s_mul_i32 s23, s23, 128
    s_add_u32 s23, s23, 32768
    v_writelane_b32 v2, s23, 5
    s_lshl_b32 s61, s61, 15
    s_add_u32 s61, s61, s53
    v_subrev_u32 v3, 8, v1
    v_lshl_add_u32 v3, v3, 2, s6
    v_min_u32 v3, 85, v3
    s_lshr_b32 s22, s47, 1
    v_lshl_add_u32 v3, v3, 2, s22
    v_mul_u32_u24 v3, 128, v3
    v_add_u32 v3, 458752, v3
    v_cmp_lt_u32 vcc, 7, v1
    s_nop 1
    v_cndmask_b32 v2, v2, v3, vcc
    s_and_b32 s22, s6, 1
    s_lshl_b32 s22, s22, 3
    v_xor_b32 v3, s22, v1
    v_xor_b32 v136, 0, v3
    v_lshlrev_b32 v136, 4, v136
    v_xor_b32 v137, 1, v3
    v_lshlrev_b32 v137, 4, v137
    v_xor_b32 v138, 2, v3
    v_lshlrev_b32 v138, 4, v138
    v_xor_b32 v139, 3, v3
    v_lshlrev_b32 v139, 4, v139
    v_xor_b32 v140, 4, v3
    v_lshlrev_b32 v140, 4, v140
    v_xor_b32 v141, 5, v3
    v_lshlrev_b32 v141, 4, v141
    v_xor_b32 v142, 6, v3
    v_lshlrev_b32 v142, 4, v142
    v_xor_b32 v143, 7, v3
    v_lshlrev_b32 v143, 4, v143
    v_and_b32 v3, 15, v1
    v_lshrrev_b32 v4, 5, v1
    v_xor_b32 v3, v3, v4
    v_lshlrev_b32 v3, 4, v3
    v_and_b32 v4, 31, v1
    v_lshl_add_u32 v3, v4, 10, v3
    v_add_u32 v3, 65536, v3
    v_xor_b32 v120, 0, v3
    v_add_u32 v128, 0x10000, v120
    v_xor_b32 v121, 32, v3
    v_add_u32 v129, 0x10000, v121
    v_xor_b32 v122, 64, v3
    v_add_u32 v130, 0x10000, v122
    v_xor_b32 v123, 96, v3
    v_add_u32 v131, 0x10000, v123
    v_xor_b32 v124, 128, v3
    v_add_u32 v132, 0x10000, v124
    v_xor_b32 v125, 160, v3
    v_add_u32 v133, 0x10000, v125
    v_xor_b32 v126, 192, v3
    v_add_u32 v134, 0x10000, v126
    v_xor_b32 v127, 224, v3
    v_add_u32 v135, 0x10000, v127
    v_lshlrev_b32 v10, 4, v1
    v_mov_b32 v11, s40
    v_mov_b32 v12, 0
    s_lshl_b32 s0, s6, 13
    s_waitcnt vmcnt(2)
    s_barrier
    s_cmp_lg_u32 s6, 0
    s_cbranch_scc1 L_nf_19
    v_mov_b32 v3, s40
    v_mov_b32 v12, 0
    s_mov_b64 exec, 1
    buffer_store_dword v3, v12, s[28:31], s50 offen sc1
    s_mov_b64 exec, -1
L_nf_19:
    s_add_u32 s70, s48, 0
    s_lshl_b32 s70, s70, 16
    s_add_u32 s70, s70, s10
    buffer_load_dwordx4 a[128:131], v10, s[28:31], s70 offen offset:0 sc1
    buffer_load_dwordx4 a[132:135], v10, s[28:31], s70 offen offset:1024 sc1
    s_add_u32 s70, s70, 196608
    buffer_load_dwordx4 a[136:139], v10, s[28:31], s70 offen offset:0 sc1
    buffer_load_dwordx4 a[140:143], v10, s[28:31], s70 offen offset:1024 sc1
    s_add_u32 s70, s70, 196608
    buffer_load_dwordx4 a[144:147], v10, s[28:31], s70 offen offset:0 sc1
    buffer_load_dwordx4 a[148:151], v10, s[28:31], s70 offen offset:1024 sc1
    s_add_u32 s70, s70, 196608
    buffer_load_dwordx4 a[152:155], v10, s[28:31], s70 offen offset:0 sc1
    buffer_load_dwordx4 a[156:159], v10, s[28:31], s70 offen offset:1024 sc1
    s_add_u32 s70, s70, 196608
    buffer_load_dwordx4 a[160:163], v10, s[28:31], s70 offen offset:0 sc1
    buffer_load_dwordx4 a[164:167], v10, s[28:31], s70 offen offset:1024 sc1
    s_add_u32 s70, s70, 196608
    buffer_load_dwordx4 a[168:171], v10, s[28:31], s70 offen offset:0 sc1
    buffer_load_dwordx4 a[172:175], v10, s[28:31], s70 offen offset:1024 sc1
    s_add_u32 s70, s70, 196608
    buffer_load_dwordx4 a[176:179], v10, s[28:31], s70 offen offset:0 sc1
    buffer_load_dwordx4 a[180:183], v10, s[28:31], s70 offen offset:1024 sc1
    s_add_u32 s70, s8, 0
    s_lshl_b32 s70, s70, 16
    s_add_u32 s70, s70, s10
    buffer_load_dwordx4 a[184:187], v10, s[28:31], s70 offen offset:0 sc1
    buffer_load_dwordx4 a[188:191], v10, s[28:31], s70 offen offset:1024 sc1
    buffer_load_dword v3, v2, s[28:31], 0 offen sc1
    ds_read_b64_tr_b16 a[64:65], v177 offset:0
    ds_read_b64_tr_b16 a[66:67], v177 offset:512
    ds_read_b64_tr_b16 a[68:69], v177 offset:2048
    ds_read_b64_tr_b16 a[70:71], v177 offset:2560
    ds_read_b64_tr_b16 a[72:73], v177 offset:4096
    ds_read_b64_tr_b16 a[74:75], v177 offset:4608
    ds_read_b64_tr_b16 a[76:77], v177 offset:6144
    ds_read_b64_tr_b16 a[78:79], v177 offset:6656
    ds_read_b64_tr_b16 a[80:81], v177 offset:8192
    ds_read_b64_tr_b16 a[82:83], v177 offset:8704
    ds_read_b64_tr_b16 a[84:85], v177 offset:10240
    ds_read_b64_tr_b16 a[86:87], v177 offset:10752
    ds_read_b64_tr_b16 a[88:89], v177 offset:12288
    ds_read_b64_tr_b16 a[90:91], v177 offset:12800
    ds_read_b64_tr_b16 a[92:93], v177 offset:14336
    s_waitcnt lgkmcnt(11)
    ds_read_b64_tr_b16 a[94:95], v177 offset:14848
    ds_read_b64_tr_b16 a[96:97], v177 offset:16384
    ds_read_b64_tr_b16 a[98:99], v177 offset:16896
    ds_read_b64_tr_b16 a[100:101], v177 offset:18432
    s_waitcnt lgkmcnt(11)
    ds_read_b64_tr_b16 a[102:103], v177 offset:18944
    ds_read_b64_tr_b16 a[104:105], v177 offset:20480
    ds_read_b64_tr_b16 a[106:107], v177 offset:20992
    ds_read_b64_tr_b16 a[108:109], v177 offset:22528
    s_waitcnt lgkmcnt(11)
    ds_read_b64_tr_b16 a[110:111], v177 offset:23040
    ds_read_b64_tr_b16 a[112:113], v177 offset:24576
    ds_read_b64_tr_b16 a[114:115], v177 offset:25088
    ds_read_b64_tr_b16 a[116:117], v177 offset:26624
    s_waitcnt lgkmcnt(11)
    ds_read_b64_tr_b16 a[118:119], v177 offset:27136
    ds_read_b64_tr_b16 a[120:121], v177 offset:28672
    ds_read_b64_tr_b16 a[122:123], v177 offset:29184
    ds_read_b64_tr_b16 a[124:125], v177 offset:30720
    s_waitcnt lgkmcnt(11)
    ds_read_b64_tr_b16 a[126:127], v177 offset:31232
    s_waitcnt vmcnt(0)
    v_cmp_ne_u32 vcc, s40, v3
    s_nop 0
    s_cbranch_vccnz L_slow_p3_20
L_ok_p3_21:
    s_cmp_eq_u32 s46, 0
    s_cbranch_scc1 L_nogemm1
    s_add_u32 m0, s0, 65536
    s_nop 0
    buffer_load_dwordx4 v136, s[28:31], s56 offen offset:0 sc1 lds
    buffer_load_dwordx4 v137, s[28:31], s56 offen offset:1024 sc1 lds
    buffer_load_dwordx4 v138, s[28:31], s56 offen offset:2048 sc1 lds
    buffer_load_dwordx4 v139, s[28:31], s56 offen offset:3072 sc1 lds
    s_add_u32 m0, s0, 69632
    s_add_u32 s56, s56, 4096
    buffer_load_dwordx4 v140, s[28:31], s56 offen offset:0 sc1 lds
    buffer_load_dwordx4 v141, s[28:31], s56 offen offset:1024 sc1 lds
    buffer_load_dwordx4 v142, s[28:31], s56 offen offset:2048 sc1 lds
    buffer_load_dwordx4 v143, s[28:31], s56 offen offset:3072 sc1 lds
    s_add_u32 m0, s0, 98304
    s_nop 0
    buffer_load_dwordx4 v136, s[28:31], s57 offen offset:0 sc1 lds
    buffer_load_dwordx4 v137, s[28:31], s57 offen offset:1024 sc1 lds
    buffer_load_dwordx4 v138, s[28:31], s57 offen offset:2048 sc1 lds
    buffer_load_dwordx4 v139, s[28:31], s57 offen offset:3072 sc1 lds
    s_add_u32 m0, s0, 102400
    s_add_u32 s57, s57, 4096
    buffer_load_dwordx4 v140, s[28:31], s57 offen offset:0 sc1 lds
    buffer_load_dwordx4 v141, s[28:31], s57 offen offset:1024 sc1 lds
    buffer_load_dwordx4 v142, s[28:31], s57 offen offset:2048 sc1 lds
    buffer_load_dwordx4 v143, s[28:31], s57 offen offset:3072 sc1 lds
    s_waitcnt vmcnt(8)
    s_waitcnt lgkmcnt(0)
    s_barrier
    ds_read_b128 v[144:147], v120 offset:0
    ds_read_b128 v[148:151], v121 offset:0
    ds_read_b128 v[152:155], v122 offset:0
    ds_read_b128 v[156:159], v123 offset:0
    ds_read_b128 v[160:163], v124 offset:0
    ds_read_b128 v[164:167], v125 offset:0
    buffer_store_dword v11, v12, s[28:31], s17 offen sc1
    buffer_store_dword v11, v12, s[28:31], s69 offen sc1
    s_waitcnt lgkmcnt(4)
    v_mfma_f32_32x32x16_bf16 v[64:79], a[0:3], v[144:147], 0
    ds_read_b128 v[168:171], v126 offset:0
    s_mul_i32 s22, s49, 88
    v_mfma_f32_32x32x16_bf16 v[64:79], a[4:7], v[148:151], v[64:79]
    ds_read_b128 v[172:175], v127 offset:0
    s_add_u32 s22, s22, s6
    s_mul_i32 s22, s22, 128
    s_waitcnt lgkmcnt(4)
    v_mfma_f32_32x32x16_bf16 v[64:79], a[8:11], v[152:155], v[64:79]
    ds_read_b128 v[144:147], v120 offset:256
    s_add_u32 s22, s22, 65536
    v_min_u32 v6, 21, v1
    v_mfma_f32_32x32x16_bf16 v[64:79], a[12:15], v[156:159], v[64:79]
    ds_read_b128 v[148:151], v121 offset:256
    v_mul_u32_u24 v6, 512, v6
    s_waitcnt lgkmcnt(4)
    v_mfma_f32_32x32x16_bf16 v[64:79], a[16:19], v[160:163], v[64:79]
    ds_read_b128 v[152:155], v122 offset:256
    v_add_u32 v17, s22, v6
    v_bfe_u32 v8, v1, 2, 1
    v_mfma_f32_32x32x16_bf16 v[64:79], a[20:23], v[164:167], v[64:79]
    ds_read_b128 v[156:159], v123 offset:256
    v_mul_u32_u24 v8, 512, v8
    s_add_u32 m0, s0, 131072
    s_nop 0
    buffer_load_dwordx4 v136, s[28:31], s58 offen offset:0 sc1 lds
    s_waitcnt lgkmcnt(4)
    v_mfma_f32_32x32x16_bf16 v[64:79], a[24:27], v[168:171], v[64:79]
    ds_read_b128 v[160:163], v124 offset:256
    v_and_b32 v9, 3, v1
    v_lshl_add_u32 v8, v9, 2, v8
    v_mfma_f32_32x32x16_bf16 v[64:79], a[28:31], v[172:175], v[64:79]
    ds_read_b128 v[164:167], v125 offset:256
    buffer_load_dwordx4 v137, s[28:31], s58 offen offset:1024 sc1 lds
    s_lshl_b32 s22, s11, 2
    s_add_u32 s22, s22, s6
    s_waitcnt lgkmcnt(4)
    v_mfma_f32_32x32x16_bf16 v[64:79], a[32:35], v[144:147], v[64:79]
    ds_read_b128 v[168:171], v126 offset:256
    buffer_load_dwordx4 v138, s[28:31], s58 offen offset:2048 sc1 lds
    s_mul_i32 s22, s22, 128
    v_mfma_f32_32x32x16_bf16 v[64:79], a[36:39], v[148:151], v[64:79]
    ds_read_b128 v[172:175], v127 offset:256
    s_add_u32 s22, s22, 262144
    buffer_load_dwordx4 v139, s[28:31], s58 offen offset:3072 sc1 lds
    v_add_u32 v8, s22, v8
    s_waitcnt lgkmcnt(4)
    v_mfma_f32_32x32x16_bf16 v[64:79], a[40:43], v[152:155], v[64:79]
    ds_read_b128 v[144:147], v120 offset:512
    v_cmp_lt_u32 vcc, 23, v1
    s_nop 1
    v_cndmask_b32 v17, v17, v8, vcc
    v_mfma_f32_32x32x16_bf16 v[64:79], a[44:47], v[156:159], v[64:79]
    ds_read_b128 v[148:151], v121 offset:512
    s_add_u32 m0, s0, 135168
    s_add_u32 s58, s58, 4096
    buffer_load_dwordx4 v140, s[28:31], s58 offen offset:0 sc1 lds
    s_waitcnt lgkmcnt(4)
    v_mfma_f32_32x32x16_bf16 v[64:79], a[48:51], v[160:163], v[64:79]
    ds_read_b128 v[152:155], v122 offset:512
    s_add_u32 s22, s47, 40
    s_mul_i32 s22, s22, 128
    v_mfma_f32_32x32x16_bf16 v[64:79], a[52:55], v[164:167], v[64:79]
    ds_read_b128 v[156:159], v123 offset:512
    buffer_load_dwordx4 v141, s[28:31], s58 offen offset:1024 sc1 lds
    s_add_u32 s22, s22, 20480
    v_mov_b32 v8, s22
    s_waitcnt lgkmcnt(4)
    v_mfma_f32_32x32x16_bf16 v[64:79], a[56:59], v[168:171], v[64:79]
    ds_read_b128 v[160:163], v124 offset:512
    buffer_load_dwordx4 v142, s[28:31], s58 offen offset:2048 sc1 lds
    buffer_load_dwordx4 v143, s[28:31], s58 offen offset:3072 sc1 lds
    v_mfma_f32_32x32x16_bf16 v[64:79], a[60:63], v[172:175], v[64:79]
    ds_read_b128 v[164:167], v125 offset:512
    v_cmp_lt_u32 vcc, 31, v1
    s_nop 1
    v_cndmask_b32 v17, v17, v8, vcc
    v_lshrrev_b32 v6, 3, v1
    s_lshl_b32 s22, s6, 3
    v_add_u32 v6, s22, v6
    s_waitcnt lgkmcnt(4)
    v_mfma_f32_32x32x16_bf16 v[64:79], a[64:67], v[144:147], v[64:79]
    ds_read_b128 v[168:171], v126 offset:512
    s_add_u32 s70, s70, 196608
    buffer_load_dwordx4 a[192:195], v10, s[28:31], s70 offen offset:0 sc1
    v_mfma_f32_32x32x16_bf16 v[64:79], a[68:71], v[148:151], v[64:79]
    ds_read_b128 v[172:175], v127 offset:512
    v_and_b32 v7, 7, v1
    v_lshlrev_b32 v8, 4, v7
    s_lshl_b32 s22, s47, 7
    v_add_u32 v8, s22, v8
    s_waitcnt lgkmcnt(4)
    v_mfma_f32_32x32x16_bf16 v[64:79], a[72:75], v[152:155], v[64:79]
    ds_read_b128 v[144:147], v120 offset:768
    v_lshl_add_u32 v22, v6, 10, v8
    buffer_load_dwordx4 a[196:199], v10, s[28:31], s70 offen offset:1024 sc1
    v_mfma_f32_32x32x16_bf16 v[64:79], a[76:79], v[156:159], v[64:79]
    ds_read_b128 v[148:151], v121 offset:768
    v_lshl_add_u32 v23, v6, 16, v8
    v_lshlrev_b32 v24, 1, v8
    s_waitcnt lgkmcnt(4)
    v_mfma_f32_32x32x16_bf16 v[64:79], a[80:83], v[160:163], v[64:79]
    ds_read_b128 v[152:155], v122 offset:768
    v_and_b32 v8, 7, v6
    v_lshlrev_b32 v7, 1, v7
    v_mfma_f32_32x32x16_bf16 v[64:79], a[84:87], v[164:167], v[64:79]
    ds_read_b128 v[156:159], v123 offset:768
    v_xor_b32 v7, v7, v8
    s_add_u32 s70, s70, 196608
    buffer_load_dwordx4 a[200:203], v10, s[28:31], s70 offen offset:0 sc1
    s_waitcnt lgkmcnt(4)
    v_mfma_f32_32x32x16_bf16 v[64:79], a[88:91], v[168:171], v[64:79]
    ds_read_b128 v[160:163], v124 offset:768
    v_lshlrev_b32 v7, 4, v7
    v_lshl_add_u32 v25, v6, 8, v7
    v_mfma_f32_32x32x16_bf16 v[64:79], a[92:95], v[172:175], v[64:79]
    ds_read_b128 v[164:167], v125 offset:768
    v_xor_b32 v26, 16, v25
    v_and_b32 v6, 31, v1
    s_waitcnt lgkmcnt(4)
    v_mfma_f32_32x32x16_bf16 v[64:79], a[96:99], v[144:147], v[64:79]
    ds_read_b128 v[168:171], v126 offset:768
    v_lshrrev_b32 v7, 5, v1
    buffer_load_dwordx4 a[204:207], v10, s[28:31], s70 offen offset:1024 sc1
    v_mfma_f32_32x32x16_bf16 v[64:79], a[100:103], v[148:151], v[64:79]
    ds_read_b128 v[172:175], v127 offset:768
    v_and_b32 v8, 7, v1
    v_xor_b32 v7, v7, v8
    s_waitcnt lgkmcnt(4)
    v_mfma_f32_32x32x16_bf16 v[64:79], a[104:107], v[152:155], v[64:79]
    s_waitcnt vmcnt(14)
    s_barrier
    ds_read_b128 v[144:147], v120 offset:32768
    v_lshlrev_b32 v7, 4, v7
    v_lshl_add_u32 v7, v6, 8, v7
    v_mfma_f32_32x32x16_bf16 v[64:79], a[108:111], v[156:159], v[64:79]
    ds_read_b128 v[148:151], v121 offset:32768
    s_lshl_b32 s22, s6, 13
    s_add_u32 s70, s70, 196608
    buffer_load_dwordx4 a[208:211], v10, s[28:31], s70 offen offset:0 sc1
    s_waitcnt lgkmcnt(4)
    v_mfma_f32_32x32x16_bf16 v[64:79], a[112:115], v[160:163], v[64:79]
    ds_read_b128 v[152:155], v122 offset:32768
    v_add_u32 v27, s22, v7
    v_xor_b32 v28, 32, v27
    v_mfma_f32_32x32x16_bf16 v[64:79], a[116:119], v[164:167], v[64:79]
    ds_read_b128 v[156:159], v123 offset:32768
    v_xor_b32 v29, 64, v27
    v_xor_b32 v30, 0x60, v27
    s_waitcnt lgkmcnt(4)
    v_mfma_f32_32x32x16_bf16 v[64:79], a[120:123], v[168:171], v[64:79]
    ds_read_b128 v[160:163], v124 offset:32768
    buffer_load_dwordx4 a[212:215], v10, s[28:31], s70 offen offset:1024 sc1
    v_add_u32 v9, 88064, v10
    v_mfma_f32_32x32x16_bf16 v[64:79], a[124:127], v[172:175], v[64:79]
    ds_read_b128 v[164:167], v125 offset:32768
    s_waitcnt lgkmcnt(4)
    v_mfma_f32_32x32x16_bf16 v[80:95], a[0:3], v[144:147], 0
    ds_read_b128 v[168:171], v126 offset:32768
    v_mfma_f32_32x32x16_bf16 v[80:95], a[4:7], v[148:151], v[80:95]
    s_barrier
    ds_read_b128 v[172:175], v127 offset:32768
    s_waitcnt lgkmcnt(4)
    v_mfma_f32_32x32x16_bf16 v[80:95], a[8:11], v[152:155], v[80:95]
    ds_read_b128 v[144:147], v120 offset:33024
    s_add_u32 m0, s0, 65536
    s_nop 0
    buffer_load_dwordx4 v136, s[28:31], s59 offen offset:0 sc1 lds
    v_mfma_f32_32x32x16_bf16 v[80:95], a[12:15], v[156:159], v[80:95]
    ds_read_b128 v[148:151], v121 offset:33024
    v_mul_f32 v96, s16, v64
    v_mul_f32 v98, s16, v65
    s_waitcnt lgkmcnt(4)
    v_mfma_f32_32x32x16_bf16 v[80:95], a[16:19], v[160:163], v[80:95]
    ds_read_b128 v[152:155], v122 offset:33024
    buffer_load_dwordx4 v137, s[28:31], s59 offen offset:1024 sc1 lds
    v_mul_f32 v100, s16, v66
    v_mfma_f32_32x32x16_bf16 v[80:95], a[20:23], v[164:167], v[80:95]
    ds_read_b128 v[156:159], v123 offset:33024
    v_mul_f32 v102, s16, v67
    v_mul_f32 v104, s16, v72
    v_mul_f32 v106, s16, v73
    s_waitcnt lgkmcnt(4)
    v_mfma_f32_32x32x16_bf16 v[80:95], a[24:27], v[168:171], v[80:95]
    ds_read_b128 v[160:163], v124 offset:33024
    buffer_load_dwordx4 v138, s[28:31], s59 offen offset:2048 sc1 lds
    v_mul_f32 v108, s16, v74
    v_mfma_f32_32x32x16_bf16 v[80:95], a[28:31], v[172:175], v[80:95]
    ds_read_b128 v[164:167], v125 offset:33024
    v_mul_f32 v110, s16, v75
    v_exp_f32 v96, v96
    v_mul_f32 v97, v64, v68
    s_waitcnt lgkmcnt(4)
    v_mfma_f32_32x32x16_bf16 v[80:95], a[32:35], v[144:147], v[80:95]
    ds_read_b128 v[168:171], v126 offset:33024
    buffer_load_dwordx4 v139, s[28:31], s59 offen offset:3072 sc1 lds
    v_mfma_f32_32x32x16_bf16 v[80:95], a[36:39], v[148:151], v[80:95]
    ds_read_b128 v[172:175], v127 offset:33024
    v_exp_f32 v98, v98
    v_mul_f32 v99, v65, v69
    v_exp_f32 v100, v100
    s_waitcnt lgkmcnt(4)
    v_mfma_f32_32x32x16_bf16 v[80:95], a[40:43], v[152:155], v[80:95]
    ds_read_b128 v[144:147], v120 offset:33280
    v_mul_f32 v101, v66, v70
    v_mfma_f32_32x32x16_bf16 v[80:95], a[44:47], v[156:159], v[80:95]
    ds_read_b128 v[148:151], v121 offset:33280
    s_add_u32 m0, s0, 69632
    s_add_u32 s59, s59, 4096
    buffer_load_dwordx4 v140, s[28:31], s59 offen offset:0 sc1 lds
    s_waitcnt lgkmcnt(4)
    v_mfma_f32_32x32x16_bf16 v[80:95], a[48:51], v[160:163], v[80:95]
    ds_read_b128 v[152:155], v122 offset:33280
    v_exp_f32 v102, v102
    v_mul_f32 v103, v67, v71
    v_mfma_f32_32x32x16_bf16 v[80:95], a[52:55], v[164:167], v[80:95]
    ds_read_b128 v[156:159], v123 offset:33280
    v_exp_f32 v104, v104
    v_mul_f32 v105, v72, v76
    s_waitcnt lgkmcnt(4)
    v_mfma_f32_32x32x16_bf16 v[80:95], a[56:59], v[168:171], v[80:95]
    ds_read_b128 v[160:163], v124 offset:33280
    buffer_load_dwordx4 v141, s[28:31], s59 offen offset:1024 sc1 lds
    buffer_load_dwordx4 v142, s[28:31], s59 offen offset:2048 sc1 lds
    buffer_load_dwordx4 v143, s[28:31], s59 offen offset:3072 sc1 lds
    v_mfma_f32_32x32x16_bf16 v[80:95], a[60:63], v[172:175], v[80:95]
    ds_read_b128 v[164:167], v125 offset:33280
    v_exp_f32 v106, v106
    v_mul_f32 v107, v73, v77
    v_exp_f32 v108, v108
    s_waitcnt lgkmcnt(4)
    v_mfma_f32_32x32x16_bf16 v[80:95], a[64:67], v[144:147], v[80:95]
    ds_read_b128 v[168:171], v126 offset:33280
    v_mul_f32 v109, v74, v78
    v_exp_f32 v110, v110
    v_mul_f32 v111, v75, v79
    v_mfma_f32_32x32x16_bf16 v[80:95], a[68:71], v[148:151], v[80:95]
    ds_read_b128 v[172:175], v127 offset:33280
    v_add_f32 v96, 1.0, v96
    v_add_f32 v98, 1.0, v98
    v_add_f32 v100, 1.0, v100
    v_add_f32 v102, 1.0, v102
    s_waitcnt lgkmcnt(4)
    v_mfma_f32_32x32x16_bf16 v[80:95], a[72:75], v[152:155], v[80:95]
    ds_read_b128 v[144:147], v120 offset:33536
    s_add_u32 s70, s70, 196608
    buffer_load_dwordx4 a[216:219], v10, s[28:31], s70 offen offset:0 sc1
    v_mfma_f32_32x32x16_bf16 v[80:95], a[76:79], v[156:159], v[80:95]
    ds_read_b128 v[148:151], v121 offset:33536
    v_add_f32 v104, 1.0, v104
    v_add_f32 v106, 1.0, v106
    v_add_f32 v108, 1.0, v108
    v_add_f32 v110, 1.0, v110
    s_waitcnt lgkmcnt(4)
    v_mfma_f32_32x32x16_bf16 v[80:95], a[80:83], v[160:163], v[80:95]
    ds_read_b128 v[152:155], v122 offset:33536
    v_rcp_f32 v96, v96
    v_rcp_f32 v98, v98
    v_mfma_f32_32x32x16_bf16 v[80:95], a[84:87], v[164:167], v[80:95]
    ds_read_b128 v[156:159], v123 offset:33536
    v_rcp_f32 v100, v100
    buffer_load_dwordx4 a[220:223], v10, s[28:31], s70 offen offset:1024 sc1
    s_waitcnt lgkmcnt(4)
    v_mfma_f32_32x32x16_bf16 v[80:95], a[88:91], v[168:171], v[80:95]
    ds_read_b128 v[160:163], v124 offset:33536
    v_mul_f32 v96, v96, v97
    v_rcp_f32 v102, v102
    v_mul_f32 v98, v98, v99
    v_mfma_f32_32x32x16_bf16 v[80:95], a[92:95], v[172:175], v[80:95]
    ds_read_b128 v[164:167], v125 offset:33536
    v_rcp_f32 v104, v104
    v_mul_f32 v100, v100, v101
    v_rcp_f32 v106, v106
    s_waitcnt lgkmcnt(4)
    v_mfma_f32_32x32x16_bf16 v[80:95], a[96:99], v[144:147], v[80:95]
    ds_read_b128 v[168:171], v126 offset:33536
    v_mul_f32 v102, v102, v103
    v_rcp_f32 v108, v108
    v_mfma_f32_32x32x16_bf16 v[80:95], a[100:103], v[148:151], v[80:95]
    ds_read_b128 v[172:175], v127 offset:33536
    s_add_u32 s70, s70, 196608
    buffer_load_dwordx4 a[224:227], v10, s[28:31], s70 offen offset:0 sc1
    v_mul_f32 v104, v104, v105
    buffer_load_dwordx4 a[228:231], v10, s[28:31], s70 offen offset:1024 sc1
    s_waitcnt lgkmcnt(4)
    v_mfma_f32_32x32x16_bf16 v[80:95], a[104:107], v[152:155], v[80:95]
    s_waitcnt vmcnt(18)
    s_barrier
    ds_read_b128 v[144:147], v128 offset:0
    v_rcp_f32 v110, v110
    v_mul_f32 v106, v106, v107
    v_mul_f32 v108, v108, v109
    v_mul_f32 v110, v110, v111
    v_cvt_pk_bf16_f32 v112, v96, v98
    v_cvt_pk_bf16_f32 v113, v100, v102
    v_cvt_pk_bf16_f32 v114, v104, v106
    v_cvt_pk_bf16_f32 v115, v108, v110
    buffer_store_dwordx4 v[112:115], v10, s[28:31], s62 offen sc1
    v_mfma_f32_32x32x16_bf16 v[80:95], a[108:111], v[156:159], v[80:95]
    ds_read_b128 v[148:151], v129 offset:0
    s_waitcnt lgkmcnt(4)
    v_mfma_f32_32x32x16_bf16 v[80:95], a[112:115], v[160:163], v[80:95]
    ds_read_b128 v[152:155], v130 offset:0
    v_mfma_f32_32x32x16_bf16 v[80:95], a[116:119], v[164:167], v[80:95]
    ds_read_b128 v[156:159], v131 offset:0
    s_waitcnt lgkmcnt(4)
    v_mfma_f32_32x32x16_bf16 v[80:95], a[120:123], v[168:171], v[80:95]
    ds_read_b128 v[160:163], v132 offset:0
    v_mfma_f32_32x32x16_bf16 v[80:95], a[124:127], v[172:175], v[80:95]
    ds_read_b128 v[164:167], v133 offset:0
    s_waitcnt lgkmcnt(4)
    v_mfma_f32_32x32x16_bf16 v[64:79], a[0:3], v[144:147], 0
    ds_read_b128 v[168:171], v134 offset:0
    v_mfma_f32_32x32x16_bf16 v[64:79], a[4:7], v[148:151], v[64:79]
    s_barrier
    ds_read_b128 v[172:175], v135 offset:0
    s_waitcnt lgkmcnt(4)
    v_mfma_f32_32x32x16_bf16 v[64:79], a[8:11], v[152:155], v[64:79]
    ds_read_b128 v[144:147], v128 offset:256
    s_add_u32 m0, s0, 98304
    s_nop 0
    buffer_load_dwordx4 v136, s[28:31], s60 offen offset:0 sc1 lds
    v_mfma_f32_32x32x16_bf16 v[64:79], a[12:15], v[156:159], v[64:79]
    ds_read_b128 v[148:151], v129 offset:256
    v_mul_f32 v96, s16, v80
    v_mul_f32 v98, s16, v81
    s_waitcnt lgkmcnt(4)
    v_mfma_f32_32x32x16_bf16 v[64:79], a[16:19], v[160:163], v[64:79]
    ds_read_b128 v[152:155], v130 offset:256
    buffer_load_dwordx4 v137, s[28:31], s60 offen offset:1024 sc1 lds
    v_mul_f32 v100, s16, v82
    v_mfma_f32_32x32x16_bf16 v[64:79], a[20:23], v[164:167], v[64:79]
    ds_read_b128 v[156:159], v131 offset:256
    v_mul_f32 v102, s16, v83
    v_mul_f32 v104, s16, v88
    v_mul_f32 v106, s16, v89
    s_waitcnt lgkmcnt(4)
    v_mfma_f32_32x32x16_bf16 v[64:79], a[24:27], v[168:171], v[64:79]
    ds_read_b128 v[160:163], v132 offset:256
    buffer_load_dwordx4 v138, s[28:31], s60 offen offset:2048 sc1 lds
    v_mul_f32 v108, s16, v90
    v_mfma_f32_32x32x16_bf16 v[64:79], a[28:31], v[172:175], v[64:79]
    ds_read_b128 v[164:167], v133 offset:256
    v_mul_f32 v110, s16, v91
    v_exp_f32 v96, v96
    v_mul_f32 v97, v80, v84
    s_waitcnt lgkmcnt(4)
    v_mfma_f32_32x32x16_bf16 v[64:79], a[32:35], v[144:147], v[64:79]
    ds_read_b128 v[168:171], v134 offset:256
    buffer_load_dwordx4 v139, s[28:31], s60 offen offset:3072 sc1 lds
    v_mfma_f32_32x32x16_bf16 v[64:79], a[36:39], v[148:151], v[64:79]
    ds_read_b128 v[172:175], v135 offset:256
    v_exp_f32 v98, v98
    v_mul_f32 v99, v81, v85
    v_exp_f32 v100, v100
    s_waitcnt lgkmcnt(4)
    v_mfma_f32_32x32x16_bf16 v[64:79], a[40:43], v[152:155], v[64:79]
    ds_read_b128 v[144:147], v128 offset:512
    v_mul_f32 v101, v82, v86
    v_mfma_f32_32x32x16_bf16 v[64:79], a[44:47], v[156:159], v[64:79]
    ds_read_b128 v[148:151], v129 offset:512
    s_add_u32 m0, s0, 102400
    s_add_u32 s60, s60, 4096
    buffer_load_dwordx4 v140, s[28:31], s60 offen offset:0 sc1 lds
    s_waitcnt lgkmcnt(4)
    v_mfma_f32_32x32x16_bf16 v[64:79], a[48:51], v[160:163], v[64:79]
    ds_read_b128 v[152:155], v130 offset:512
    v_exp_f32 v102, v102
    v_mul_f32 v103, v83, v87
    v_mfma_f32_32x32x16_bf16 v[64:79], a[52:55], v[164:167], v[64:79]
    ds_read_b128 v[156:159], v131 offset:512
    v_exp_f32 v104, v104
    v_mul_f32 v105, v88, v92
    s_waitcnt lgkmcnt(4)
    v_mfma_f32_32x32x16_bf16 v[64:79], a[56:59], v[168:171], v[64:79]
    ds_read_b128 v[160:163], v132 offset:512
    buffer_load_dwordx4 v141, s[28:31], s60 offen offset:1024 sc1 lds
    buffer_load_dwordx4 v142, s[28:31], s60 offen offset:2048 sc1 lds
    buffer_load_dwordx4 v143, s[28:31], s60 offen offset:3072 sc1 lds
    v_mfma_f32_32x32x16_bf16 v[64:79], a[60:63], v[172:175], v[64:79]
    ds_read_b128 v[164:167], v133 offset:512
    v_exp_f32 v106, v106
    v_mul_f32 v107, v89, v93
    v_exp_f32 v108, v108
    s_waitcnt lgkmcnt(4)
    v_mfma_f32_32x32x16_bf16 v[64:79], a[64:67], v[144:147], v[64:79]
    ds_read_b128 v[168:171], v134 offset:512
    v_mul_f32 v109, v90, v94
    v_exp_f32 v110, v110
    v_mul_f32 v111, v91, v95
    v_mfma_f32_32x32x16_bf16 v[64:79], a[68:71], v[148:151], v[64:79]
    ds_read_b128 v[172:175], v135 offset:512
    v_add_f32 v96, 1.0, v96
    v_add_f32 v98, 1.0, v98
    v_add_f32 v100, 1.0, v100
    v_add_f32 v102, 1.0, v102
    s_waitcnt lgkmcnt(4)
    v_mfma_f32_32x32x16_bf16 v[64:79], a[72:75], v[152:155], v[64:79]
    ds_read_b128 v[144:147], v128 offset:768
    s_add_u32 s70, s70, 196608
    buffer_load_dwordx4 a[232:235], v10, s[28:31], s70 offen offset:0 sc1
    v_mfma_f32_32x32x16_bf16 v[64:79], a[76:79], v[156:159], v[64:79]
    ds_read_b128 v[148:151], v129 offset:768
    v_add_f32 v104, 1.0, v104
    v_add_f32 v106, 1.0, v106
    v_add_f32 v108, 1.0, v108
    v_add_f32 v110, 1.0, v110
    s_waitcnt lgkmcnt(4)
    v_mfma_f32_32x32x16_bf16 v[64:79], a[80:83], v[160:163], v[64:79]
    ds_read_b128 v[152:155], v130 offset:768
    v_rcp_f32 v96, v96
    v_rcp_f32 v98, v98
    v_mfma_f32_32x32x16_bf16 v[64:79], a[84:87], v[164:167], v[64:79]
    ds_read_b128 v[156:159], v131 offset:768
    v_rcp_f32 v100, v100
    buffer_load_dwordx4 a[236:239], v10, s[28:31], s70 offen offset:1024 sc1
    s_waitcnt lgkmcnt(4)
    v_mfma_f32_32x32x16_bf16 v[64:79], a[88:91], v[168:171], v[64:79]
    ds_read_b128 v[160:163], v132 offset:768
    v_mul_f32 v96, v96, v97
    v_rcp_f32 v102, v102
    v_mul_f32 v98, v98, v99
    v_mfma_f32_32x32x16_bf16 v[64:79], a[92:95], v[172:175], v[64:79]
    ds_read_b128 v[164:167], v133 offset:768
    v_rcp_f32 v104, v104
    v_mul_f32 v100, v100, v101
    v_rcp_f32 v106, v106
    s_waitcnt lgkmcnt(4)
    v_mfma_f32_32x32x16_bf16 v[64:79], a[96:99], v[144:147], v[64:79]
    ds_read_b128 v[168:171], v134 offset:768
    v_mul_f32 v102, v102, v103
    v_rcp_f32 v108, v108
    v_mfma_f32_32x32x16_bf16 v[64:79], a[100:103], v[148:151], v[64:79]
    ds_read_b128 v[172:175], v135 offset:768
    s_add_u32 s70, s9, 0
    s_lshl_b32 s70, s70, 16
    s_add_u32 s70, s70, s10
    buffer_load_dwordx4 a[240:243], v10, s[28:31], s70 offen offset:0 sc1
    buffer_load_dwordx4 a[244:247], v10, s[28:31], s70 offen offset:1024 sc1
    s_waitcnt lgkmcnt(4)
    v_mfma_f32_32x32x16_bf16 v[64:79], a[104:107], v[152:155], v[64:79]
    s_waitcnt vmcnt(17)
    s_barrier
    ds_read_b128 v[144:147], v120 offset:0
    v_mul_f32 v104, v104, v105
    v_rcp_f32 v110, v110
    v_mul_f32 v106, v106, v107
    v_mul_f32 v108, v108, v109
    v_mul_f32 v110, v110, v111
    v_cvt_pk_bf16_f32 v112, v96, v98
    v_cvt_pk_bf16_f32 v113, v100, v102
    v_cvt_pk_bf16_f32 v114, v104, v106
    v_cvt_pk_bf16_f32 v115, v108, v110
    buffer_store_dwordx4 v[112:115], v10, s[28:31], s63 offen sc1
    v_mfma_f32_32x32x16_bf16 v[64:79], a[108:111], v[156:159], v[64:79]
    ds_read_b128 v[148:151], v121 offset:0
    s_waitcnt lgkmcnt(4)
    v_mfma_f32_32x32x16_bf16 v[64:79], a[112:115], v[160:163], v[64:79]
    ds_read_b128 v[152:155], v122 offset:0
    v_mfma_f32_32x32x16_bf16 v[64:79], a[116:119], v[164:167], v[64:79]
    ds_read_b128 v[156:159], v123 offset:0
    s_waitcnt lgkmcnt(4)
    v_mfma_f32_32x32x16_bf16 v[64:79], a[120:123], v[168:171], v[64:79]
    ds_read_b128 v[160:163], v124 offset:0
    v_mfma_f32_32x32x16_bf16 v[64:79], a[124:127], v[172:175], v[64:79]
    ds_read_b128 v[164:167], v125 offset:0
    s_waitcnt lgkmcnt(4)
    v_mfma_f32_32x32x16_bf16 v[80:95], a[0:3], v[144:147], 0
    ds_read_b128 v[168:171], v126 offset:0
    v_mfma_f32_32x32x16_bf16 v[80:95], a[4:7], v[148:151], v[80:95]
    s_barrier
    ds_read_b128 v[172:175], v127 offset:0
    s_waitcnt lgkmcnt(4)
    v_mfma_f32_32x32x16_bf16 v[80:95], a[8:11], v[152:155], v[80:95]
    ds_read_b128 v[144:147], v120 offset:256
    buffer_load_dword v31, v17, s[28:31], 0 offen sc1
    v_mfma_f32_32x32x16_bf16 v[80:95], a[12:15], v[156:159], v[80:95]
    ds_read_b128 v[148:151], v121 offset:256
    s_add_u32 m0, s0, 131072
    s_nop 0
    buffer_load_dwordx4 v136, s[28:31], s61 offen offset:0 sc1 lds
    s_waitcnt lgkmcnt(4)
    v_mfma_f32_32x32x16_bf16 v[80:95], a[16:19], v[160:163], v[80:95]
    ds_read_b128 v[152:155], v122 offset:256
    v_mul_f32 v96, s16, v64
    v_mul_f32 v98, s16, v65
    v_mfma_f32_32x32x16_bf16 v[80:95], a[20:23], v[164:167], v[80:95]
    ds_read_b128 v[156:159], v123 offset:256
    buffer_load_dwordx4 v137, s[28:31], s61 offen offset:1024 sc1 lds
    v_mul_f32 v100, s16, v66
    v_mul_f32 v102, s16, v67
    s_waitcnt lgkmcnt(4)
    v_mfma_f32_32x32x16_bf16 v[80:95], a[24:27], v[168:171], v[80:95]
    ds_read_b128 v[160:163], v124 offset:256
    v_mul_f32 v104, s16, v72
    v_mul_f32 v106, s16, v73
    v_mfma_f32_32x32x16_bf16 v[80:95], a[28:31], v[172:175], v[80:95]
    ds_read_b128 v[164:167], v125 offset:256
    buffer_load_dwordx4 v138, s[28:31], s61 offen offset:2048 sc1 lds
    v_mul_f32 v108, s16, v74
    v_mul_f32 v110, s16, v75
    s_waitcnt lgkmcnt(4)
    v_mfma_f32_32x32x16_bf16 v[80:95], a[32:35], v[144:147], v[80:95]
    ds_read_b128 v[168:171], v126 offset:256
    v_exp_f32 v96, v96
    v_mul_f32 v97, v64, v68
    v_mfma_f32_32x32x16_bf16 v[80:95], a[36:39], v[148:151], v[80:95]
    ds_read_b128 v[172:175], v127 offset:256
    buffer_load_dwordx4 v139, s[28:31], s61 offen offset:3072 sc1 lds
    v_exp_f32 v98, v98
    s_waitcnt lgkmcnt(4)
    v_mfma_f32_32x32x16_bf16 v[80:95], a[40:43], v[152:155], v[80:95]
    ds_read_b128 v[144:147], v120 offset:512
    v_mul_f32 v99, v65, v69
    v_exp_f32 v100, v100
    v_mul_f32 v101, v66, v70
    v_mfma_f32_32x32x16_bf16 v[80:95], a[44:47], v[156:159], v[80:95]
    ds_read_b128 v[148:151], v121 offset:512
    s_add_u32 m0, s0, 135168
    s_add_u32 s61, s61, 4096
    buffer_load_dwordx4 v140, s[28:31], s61 offen offset:0 sc1 lds
    s_waitcnt lgkmcnt(4)
    v_mfma_f32_32x32x16_bf16 v[80:95], a[48:51], v[160:163], v[80:95]
    ds_read_b128 v[152:155], v122 offset:512
    v_exp_f32 v102, v102
    v_mul_f32 v103, v67, v71
    v_mfma_f32_32x32x16_bf16 v[80:95], a[52:55], v[164:167], v[80:95]
    ds_read_b128 v[156:159], v123 offset:512
    v_exp_f32 v104, v104
    v_mul_f32 v105, v72, v76
    s_waitcnt lgkmcnt(4)
    v_mfma_f32_32x32x16_bf16 v[80:95], a[56:59], v[168:171], v[80:95]
    ds_read_b128 v[160:163], v124 offset:512
    buffer_load_dwordx4 v141, s[28:31], s61 offen offset:1024 sc1 lds
    buffer_load_dwordx4 v142, s[28:31], s61 offen offset:2048 sc1 lds
    buffer_load_dwordx4 v143, s[28:31], s61 offen offset:3072 sc1 lds
    v_mfma_f32_32x32x16_bf16 v[80:95], a[60:63], v[172:175], v[80:95]
    ds_read_b128 v[164:167], v125 offset:512
    v_exp_f32 v106, v106
    v_mul_f32 v107, v73, v77
    v_exp_f32 v108, v108
    s_waitcnt lgkmcnt(4)
    v_mfma_f32_32x32x16_bf16 v[80:95], a[64:67], v[144:147], v[80:95]
    ds_read_b128 v[168:171], v126 offset:512
    v_mul_f32 v109, v74, v78
    v_exp_f32 v110, v110
    v_mul_f32 v111, v75, v79
    v_mfma_f32_32x32x16_bf16 v[80:95], a[68:71], v[148:151], v[80:95]
    ds_read_b128 v[172:175], v127 offset:512
    v_add_f32 v96, 1.0, v96
    v_add_f32 v98, 1.0, v98
    v_add_f32 v100, 1.0, v100
    v_add_f32 v102, 1.0, v102
    s_waitcnt lgkmcnt(4)
    v_mfma_f32_32x32x16_bf16 v[80:95], a[72:75], v[152:155], v[80:95]
    ds_read_b128 v[144:147], v120 offset:768
    s_add_u32 s70, s70, 196608
    buffer_load_dwordx4 a[248:251], v10, s[28:31], s70 offen offset:0 sc1
    v_mfma_f32_32x32x16_bf16 v[80:95], a[76:79], v[156:159], v[80:95]
    ds_read_b128 v[148:151], v121 offset:768
    v_add_f32 v104, 1.0, v104
    v_add_f32 v106, 1.0, v106
    v_add_f32 v108, 1.0, v108
    v_add_f32 v110, 1.0, v110
    s_waitcnt lgkmcnt(4)
    v_mfma_f32_32x32x16_bf16 v[80:95], a[80:83], v[160:163], v[80:95]
    ds_read_b128 v[152:155], v122 offset:768
    v_rcp_f32 v96, v96
    v_rcp_f32 v98, v98
    v_mfma_f32_32x32x16_bf16 v[80:95], a[84:87], v[164:167], v[80:95]
    ds_read_b128 v[156:159], v123 offset:768
    v_rcp_f32 v100, v100
    buffer_load_dwordx4 a[252:255], v10, s[28:31], s70 offen offset:1024 sc1
    s_waitcnt lgkmcnt(4)
    v_mfma_f32_32x32x16_bf16 v[80:95], a[88:91], v[168:171], v[80:95]
    ds_read_b128 v[160:163], v124 offset:768
    v_mul_f32 v96, v96, v97
    v_rcp_f32 v102, v102
    v_mul_f32 v98, v98, v99
    v_mfma_f32_32x32x16_bf16 v[80:95], a[92:95], v[172:175], v[80:95]
    ds_read_b128 v[164:167], v125 offset:768
    v_rcp_f32 v104, v104
    v_mul_f32 v100, v100, v101
    v_rcp_f32 v106, v106
    s_waitcnt lgkmcnt(4)
    v_mfma_f32_32x32x16_bf16 v[80:95], a[96:99], v[144:147], v[80:95]
    ds_read_b128 v[168:171], v126 offset:768
    v_mul_f32 v102, v102, v103
    v_rcp_f32 v108, v108
    v_mfma_f32_32x32x16_bf16 v[80:95], a[100:103], v[148:151], v[80:95]
    ds_read_b128 v[172:175], v127 offset:768
    s_add_u32 s70, s70, 196608
    buffer_load_dwordx4 v[192:195], v10, s[28:31], s70 offen offset:0 sc1
    v_mul_f32 v104, v104, v105
    buffer_load_dwordx4 v[196:199], v10, s[28:31], s70 offen offset:1024 sc1
    s_waitcnt lgkmcnt(4)
    v_mfma_f32_32x32x16_bf16 v[80:95], a[104:107], v[152:155], v[80:95]
    s_waitcnt vmcnt(18)
    s_barrier
    ds_read_b128 v[144:147], v120 offset:32768
    v_rcp_f32 v110, v110
    v_mul_f32 v106, v106, v107
    v_mul_f32 v108, v108, v109
    v_mul_f32 v110, v110, v111
    v_cvt_pk_bf16_f32 v112, v96, v98
    v_cvt_pk_bf16_f32 v113, v100, v102
    v_cvt_pk_bf16_f32 v114, v104, v106
    v_cvt_pk_bf16_f32 v115, v108, v110
    buffer_store_dwordx4 v[112:115], v10, s[28:31], s64 offen sc1
    v_mfma_f32_32x32x16_bf16 v[80:95], a[108:111], v[156:159], v[80:95]
    ds_read_b128 v[148:151], v121 offset:32768
    s_waitcnt lgkmcnt(4)
    v_mfma_f32_32x32x16_bf16 v[80:95], a[112:115], v[160:163], v[80:95]
    ds_read_b128 v[152:155], v122 offset:32768
    v_mfma_f32_32x32x16_bf16 v[80:95], a[116:119], v[164:167], v[80:95]
    ds_read_b128 v[156:159], v123 offset:32768
    s_waitcnt lgkmcnt(4)
    v_mfma_f32_32x32x16_bf16 v[80:95], a[120:123], v[168:171], v[80:95]
    ds_read_b128 v[160:163], v124 offset:32768
    s_waitcnt vmcnt(13)
    v_cmp_ne_u32 vcc, s40, v31
    s_nop 0
    s_cbranch_vccnz L_slow_pa_22
L_ok_pa_23:
    v_mfma_f32_32x32x16_bf16 v[80:95], a[124:127], v[172:175], v[80:95]
    ds_read_b128 v[164:167], v125 offset:32768
    s_waitcnt lgkmcnt(4)
    v_mfma_f32_32x32x16_bf16 v[64:79], a[0:3], v[144:147], 0
    ds_read_b128 v[168:171], v126 offset:32768
    v_mfma_f32_32x32x16_bf16 v[64:79], a[4:7], v[148:151], v[64:79]
    ds_read_b128 v[172:175], v127 offset:32768
    s_waitcnt lgkmcnt(4)
    v_mfma_f32_32x32x16_bf16 v[64:79], a[8:11], v[152:155], v[64:79]
    ds_read_b128 v[144:147], v120 offset:33024
    s_add_u32 s70, s70, 196608
    buffer_load_dwordx4 v[200:203], v10, s[28:31], s70 offen offset:0 sc1
    v_mfma_f32_32x32x16_bf16 v[64:79], a[12:15], v[156:159], v[64:79]
    ds_read_b128 v[148:151], v121 offset:33024
    v_mul_f32 v96, s16, v80
    v_mul_f32 v98, s16, v81
    s_waitcnt lgkmcnt(4)
    v_mfma_f32_32x32x16_bf16 v[64:79], a[16:19], v[160:163], v[64:79]
    ds_read_b128 v[152:155], v122 offset:33024
    v_mul_f32 v100, s16, v82
    v_mul_f32 v102, s16, v83
    v_mfma_f32_32x32x16_bf16 v[64:79], a[20:23], v[164:167], v[64:79]
    ds_read_b128 v[156:159], v123 offset:33024
    buffer_load_dwordx4 v[204:207], v10, s[28:31], s70 offen offset:1024 sc1
    v_mul_f32 v104, s16, v88
    v_mul_f32 v106, s16, v89
    s_waitcnt lgkmcnt(4)
    v_mfma_f32_32x32x16_bf16 v[64:79], a[24:27], v[168:171], v[64:79]
    ds_read_b128 v[160:163], v124 offset:33024
    v_mul_f32 v108, s16, v90
    v_mul_f32 v110, s16, v91
    v_mfma_f32_32x32x16_bf16 v[64:79], a[28:31], v[172:175], v[64:79]
    ds_read_b128 v[164:167], v125 offset:33024
    v_exp_f32 v96, v96
    v_mul_f32 v97, v80, v84
    s_waitcnt lgkmcnt(4)
    v_mfma_f32_32x32x16_bf16 v[64:79], a[32:35], v[144:147], v[64:79]
    ds_read_b128 v[168:171], v126 offset:33024
    s_add_u32 s70, s70, 196608
    buffer_load_dwordx4 v[208:211], v10, s[28:31], s70 offen offset:0 sc1
    v_mfma_f32_32x32x16_bf16 v[64:79], a[36:39], v[148:151], v[64:79]
    ds_read_b128 v[172:175], v127 offset:33024
    v_exp_f32 v98, v98
    v_mul_f32 v99, v81, v85
    v_exp_f32 v100, v100
    s_waitcnt lgkmcnt(4)
    v_mfma_f32_32x32x16_bf16 v[64:79], a[40:43], v[152:155], v[64:79]
    ds_read_b128 v[144:147], v120 offset:33280
    v_mul_f32 v101, v82, v86
    v_exp_f32 v102, v102
    v_mul_f32 v103, v83, v87
    v_mfma_f32_32x32x16_bf16 v[64:79], a[44:47], v[156:159], v[64:79]
    ds_read_b128 v[148:151], v121 offset:33280
    buffer_load_dwordx4 v[212:215], v10, s[28:31], s70 offen offset:1024 sc1
    v_exp_f32 v104, v104
    s_waitcnt lgkmcnt(4)
    v_mfma_f32_32x32x16_bf16 v[64:79], a[48:51], v[160:163], v[64:79]
    ds_read_b128 v[152:155], v122 offset:33280
    v_mul_f32 v105, v88, v92
    v_exp_f32 v106, v106
    v_mul_f32 v107, v89, v93
    v_mfma_f32_32x32x16_bf16 v[64:79], a[52:55], v[164:167], v[64:79]
    ds_read_b128 v[156:159], v123 offset:33280
    v_exp_f32 v108, v108
    s_waitcnt lgkmcnt(4)
    v_mfma_f32_32x32x16_bf16 v[64:79], a[56:59], v[168:171], v[64:79]
    ds_read_b128 v[160:163], v124 offset:33280
    s_add_u32 s70, s70, 196608
    buffer_load_dwordx4 v[216:219], v10, s[28:31], s70 offen offset:0 sc1
    v_mfma_f32_32x32x16_bf16 v[64:79], a[60:63], v[172:175], v[64:79]
    ds_read_b128 v[164:167], v125 offset:33280
    v_mul_f32 v109, v90, v94
    v_exp_f32 v110, v110
    v_mul_f32 v111, v91, v95
    v_add_f32 v96, 1.0, v96
    s_waitcnt lgkmcnt(4)
    v_mfma_f32_32x32x16_bf16 v[64:79], a[64:67], v[144:147], v[64:79]
    ds_read_b128 v[168:171], v126 offset:33280
    v_add_f32 v98, 1.0, v98
    v_add_f32 v100, 1.0, v100
    v_mfma_f32_32x32x16_bf16 v[64:79], a[68:71], v[148:151], v[64:79]
    ds_read_b128 v[172:175], v127 offset:33280
    buffer_load_dwordx4 v[220:223], v10, s[28:31], s70 offen offset:1024 sc1
    v_add_f32 v102, 1.0, v102
    v_add_f32 v104, 1.0, v104
    s_waitcnt lgkmcnt(4)
    v_mfma_f32_32x32x16_bf16 v[64:79], a[72:75], v[152:155], v[64:79]
    ds_read_b128 v[144:147], v120 offset:33536
    v_add_f32 v106, 1.0, v106
    v_add_f32 v108, 1.0, v108
    v_add_f32 v110, 1.0, v110
    v_mfma_f32_32x32x16_bf16 v[64:79], a[76:79], v[156:159], v[64:79]
    ds_read_b128 v[148:151], v121 offset:33536
    v_rcp_f32 v96, v96
    s_waitcnt lgkmcnt(4)
    v_mfma_f32_32x32x16_bf16 v[64:79], a[80:83], v[160:163], v[64:79]
    ds_read_b128 v[152:155], v122 offset:33536
    s_add_u32 s70, s70, 196608
    buffer_load_dwordx4 v[224:227], v10, s[28:31], s70 offen offset:0 sc1
    v_mfma_f32_32x32x16_bf16 v[64:79], a[84:87], v[164:167], v[64:79]
    ds_read_b128 v[156:159], v123 offset:33536
    v_rcp_f32 v98, v98
    v_rcp_f32 v100, v100
    v_mul_f32 v96, v96, v97
    s_waitcnt lgkmcnt(4)
    v_mfma_f32_32x32x16_bf16 v[64:79], a[88:91], v[168:171], v[64:79]
    ds_read_b128 v[160:163], v124 offset:33536
    v_rcp_f32 v102, v102
    v_mul_f32 v98, v98, v99
    v_mfma_f32_32x32x16_bf16 v[64:79], a[92:95], v[172:175], v[64:79]
    ds_read_b128 v[164:167], v125 offset:33536
    v_rcp_f32 v104, v104
    buffer_load_dwordx4 v[228:231], v10, s[28:31], s70 offen offset:1024 sc1
    s_waitcnt lgkmcnt(4)
    v_mfma_f32_32x32x16_bf16 v[64:79], a[96:99], v[144:147], v[64:79]
    ds_read_b128 v[168:171], v126 offset:33536
    v_mul_f32 v100, v100, v101
    v_rcp_f32 v106, v106
    v_mul_f32 v102, v102, v103
    v_mfma_f32_32x32x16_bf16 v[64:79], a[100:103], v[148:151], v[64:79]
    ds_read_b128 v[172:175], v127 offset:33536
    v_rcp_f32 v108, v108
    v_mul_f32 v104, v104, v105
    s_add_u32 s70, s10, 1376256
    s_cmp_gt_u32 s6, 1
    s_cselect_b32 s70, 2146435072, s70
    buffer_load_dwordx4 v[232:235], v10, s[28:31], s70 offen offset:0 sc1
    buffer_load_dwordx4 v[236:239], v10, s[28:31], s70 offen offset:1024 sc1
    s_waitcnt lgkmcnt(4)
    v_mfma_f32_32x32x16_bf16 v[64:79], a[104:107], v[152:155], v[64:79]
    s_waitcnt vmcnt(15)
    s_barrier
    ds_read_b128 v[144:147], v128 offset:0
    v_rcp_f32 v110, v110
    v_mul_f32 v106, v106, v107
    v_mul_f32 v108, v108, v109
    v_mul_f32 v110, v110, v111
    v_cvt_pk_bf16_f32 v112, v96, v98
    v_cvt_pk_bf16_f32 v113, v100, v102
    v_cvt_pk_bf16_f32 v114, v104, v106
    v_cvt_pk_bf16_f32 v115, v108, v110
    buffer_store_dwordx4 v[112:115], v10, s[28:31], s65 offen sc1
    v_mfma_f32_32x32x16_bf16 v[64:79], a[108:111], v[156:159], v[64:79]
    ds_read_b128 v[148:151], v129 offset:0
    s_waitcnt lgkmcnt(4)
    v_mfma_f32_32x32x16_bf16 v[64:79], a[112:115], v[160:163], v[64:79]
    ds_read_b128 v[152:155], v130 offset:0
    v_mfma_f32_32x32x16_bf16 v[64:79], a[116:119], v[164:167], v[64:79]
    ds_read_b128 v[156:159], v131 offset:0
    s_waitcnt lgkmcnt(4)
    v_mfma_f32_32x32x16_bf16 v[64:79], a[120:123], v[168:171], v[64:79]
    ds_read_b128 v[160:163], v132 offset:0
    v_mfma_f32_32x32x16_bf16 v[64:79], a[124:127], v[172:175], v[64:79]
    ds_read_b128 v[164:167], v133 offset:0
    s_waitcnt lgkmcnt(4)
    v_mfma_f32_32x32x16_bf16 v[80:95], a[0:3], v[144:147], 0
    ds_read_b128 v[168:171], v134 offset:0
    v_mfma_f32_32x32x16_bf16 v[80:95], a[4:7], v[148:151], v[80:95]
    ds_read_b128 v[172:175], v135 offset:0
    s_waitcnt lgkmcnt(4)
    v_mfma_f32_32x32x16_bf16 v[80:95], a[8:11], v[152:155], v[80:95]
    ds_read_b128 v[144:147], v128 offset:256
    v_mfma_f32_32x32x16_bf16 v[80:95], a[12:15], v[156:159], v[80:95]
    ds_read_b128 v[148:151], v129 offset:256
    s_nop 0
    v_mul_f32 v96, s16, v64
    v_mul_f32 v98, s16, v65
    s_waitcnt lgkmcnt(4)
    v_mfma_f32_32x32x16_bf16 v[80:95], a[16:19], v[160:163], v[80:95]
    ds_read_b128 v[152:155], v130 offset:256
    v_mul_f32 v100, s16, v66
    v_mul_f32 v102, s16, v67
    v_mfma_f32_32x32x16_bf16 v[80:95], a[20:23], v[164:167], v[80:95]
    ds_read_b128 v[156:159], v131 offset:256
    v_mul_f32 v104, s16, v72
    v_mul_f32 v106, s16, v73
    s_waitcnt lgkmcnt(4)
    v_mfma_f32_32x32x16_bf16 v[80:95], a[24:27], v[168:171], v[80:95]
    ds_read_b128 v[160:163], v132 offset:256
    v_mul_f32 v108, s16, v74
    v_mul_f32 v110, s16, v75
    v_mfma_f32_32x32x16_bf16 v[80:95], a[28:31], v[172:175], v[80:95]
    ds_read_b128 v[164:167], v133 offset:256
    v_exp_f32 v96, v96
    v_mul_f32 v97, v64, v68
    s_waitcnt lgkmcnt(4)
    v_mfma_f32_32x32x16_bf16 v[80:95], a[32:35], v[144:147], v[80:95]
    ds_read_b128 v[168:171], v134 offset:256
    s_add_u32 s98, s48, 0
    s_lshl_b32 s98, s98, 12
    s_add_u32 s98, s98, s14
    buffer_load_dwordx4 a[0:3], v10, s[28:31], s98 offen sc1
    v_mfma_f32_32x32x16_bf16 v[80:95], a[36:39], v[148:151], v[80:95]
    ds_read_b128 v[172:175], v135 offset:256
    v_exp_f32 v98, v98
    v_mul_f32 v99, v65, v69
    v_exp_f32 v100, v100
    s_waitcnt lgkmcnt(4)
    v_mfma_f32_32x32x16_bf16 v[80:95], a[40:43], v[152:155], v[80:95]
    ds_read_b128 v[144:147], v128 offset:512
    v_mul_f32 v101, v66, v70
    v_mfma_f32_32x32x16_bf16 v[80:95], a[44:47], v[156:159], v[80:95]
    ds_read_b128 v[148:151], v129 offset:512
    s_add_u32 s98, s98, 12288
    buffer_load_dwordx4 a[4:7], v10, s[28:31], s98 offen sc1
    s_waitcnt lgkmcnt(4)
    v_mfma_f32_32x32x16_bf16 v[80:95], a[48:51], v[160:163], v[80:95]
    ds_read_b128 v[152:155], v130 offset:512
    v_exp_f32 v102, v102
    v_mul_f32 v103, v67, v71
    v_mfma_f32_32x32x16_bf16 v[80:95], a[52:55], v[164:167], v[80:95]
    ds_read_b128 v[156:159], v131 offset:512
    v_exp_f32 v104, v104
    v_mul_f32 v105, v72, v76
    s_waitcnt lgkmcnt(4)
    v_mfma_f32_32x32x16_bf16 v[80:95], a[56:59], v[168:171], v[80:95]
    ds_read_b128 v[160:163], v132 offset:512
    s_add_u32 s98, s98, 12288
    buffer_load_dwordx4 a[8:11], v10, s[28:31], s98 offen sc1
    v_mfma_f32_32x32x16_bf16 v[80:95], a[60:63], v[172:175], v[80:95]
    ds_read_b128 v[164:167], v133 offset:512
    v_exp_f32 v106, v106
    v_mul_f32 v107, v73, v77
    v_exp_f32 v108, v108
    s_waitcnt lgkmcnt(4)
    v_mfma_f32_32x32x16_bf16 v[80:95], a[64:67], v[144:147], v[80:95]
    ds_read_b128 v[168:171], v134 offset:512
    v_mul_f32 v109, v74, v78
    v_mfma_f32_32x32x16_bf16 v[80:95], a[68:71], v[148:151], v[80:95]
    ds_read_b128 v[172:175], v135 offset:512
    s_add_u32 s98, s98, 12288
    buffer_load_dwordx4 a[12:15], v10, s[28:31], s98 offen sc1
    s_waitcnt lgkmcnt(4)
    v_mfma_f32_32x32x16_bf16 v[80:95], a[72:75], v[152:155], v[80:95]
    ds_read_b128 v[144:147], v128 offset:768
    v_exp_f32 v110, v110
    v_mul_f32 v111, v75, v79
    v_add_f32 v96, 1.0, v96
    v_mfma_f32_32x32x16_bf16 v[80:95], a[76:79], v[156:159], v[80:95]
    ds_read_b128 v[148:151], v129 offset:768
    v_add_f32 v98, 1.0, v98
    s_add_u32 s98, s98, 12288
    buffer_load_dwordx4 a[16:19], v10, s[28:31], s98 offen sc1
    s_waitcnt lgkmcnt(4)
    v_mfma_f32_32x32x16_bf16 v[80:95], a[80:83], v[160:163], v[80:95]
    ds_read_b128 v[152:155], v130 offset:768
    v_add_f32 v100, 1.0, v100
    v_add_f32 v102, 1.0, v102
    v_add_f32 v104, 1.0, v104
    v_add_f32 v106, 1.0, v106
    v_mfma_f32_32x32x16_bf16 v[80:95], a[84:87], v[164:167], v[80:95]
    ds_read_b128 v[156:159], v131 offset:768
    s_add_u32 s98, s98, 12288
    buffer_load_dwordx4 a[20:23], v10, s[28:31], s98 offen sc1
    v_add_f32 v108, 1.0, v108
    s_waitcnt lgkmcnt(4)
    v_mfma_f32_32x32x16_bf16 v[80:95], a[88:91], v[168:171], v[80:95]
    ds_read_b128 v[160:163], v132 offset:768
    v_add_f32 v110, 1.0, v110
    v_rcp_f32 v96, v96
    v_mfma_f32_32x32x16_bf16 v[80:95], a[92:95], v[172:175], v[80:95]
    ds_read_b128 v[164:167], v133 offset:768
    v_rcp_f32 v98, v98
    s_waitcnt lgkmcnt(4)
    v_mfma_f32_32x32x16_bf16 v[80:95], a[96:99], v[144:147], v[80:95]
    ds_read_b128 v[168:171], v134 offset:768
    s_add_u32 s98, s98, 12288
    buffer_load_dwordx4 a[24:27], v10, s[28:31], s98 offen sc1
    v_mfma_f32_32x32x16_bf16 v[80:95], a[100:103], v[148:151], v[80:95]
    ds_read_b128 v[172:175], v135 offset:768
    v_rcp_f32 v100, v100
    v_mul_f32 v96, v96, v97
    v_rcp_f32 v102, v102
    s_waitcnt lgkmcnt(4)
    v_mfma_f32_32x32x16_bf16 v[80:95], a[104:107], v[152:155], v[80:95]
    v_mul_f32 v98, v98, v99
    s_add_u32 s98, s48, 0
    s_lshl_b32 s98, s98, 12
    s_add_u32 s98, s98, s14
    buffer_load_dwordx4 a[28:31], v9, s[28:31], s98 offen sc1
    v_rcp_f32 v104, v104
    v_mul_f32 v100, v100, v101
    v_rcp_f32 v106, v106
    v_mul_f32 v102, v102, v103
    v_rcp_f32 v108, v108
    v_mul_f32 v104, v104, v105
    v_rcp_f32 v110, v110
    v_mul_f32 v106, v106, v107
    v_mul_f32 v108, v108, v109
    v_mul_f32 v110, v110, v111
    v_cvt_pk_bf16_f32 v112, v96, v98
    v_cvt_pk_bf16_f32 v113, v100, v102
    v_cvt_pk_bf16_f32 v114, v104, v106
    v_cvt_pk_bf16_f32 v115, v108, v110
    buffer_store_dwordx4 v[112:115], v10, s[28:31], s66 offen sc1
    v_mfma_f32_32x32x16_bf16 v[80:95], a[108:111], v[156:159], v[80:95]
    s_add_u32 s98, s98, 12288
    buffer_load_dwordx4 a[32:35], v9, s[28:31], s98 offen sc1
    s_waitcnt lgkmcnt(2)
    v_mfma_f32_32x32x16_bf16 v[80:95], a[112:115], v[160:163], v[80:95]
    s_add_u32 s98, s98, 12288
    buffer_load_dwordx4 a[36:39], v9, s[28:31], s98 offen sc1
    v_mfma_f32_32x32x16_bf16 v[80:95], a[116:119], v[164:167], v[80:95]
    s_add_u32 s98, s98, 12288
    buffer_load_dwordx4 a[40:43], v9, s[28:31], s98 offen sc1
    s_waitcnt lgkmcnt(0)
    v_mfma_f32_32x32x16_bf16 v[80:95], a[120:123], v[168:171], v[80:95]
    s_add_u32 s98, s98, 12288
    buffer_load_dwordx4 a[44:47], v9, s[28:31], s98 offen sc1
    s_add_u32 s98, s98, 12288
    buffer_load_dwordx4 a[48:51], v9, s[28:31], s98 offen sc1
    s_add_u32 s98, s98, 12288
    buffer_load_dwordx4 a[52:55], v9, s[28:31], s98 offen sc1
    v_mfma_f32_32x32x16_bf16 v[80:95], a[124:127], v[172:175], v[80:95]
    s_nop 11
    v_mul_f32 v96, s16, v80
    v_mul_f32 v98, s16, v81
    v_mul_f32 v100, s16, v82
    v_mul_f32 v102, s16, v83
    v_mul_f32 v104, s16, v88
    v_mul_f32 v106, s16, v89
    v_mul_f32 v108, s16, v90
    v_mul_f32 v110, s16, v91
    v_exp_f32 v96, v96
    v_mul_f32 v97, v80, v84
    s_add_u32 s98, s8, 0
    s_lshl_b32 s98, s98, 12
    s_add_u32 s98, s98, s14
    buffer_load_dwordx4 a[56:59], v10, s[28:31], s98 offen sc1
    v_exp_f32 v98, v98
    v_mul_f32 v99, v81, v85
    v_exp_f32 v100, v100
    v_mul_f32 v101, v82, v86
    v_exp_f32 v102, v102
    v_mul_f32 v103, v83, v87
    v_exp_f32 v104, v104
    v_mul_f32 v105, v88, v92
    v_exp_f32 v106, v106
    v_mul_f32 v107, v89, v93
    s_add_u32 s98, s98, 12288
    buffer_load_dwordx4 a[60:63], v10, s[28:31], s98 offen sc1
    v_exp_f32 v108, v108
    v_mul_f32 v109, v90, v94
    v_exp_f32 v110, v110
    v_mul_f32 v111, v91, v95
    v_add_f32 v96, 1.0, v96
    v_add_f32 v98, 1.0, v98
    v_add_f32 v100, 1.0, v100
    v_add_f32 v102, 1.0, v102
    v_add_f32 v104, 1.0, v104
    v_add_f32 v106, 1.0, v106
    s_add_u32 s98, s98, 12288
    buffer_load_dwordx4 a[64:67], v10, s[28:31], s98 offen sc1
    v_add_f32 v108, 1.0, v108
    v_add_f32 v110, 1.0, v110
    v_rcp_f32 v96, v96
    v_rcp_f32 v98, v98
    v_rcp_f32 v100, v100
    v_mul_f32 v96, v96, v97
    v_rcp_f32 v102, v102
    v_mul_f32 v98, v98, v99
    v_rcp_f32 v104, v104
    v_mul_f32 v100, v100, v101
    v_rcp_f32 v106, v106
    v_mul_f32 v102, v102, v103
    v_rcp_f32 v108, v108
    v_mul_f32 v104, v104, v105
    v_rcp_f32 v110, v110
    v_mul_f32 v106, v106, v107
    v_mul_f32 v108, v108, v109
    v_mul_f32 v110, v110, v111
    v_cvt_pk_bf16_f32 v112, v96, v98
    v_cvt_pk_bf16_f32 v113, v100, v102
    v_cvt_pk_bf16_f32 v114, v104, v106
    v_cvt_pk_bf16_f32 v115, v108, v110
    buffer_store_dwordx4 v[112:115], v10, s[28:31], s67 offen sc1
L_gemm2:
    s_waitcnt vmcnt(18)
    v_mfma_f32_32x32x16_bf16 v[64:79], a[128:131], a[0:3], 0
    s_add_u32 s98, s98, 12288
    buffer_load_dwordx4 a[68:71], v10, s[28:31], s98 offen sc1
    v_mfma_f32_32x32x16_bf16 v[80:95], a[132:135], a[0:3], 0
    s_add_u32 s98, s98, 12288
    buffer_load_dwordx4 a[72:75], v10, s[28:31], s98 offen sc1
    s_waitcnt vmcnt(19)
    v_mfma_f32_32x32x16_bf16 v[64:79], a[136:139], a[4:7], v[64:79]
    s_add_u32 s98, s98, 12288
    buffer_load_dwordx4 a[76:79], v10, s[28:31], s98 offen sc1
    v_mfma_f32_32x32x16_bf16 v[80:95], a[140:143], a[4:7], v[80:95]
    s_add_u32 s98, s98, 12288
    buffer_load_dwordx4 a[80:83], v10, s[28:31], s98 offen sc1
    s_waitcnt vmcnt(20)
    v_mfma_f32_32x32x16_bf16 v[64:79], a[144:147], a[8:11], v[64:79]
    v_mfma_f32_32x32x16_bf16 v[80:95], a[148:151], a[8:11], v[80:95]
    s_waitcnt vmcnt(19)
    v_mfma_f32_32x32x16_bf16 v[64:79], a[152:155], a[12:15], v[64:79]
    v_mfma_f32_32x32x16_bf16 v[80:95], a[156:159], a[12:15], v[80:95]
    s_waitcnt vmcnt(18)
    v_mfma_f32_32x32x16_bf16 v[64:79], a[160:163], a[16:19], v[64:79]
    v_mfma_f32_32x32x16_bf16 v[80:95], a[164:167], a[16:19], v[80:95]
    s_waitcnt vmcnt(17)
    v_mfma_f32_32x32x16_bf16 v[64:79], a[168:171], a[20:23], v[64:79]
    s_add_u32 s98, s8, 0
    s_lshl_b32 s98, s98, 12
    s_add_u32 s98, s98, s14
    buffer_load_dwordx4 a[84:87], v9, s[28:31], s98 offen sc1
    v_mfma_f32_32x32x16_bf16 v[80:95], a[172:175], a[20:23], v[80:95]
    s_add_u32 s98, s98, 12288
    buffer_load_dwordx4 a[88:91], v9, s[28:31], s98 offen sc1
    s_waitcnt vmcnt(18)
    v_mfma_f32_32x32x16_bf16 v[64:79], a[176:179], a[24:27], v[64:79]
    s_add_u32 s98, s98, 12288
    buffer_load_dwordx4 a[92:95], v9, s[28:31], s98 offen sc1
    v_mfma_f32_32x32x16_bf16 v[80:95], a[180:183], a[24:27], v[80:95]
    s_add_u32 s98, s98, 12288
    buffer_load_dwordx4 a[96:99], v9, s[28:31], s98 offen sc1
    s_waitcnt vmcnt(19)
    v_mfma_f32_32x32x16_bf16 v[96:111], a[128:131], a[28:31], 0
    s_add_u32 s98, s98, 12288
    buffer_load_dwordx4 a[100:103], v9, s[28:31], s98 offen sc1
    v_mfma_f32_32x32x16_bf16 v[112:127], a[132:135], a[28:31], 0
    s_add_u32 s98, s98, 12288
    buffer_load_dwordx4 a[104:107], v9, s[28:31], s98 offen sc1
    s_waitcnt vmcnt(19)
    v_mfma_f32_32x32x16_bf16 v[96:111], a[136:139], a[32:35], v[96:111]
    s_add_u32 s98, s98, 12288
    buffer_load_dwordx4 a[108:111], v9, s[28:31], s98 offen sc1
    v_mfma_f32_32x32x16_bf16 v[112:127], a[140:143], a[32:35], v[112:127]
    v_cmp_u_f32 vcc, v64, v64
    s_nop 0
    s_cbranch_vccnz L_again_0_24
L_clean_0_25:
    s_waitcnt vmcnt(19)
    v_mfma_f32_32x32x16_bf16 v[96:111], a[144:147], a[36:39], v[96:111]
    v_mov_b32 v128, v64
    v_mov_b32 v129, v65
    v_mov_b32 v130, v66
    v_mov_b32 v131, v67
    v_mfma_f32_32x32x16_bf16 v[112:127], a[148:151], a[36:39], v[112:127]
    v_mov_b32 v132, v68
    v_mov_b32 v133, v69
    v_mov_b32 v134, v70
    v_mov_b32 v135, v71
    s_waitcnt vmcnt(18)
    v_mfma_f32_32x32x16_bf16 v[96:111], a[152:155], a[40:43], v[96:111]
    v_mov_b32 v136, v72
    v_mov_b32 v137, v73
    v_mov_b32 v138, v74
    v_mov_b32 v139, v75
    v_mfma_f32_32x32x16_bf16 v[112:127], a[156:159], a[40:43], v[112:127]
    v_mov_b32 v140, v76
    v_mov_b32 v141, v77
    v_mov_b32 v142, v78
    v_mov_b32 v143, v79
    s_waitcnt vmcnt(17)
    v_mfma_f32_32x32x16_bf16 v[96:111], a[160:163], a[44:47], v[96:111]
    v_mov_b32 v144, v80
    v_mov_b32 v145, v81
    v_mov_b32 v146, v82
    v_mov_b32 v147, v83
    v_mfma_f32_32x32x16_bf16 v[112:127], a[164:167], a[44:47], v[112:127]
    v_mov_b32 v148, v84
    v_mov_b32 v149, v85
    v_mov_b32 v150, v86
    v_mov_b32 v151, v87
    s_waitcnt vmcnt(16)
    v_mfma_f32_32x32x16_bf16 v[96:111], a[168:171], a[48:51], v[96:111]
    v_mov_b32 v152, v88
    v_mov_b32 v153, v89
    v_mov_b32 v154, v90
    v_mov_b32 v155, v91
    v_mfma_f32_32x32x16_bf16 v[112:127], a[172:175], a[48:51], v[112:127]
    v_mov_b32 v156, v92
    v_mov_b32 v157, v93
    v_mov_b32 v158, v94
    v_mov_b32 v159, v95
    s_waitcnt vmcnt(15)
    v_mfma_f32_32x32x16_bf16 v[96:111], a[176:179], a[52:55], v[96:111]
    v_mfma_f32_32x32x16_bf16 v[112:127], a[180:183], a[52:55], v[112:127]
    s_mov_b32 s22, 337920
    buffer_load_dwordx4 v[32:35], v24, s[28:31], s22 offen sc1
    buffer_load_dwordx4 v[36:39], v24, s[28:31], s22 offen offset:16 sc1
    s_add_u32 s22, s11, 0
    s_lshl_b32 s22, s22, 15
    s_add_u32 s22, s22, 5373952
    buffer_load_dwordx4 v[40:43], v22, s[28:31], s22 offen sc1
    s_add_u32 s22, s11, 1
    s_lshl_b32 s22, s22, 15
    s_add_u32 s22, s22, 5373952
    buffer_load_dwordx4 v[44:47], v22, s[28:31], s22 offen sc1
    s_waitcnt vmcnt(18)
    v_mfma_f32_32x32x16_bf16 v[64:79], a[184:187], a[56:59], v[64:79]
    v_mfma_f32_32x32x16_bf16 v[80:95], a[188:191], a[56:59], v[80:95]
    s_waitcnt vmcnt(17)
    v_mfma_f32_32x32x16_bf16 v[64:79], a[192:195], a[60:63], v[64:79]
    v_mfma_f32_32x32x16_bf16 v[80:95], a[196:199], a[60:63], v[80:95]
    v_cmp_u_f32 vcc, v96, v96
    s_nop 0
    s_cbranch_vccnz L_again_1_26
L_clean_1_27:
    s_waitcnt vmcnt(16)
    v_mfma_f32_32x32x16_bf16 v[64:79], a[200:203], a[64:67], v[64:79]
    v_mov_b32 v160, v96
    v_mov_b32 v161, v97
    v_mov_b32 v162, v98
    v_mov_b32 v163, v99
    v_mfma_f32_32x32x16_bf16 v[80:95], a[204:207], a[64:67], v[80:95]
    v_mov_b32 v164, v100
    v_mov_b32 v165, v101
    v_mov_b32 v166, v102
    v_mov_b32 v167, v103
    s_waitcnt vmcnt(14)
    v_mfma_f32_32x32x16_bf16 v[64:79], a[208:211], a[68:71], v[64:79]
    v_mov_b32 v168, v104
    v_mov_b32 v169, v105
    v_mov_b32 v170, v106
    v_mov_b32 v171, v107
    v_mfma_f32_32x32x16_bf16 v[80:95], a[212:215], a[68:71], v[80:95]
    v_mov_b32 v172, v108
    v_mov_b32 v173, v109
    v_mov_b32 v174, v110
    v_mov_b32 v175, v111
    s_waitcnt vmcnt(13)
    v_mfma_f32_32x32x16_bf16 v[64:79], a[216:219], a[72:75], v[64:79]
    s_add_u32 s98, s9, 0
    s_lshl_b32 s98, s98, 12
    s_add_u32 s98, s98, s14
    buffer_load_dwordx4 a[0:3], v10, s[28:31], s98 offen sc1
    v_mov_b32 v176, v112
    v_mov_b32 v177, v113
    v_mov_b32 v178, v114
    v_mov_b32 v179, v115
    v_mfma_f32_32x32x16_bf16 v[80:95], a[220:223], a[72:75], v[80:95]
    s_add_u32 s98, s98, 12288
    buffer_load_dwordx4 a[4:7], v10, s[28:31], s98 offen sc1
    v_mov_b32 v180, v116
    v_mov_b32 v181, v117
    v_mov_b32 v182, v118
    v_mov_b32 v183, v119
    s_waitcnt vmcnt(14)
    v_mfma_f32_32x32x16_bf16 v[64:79], a[224:227], a[76:79], v[64:79]
    s_add_u32 s98, s98, 12288
    buffer_load_dwordx4 a[8:11], v10, s[28:31], s98 offen sc1
    v_mov_b32 v184, v120
    v_mov_b32 v185, v121
    v_mov_b32 v186, v122
    v_mov_b32 v187, v123
    v_mfma_f32_32x32x16_bf16 v[80:95], a[228:231], a[76:79], v[80:95]
    s_add_u32 s98, s98, 12288
    buffer_load_dwordx4 a[12:15], v10, s[28:31], s98 offen sc1
    v_mov_b32 v188, v124
    v_mov_b32 v189, v125
    v_mov_b32 v190, v126
    v_mov_b32 v191, v127
    s_waitcnt vmcnt(15)
    v_mfma_f32_32x32x16_bf16 v[64:79], a[232:235], a[80:83], v[64:79]
    s_add_u32 s98, s98, 12288
    buffer_load_dwordx4 a[16:19], v10, s[28:31], s98 offen sc1
    v_mfma_f32_32x32x16_bf16 v[80:95], a[236:239], a[80:83], v[80:95]
    s_add_u32 s98, s98, 12288
    buffer_load_dwordx4 a[20:23], v10, s[28:31], s98 offen sc1
    s_waitcnt vmcnt(16)
    v_mfma_f32_32x32x16_bf16 v[96:111], a[184:187], a[84:87], v[96:111]
    s_add_u32 s98, s98, 12288
    buffer_load_dwordx4 a[24:27], v10, s[28:31], s98 offen sc1
    v_mfma_f32_32x32x16_bf16 v[112:127], a[188:191], a[84:87], v[112:127]
    s_add_u32 s98, s14, 86016
    s_cmp_gt_u32 s6, 1
    s_cselect_b32 s98, 2146435072, s98
    buffer_load_dwordx4 a[28:31], v10, s[28:31], s98 offen sc1
    s_waitcnt vmcnt(17)
    v_mfma_f32_32x32x16_bf16 v[96:111], a[192:195], a[88:91], v[96:111]
    v_mfma_f32_32x32x16_bf16 v[112:127], a[196:199], a[88:91], v[112:127]
    v_cmp_u_f32 vcc, v64, v64
    s_nop 0
    s_cbranch_vccnz L_again_2_28
L_clean_2_29:
    s_waitcnt vmcnt(16)
    v_mfma_f32_32x32x16_bf16 v[96:111], a[200:203], a[92:95], v[96:111]
    v_mov_b32 v128, v64
    v_mov_b32 v129, v65
    v_mov_b32 v130, v66
    v_mov_b32 v131, v67
    v_mfma_f32_32x32x16_bf16 v[112:127], a[204:207], a[92:95], v[112:127]
    v_mov_b32 v132, v68
    v_mov_b32 v133, v69
    v_mov_b32 v134, v70
    v_mov_b32 v135, v71
    s_waitcnt vmcnt(15)
    v_mfma_f32_32x32x16_bf16 v[96:111], a[208:211], a[96:99], v[96:111]
    v_mov_b32 v136, v72
    v_mov_b32 v137, v73
    v_mov_b32 v138, v74
    v_mov_b32 v139, v75
    v_mfma_f32_32x32x16_bf16 v[112:127], a[212:215], a[96:99], v[112:127]
    v_mov_b32 v140, v76
    v_mov_b32 v141, v77
    v_mov_b32 v142, v78
    v_mov_b32 v143, v79
    s_waitcnt vmcnt(14)
    v_mfma_f32_32x32x16_bf16 v[96:111], a[216:219], a[100:103], v[96:111]
    v_mov_b32 v144, v80
    v_mov_b32 v145, v81
    v_mov_b32 v146, v82
    v_mov_b32 v147, v83
    v_mfma_f32_32x32x16_bf16 v[112:127], a[220:223], a[100:103], v[112:127]
    v_mov_b32 v148, v84
    v_mov_b32 v149, v85
    v_mov_b32 v150, v86
    v_mov_b32 v151, v87
    s_waitcnt vmcnt(13)
    v_mfma_f32_32x32x16_bf16 v[96:111], a[224:227], a[104:107], v[96:111]
    s_add_u32 s98, s9, 0
    s_lshl_b32 s98, s98, 12
    s_add_u32 s98, s98, s14
    buffer_load_dwordx4 a[32:35], v9, s[28:31], s98 offen sc1
    v_mov_b32 v152, v88
    v_mov_b32 v153, v89
    v_mov_b32 v154, v90
    v_mov_b32 v155, v91
    v_mfma_f32_32x32x16_bf16 v[112:127], a[228:231], a[104:107], v[112:127]
    s_add_u32 s98, s98, 12288
    buffer_load_dwordx4 a[36:39], v9, s[28:31], s98 offen sc1
    v_mov_b32 v156, v92
    v_mov_b32 v157, v93
    v_mov_b32 v158, v94
    v_mov_b32 v159, v95
    s_waitcnt vmcnt(14)
    v_mfma_f32_32x32x16_bf16 v[96:111], a[232:235], a[108:111], v[96:111]
    s_add_u32 s98, s98, 12288
    buffer_load_dwordx4 a[40:43], v9, s[28:31], s98 offen sc1
    v_mfma_f32_32x32x16_bf16 v[112:127], a[236:239], a[108:111], v[112:127]
    s_add_u32 s98, s98, 12288
    buffer_load_dwordx4 a[44:47], v9, s[28:31], s98 offen sc1
    s_add_u32 s98, s98, 12288
    buffer_load_dwordx4 a[48:51], v9, s[28:31], s98 offen sc1
    s_add_u32 s98, s98, 12288
    buffer_load_dwordx4 a[52:55], v9, s[28:31], s98 offen sc1
    s_add_u32 s98, s98, 12288
    buffer_load_dwordx4 a[56:59], v9, s[28:31], s98 offen sc1
    s_add_u32 s98, s14, 86016
    s_cmp_gt_u32 s6, 1
    s_cselect_b32 s98, 2146435072, s98
    buffer_load_dwordx4 a[60:63], v9, s[28:31], s98 offen sc1
    s_waitcnt vmcnt(15)
    v_mfma_f32_32x32x16_bf16 v[64:79], a[240:243], a[0:3], v[64:79]
    v_mfma_f32_32x32x16_bf16 v[80:95], a[244:247], a[0:3], v[80:95]
    s_waitcnt vmcnt(14)
    v_mfma_f32_32x32x16_bf16 v[64:79], a[248:251], a[4:7], v[64:79]
    v_mfma_f32_32x32x16_bf16 v[80:95], a[252:255], a[4:7], v[80:95]
    v_cmp_u_f32 vcc, v96, v96
    s_nop 0
    s_cbranch_vccnz L_again_3_30
L_clean_3_31:
    s_waitcnt vmcnt(13)
    v_mfma_f32_32x32x16_bf16 v[64:79], v[192:195], a[8:11], v[64:79]
    v_mov_b32 v160, v96
    v_mov_b32 v161, v97
    v_mov_b32 v162, v98
    v_mov_b32 v163, v99
    v_mfma_f32_32x32x16_bf16 v[80:95], v[196:199], a[8:11], v[80:95]
    v_mov_b32 v164, v100
    v_mov_b32 v165, v101
    v_mov_b32 v166, v102
    v_mov_b32 v167, v103
    s_waitcnt vmcnt(12)
    v_mfma_f32_32x32x16_bf16 v[64:79], v[200:203], a[12:15], v[64:79]
    v_mov_b32 v168, v104
    v_mov_b32 v169, v105
    v_mov_b32 v170, v106
    v_mov_b32 v171, v107
    v_mfma_f32_32x32x16_bf16 v[80:95], v[204:207], a[12:15], v[80:95]
    v_mov_b32 v172, v108
    v_mov_b32 v173, v109
    v_mov_b32 v174, v110
    v_mov_b32 v175, v111
    s_waitcnt vmcnt(11)
    v_mfma_f32_32x32x16_bf16 v[64:79], v[208:211], a[16:19], v[64:79]
    v_mov_b32 v176, v112
    v_mov_b32 v177, v113
    v_mov_b32 v178, v114
    v_mov_b32 v179, v115
    v_mfma_f32_32x32x16_bf16 v[80:95], v[212:215], a[16:19], v[80:95]
    v_mov_b32 v180, v116
    v_mov_b32 v181, v117
    v_mov_b32 v182, v118
    v_mov_b32 v183, v119
    s_waitcnt vmcnt(10)
    v_mfma_f32_32x32x16_bf16 v[64:79], v[216:219], a[20:23], v[64:79]
    v_mov_b32 v184, v120
    v_mov_b32 v185, v121
    v_mov_b32 v186, v122
    v_mov_b32 v187, v123
    v_mfma_f32_32x32x16_bf16 v[80:95], v[220:223], a[20:23], v[80:95]
    v_mov_b32 v188, v124
    v_mov_b32 v189, v125
    v_mov_b32 v190, v126
    v_mov_b32 v191, v127
    s_waitcnt vmcnt(9)
    v_mfma_f32_32x32x16_bf16 v[64:79], v[224:227], a[24:27], v[64:79]
    v_mfma_f32_32x32x16_bf16 v[80:95], v[228:231], a[24:27], v[80:95]
    s_waitcnt vmcnt(8)
    v_mfma_f32_32x32x16_bf16 v[64:79], v[232:235], a[28:31], v[64:79]
    v_mfma_f32_32x32x16_bf16 v[80:95], v[236:239], a[28:31], v[80:95]
    s_waitcnt vmcnt(7)
    v_mfma_f32_32x32x16_bf16 v[96:111], a[240:243], a[32:35], v[96:111]
    v_mfma_f32_32x32x16_bf16 v[112:127], a[244:247], a[32:35], v[112:127]
    s_waitcnt vmcnt(6)
    v_mfma_f32_32x32x16_bf16 v[96:111], a[248:251], a[36:39], v[96:111]
    v_mfma_f32_32x32x16_bf16 v[112:127], a[252:255], a[36:39], v[112:127]
    s_nop 4
    v_cmp_u_f32 vcc, v64, v64
    s_nop 0
    s_cbranch_vccnz L_again_4_32
L_clean_4_33:
    s_waitcnt vmcnt(5)
    v_mfma_f32_32x32x16_bf16 v[96:111], v[192:195], a[40:43], v[96:111]
    ds_write_b128 v27, v[64:67] offset:0
    v_mfma_f32_32x32x16_bf16 v[112:127], v[196:199], a[40:43], v[112:127]
    ds_write_b128 v28, v[68:71] offset:0
    s_waitcnt vmcnt(4)
    v_mfma_f32_32x32x16_bf16 v[96:111], v[200:203], a[44:47], v[96:111]
    ds_write_b128 v29, v[72:75] offset:0
    v_mfma_f32_32x32x16_bf16 v[112:127], v[204:207], a[44:47], v[112:127]
    ds_write_b128 v30, v[76:79] offset:0
    s_waitcnt vmcnt(3)
    v_mfma_f32_32x32x16_bf16 v[96:111], v[208:211], a[48:51], v[96:111]
    ds_write_b128 v27, v[80:83] offset:128
    v_mfma_f32_32x32x16_bf16 v[112:127], v[212:215], a[48:51], v[112:127]
    ds_write_b128 v28, v[84:87] offset:128
    s_waitcnt vmcnt(2)
    v_mfma_f32_32x32x16_bf16 v[96:111], v[216:219], a[52:55], v[96:111]
    ds_write_b128 v29, v[88:91] offset:128
    v_mfma_f32_32x32x16_bf16 v[112:127], v[220:223], a[52:55], v[112:127]
    ds_write_b128 v30, v[92:95] offset:128
    s_waitcnt vmcnt(1)
    v_mfma_f32_32x32x16_bf16 v[96:111], v[224:227], a[56:59], v[96:111]
    v_mfma_f32_32x32x16_bf16 v[112:127], v[228:231], a[56:59], v[112:127]
    s_waitcnt vmcnt(0)
    v_mfma_f32_32x32x16_bf16 v[96:111], v[232:235], a[60:63], v[96:111]
    v_mfma_f32_32x32x16_bf16 v[112:127], v[236:239], a[60:63], v[112:127]
    s_waitcnt lgkmcnt(0)
    s_barrier
    ds_read_b128 v[128:131], v25 offset:0
    ds_read_b128 v[132:135], v26 offset:0
    ds_read_b128 v[136:139], v25 offset:8192
    ds_read_b128 v[140:143], v26 offset:8192
    ds_read_b128 v[144:147], v25 offset:16384
    ds_read_b128 v[148:151], v26 offset:16384
    ds_read_b128 v[152:155], v25 offset:24576
    ds_read_b128 v[156:159], v26 offset:24576
    s_nop 0
    v_cmp_u_f32 vcc, v96, v96
    s_nop 0
    s_cbranch_vccnz L_again_5_34
L_clean_5_35:
    ds_write_b128 v27, v[96:99] offset:32768
    ds_write_b128 v28, v[100:103] offset:32768
    ds_write_b128 v29, v[104:107] offset:32768
    ds_write_b128 v30, v[108:111] offset:32768
    v_lshlrev_b32 v52, 16, v40
    v_and_b32 v53, 0xffff0000, v40
    v_lshlrev_b32 v54, 16, v41
    v_and_b32 v55, 0xffff0000, v41
    v_lshlrev_b32 v56, 16, v42
    v_and_b32 v57, 0xffff0000, v42
    v_lshlrev_b32 v58, 16, v43
    v_and_b32 v59, 0xffff0000, v43
    s_add_u32 s22, s11, 0
    s_lshl_b32 s22, s22, 10
    s_waitcnt lgkmcnt(8)
    v_pk_add_f32 v[128:129], v[128:129], v[136:137]
    v_pk_add_f32 v[130:131], v[130:131], v[138:139]
    v_pk_add_f32 v[132:133], v[132:133], v[140:141]
    v_pk_add_f32 v[134:135], v[134:135], v[142:143]
    s_waitcnt lgkmcnt(4)
    v_pk_add_f32 v[144:145], v[144:145], v[152:153]
    v_pk_add_f32 v[146:147], v[146:147], v[154:155]
    v_pk_add_f32 v[148:149], v[148:149], v[156:157]
    v_pk_add_f32 v[150:151], v[150:151], v[158:159]
    v_pk_add_f32 v[128:129], v[128:129], v[144:145]
    v_pk_add_f32 v[130:131], v[130:131], v[146:147]
    v_pk_add_f32 v[132:133], v[132:133], v[148:149]
    v_pk_add_f32 v[134:135], v[134:135], v[150:151]
    v_pk_fma_f32 v[52:53], v[128:129], v[32:33], v[52:53]
    v_pk_fma_f32 v[54:55], v[130:131], v[34:35], v[54:55]
    v_pk_fma_f32 v[56:57], v[132:133], v[36:37], v[56:57]
    v_pk_fma_f32 v[58:59], v[134:135], v[38:39], v[58:59]
    v_cvt_pk_bf16_f32 v60, v52, v53
    v_cvt_pk_bf16_f32 v61, v54, v55
    v_cvt_pk_bf16_f32 v62, v56, v57
    v_cvt_pk_bf16_f32 v63, v58, v59
    buffer_store_dwordx4 v[60:63], v23, s[36:39], s22 offen
    ds_write_b128 v27, v[112:115] offset:32896
    ds_write_b128 v28, v[116:119] offset:32896
    ds_write_b128 v29, v[120:123] offset:32896
    ds_write_b128 v30, v[124:127] offset:32896
    s_waitcnt lgkmcnt(0)
    s_barrier
    ds_read_b128 v[128:131], v25 offset:32768
    ds_read_b128 v[132:135], v26 offset:32768
    ds_read_b128 v[136:139], v25 offset:40960
    ds_read_b128 v[140:143], v26 offset:40960
    ds_read_b128 v[144:147], v25 offset:49152
    ds_read_b128 v[148:151], v26 offset:49152
    ds_read_b128 v[152:155], v25 offset:57344
    ds_read_b128 v[156:159], v26 offset:57344
    v_lshlrev_b32 v52, 16, v44
    v_and_b32 v53, 0xffff0000, v44
    v_lshlrev_b32 v54, 16, v45
    v_and_b32 v55, 0xffff0000, v45
    v_lshlrev_b32 v56, 16, v46
    v_and_b32 v57, 0xffff0000, v46
    v_lshlrev_b32 v58, 16, v47
    v_and_b32 v59, 0xffff0000, v47
    s_add_u32 s22, s11, 1
    s_lshl_b32 s22, s22, 10
    s_waitcnt lgkmcnt(4)
    v_pk_add_f32 v[128:129], v[128:129], v[136:137]
    v_pk_add_f32 v[130:131], v[130:131], v[138:139]
    v_pk_add_f32 v[132:133], v[132:133], v[140:141]
    v_pk_add_f32 v[134:135], v[134:135], v[142:143]
    s_waitcnt lgkmcnt(0)
    v_pk_add_f32 v[144:145], v[144:145], v[152:153]
    v_pk_add_f32 v[146:147], v[146:147], v[154:155]
    v_pk_add_f32 v[148:149], v[148:149], v[156:157]
    v_pk_add_f32 v[150:151], v[150:151], v[158:159]
    v_pk_add_f32 v[128:129], v[128:129], v[144:145]
    v_pk_add_f32 v[130:131], v[130:131], v[146:147]
    v_pk_add_f32 v[132:133], v[132:133], v[148:149]
    v_pk_add_f32 v[134:135], v[134:135], v[150:151]
    v_pk_fma_f32 v[52:53], v[128:129], v[32:33], v[52:53]
    v_pk_fma_f32 v[54:55], v[130:131], v[34:35], v[54:55]
    v_pk_fma_f32 v[56:57], v[132:133], v[36:37], v[56:57]
    v_pk_fma_f32 v[58:59], v[134:135], v[38:39], v[58:59]
    v_cvt_pk_bf16_f32 v60, v52, v53
    v_cvt_pk_bf16_f32 v61, v54, v55
    v_cvt_pk_bf16_f32 v62, v56, v57
    v_cvt_pk_bf16_f32 v63, v58, v59
    buffer_store_dwordx4 v[60:63], v23, s[36:39], s22 offen
L_end:
    s_endpgm
L_nogemm1:
    s_mul_i32 s22, s49, 88
    s_add_u32 s22, s22, s6
    s_mul_i32 s22, s22, 128
    s_add_u32 s22, s22, 65536
    v_min_u32 v6, 21, v1
    v_mul_u32_u24 v6, 512, v6
    v_add_u32 v17, s22, v6
    v_bfe_u32 v8, v1, 2, 1
    v_mul_u32_u24 v8, 512, v8
    v_and_b32 v9, 3, v1
    v_lshl_add_u32 v8, v9, 2, v8
    s_lshl_b32 s22, s11, 2
    s_add_u32 s22, s22, s6
    s_mul_i32 s22, s22, 128
    s_add_u32 s22, s22, 262144
    v_add_u32 v8, s22, v8
    v_cmp_lt_u32 vcc, 23, v1
    s_nop 1
    v_cndmask_b32 v17, v17, v8, vcc
    s_add_u32 s22, s47, 40
    s_mul_i32 s22, s22, 128
    s_add_u32 s22, s22, 20480
    v_mov_b32 v8, s22
    v_cmp_lt_u32 vcc, 31, v1
    s_nop 1
    v_cndmask_b32 v17, v17, v8, vcc
    v_lshrrev_b32 v6, 3, v1
    s_lshl_b32 s22, s6, 3
    v_add_u32 v6, s22, v6
    v_and_b32 v7, 7, v1
    v_lshlrev_b32 v8, 4, v7
    s_lshl_b32 s22, s47, 7
    v_add_u32 v8, s22, v8
    v_lshl_add_u32 v22, v6, 10, v8
    v_lshl_add_u32 v23, v6, 16, v8
    v_lshlrev_b32 v24, 1, v8
    v_and_b32 v8, 7, v6
    v_lshlrev_b32 v7, 1, v7
    v_xor_b32 v7, v7, v8
    v_lshlrev_b32 v7, 4, v7
    v_lshl_add_u32 v25, v6, 8, v7
    v_xor_b32 v26, 16, v25
    v_and_b32 v6, 31, v1
    v_lshrrev_b32 v7, 5, v1
    v_and_b32 v8, 7, v1
    v_xor_b32 v7, v7, v8
    v_lshlrev_b32 v7, 4, v7
    v_lshl_add_u32 v7, v6, 8, v7
    s_lshl_b32 s22, s6, 13
    v_add_u32 v27, s22, v7
    v_xor_b32 v28, 32, v27
    v_xor_b32 v29, 64, v27
    v_xor_b32 v30, 0x60, v27
    v_add_u32 v9, 88064, v10
    buffer_store_dword v11, v12, s[28:31], s17 offen sc1
    s_add_u32 s70, s70, 196608
    buffer_load_dwordx4 a[192:195], v10, s[28:31], s70 offen offset:0 sc1
    buffer_load_dwordx4 a[196:199], v10, s[28:31], s70 offen offset:1024 sc1
    s_add_u32 s70, s70, 196608
    buffer_load_dwordx4 a[200:203], v10, s[28:31], s70 offen offset:0 sc1
    buffer_load_dwordx4 a[204:207], v10, s[28:31], s70 offen offset:1024 sc1
    s_add_u32 s70, s70, 196608
    buffer_load_dwordx4 a[208:211], v10, s[28:31], s70 offen offset:0 sc1
    buffer_load_dwordx4 a[212:215], v10, s[28:31], s70 offen offset:1024 sc1
    s_add_u32 s70, s70, 196608
    buffer_load_dwordx4 a[216:219], v10, s[28:31], s70 offen offset:0 sc1
    buffer_load_dwordx4 a[220:223], v10, s[28:31], s70 offen offset:1024 sc1
    s_add_u32 s70, s70, 196608
    buffer_load_dwordx4 a[224:227], v10, s[28:31], s70 offen offset:0 sc1
    buffer_load_dwordx4 a[228:231], v10, s[28:31], s70 offen offset:1024 sc1
    s_add_u32 s70, s70, 196608
    buffer_load_dwordx4 a[232:235], v10, s[28:31], s70 offen offset:0 sc1
    buffer_load_dwordx4 a[236:239], v10, s[28:31], s70 offen offset:1024 sc1
    s_add_u32 s70, s9, 0
    s_lshl_b32 s70, s70, 16
    s_add_u32 s70, s70, s10
    buffer_load_dwordx4 a[240:243], v10, s[28:31], s70 offen offset:0 sc1
    buffer_load_dwordx4 a[244:247], v10, s[28:31], s70 offen offset:1024 sc1
    s_add_u32 s70, s70, 196608
    buffer_load_dwordx4 a[248:251], v10, s[28:31], s70 offen offset:0 sc1
    buffer_load_dwordx4 a[252:255], v10, s[28:31], s70 offen offset:1024 sc1
    s_add_u32 s70, s70, 196608
    buffer_load_dwordx4 v[192:195], v10, s[28:31], s70 offen offset:0 sc1
    buffer_load_dwordx4 v[196:199], v10, s[28:31], s70 offen offset:1024 sc1
    s_add_u32 s70, s70, 196608
    buffer_load_dwordx4 v[200:203], v10, s[28:31], s70 offen offset:0 sc1
    buffer_load_dwordx4 v[204:207], v10, s[28:31], s70 offen offset:1024 sc1
    s_add_u32 s70, s70, 196608
    buffer_load_dwordx4 v[208:211], v10, s[28:31], s70 offen offset:0 sc1
    buffer_load_dwordx4 v[212:215], v10, s[28:31], s70 offen offset:1024 sc1
    s_add_u32 s70, s70, 196608
    buffer_load_dwordx4 v[216:219], v10, s[28:31], s70 offen offset:0 sc1
    buffer_load_dwordx4 v[220:223], v10, s[28:31], s70 offen offset:1024 sc1
    s_add_u32 s70, s70, 196608
    buffer_load_dwordx4 v[224:227], v10, s[28:31], s70 offen offset:0 sc1
    buffer_load_dwordx4 v[228:231], v10, s[28:31], s70 offen offset:1024 sc1
    s_add_u32 s70, s10, 1376256
    s_cmp_gt_u32 s6, 1
    s_cselect_b32 s70, 2146435072, s70
    buffer_load_dwordx4 v[232:235], v10, s[28:31], s70 offen offset:0 sc1
    buffer_load_dwordx4 v[236:239], v10, s[28:31], s70 offen offset:1024 sc1
    s_cmp_eq_u32 s2, 255
    s_cbranch_scc0 L_noslot_36
    v_mul_u32_u24 v2, 128, v0
    v_add_u32 v2, 32768, v2
    s_mov_b32 s55, 200000
L_poll_slot_37:
    buffer_load_dword v3, v2, s[28:31], 0 offen sc1
    s_waitcnt vmcnt(0)
    v_cmp_ne_u32 vcc, s40, v3
    s_nop 0
    s_cbranch_vccz L_pd_slot_38
    s_sub_u32 s55, s55, 1
    s_cbranch_scc0 L_poll_slot_37
L_pd_slot_38:
    s_barrier
    s_mov_b32 s22, 0
    s_cmp_lg_u32 s6, 0
    s_cbranch_scc1 L_nf_39
    v_mov_b32 v3, s40
    v_mov_b32 v12, 0
    s_mov_b64 exec, 1
    buffer_store_dword v3, v12, s[28:31], s22 offen sc1
    s_mov_b64 exec, -1
L_nf_39:
L_noslot_36:
    s_mov_b32 s55, 200000
L_poll_na_40:
    buffer_load_dword v31, v17, s[28:31], 0 offen sc1
    s_waitcnt vmcnt(0)
    v_cmp_ne_u32 vcc, s40, v31
    s_nop 0
    s_cbranch_vccz L_pd_na_41
    s_sub_u32 s55, s55, 1
    s_cbranch_scc0 L_poll_na_40
L_pd_na_41:
    s_mov_b32 s55, 200000
    s_lshl_b32 s68, s48, 12
    s_add_u32 s68, s68, s14
    s_add_u32 s68, s68, 0
    v_min_u32 v48, 6, v1
    v_mul_u32_u24 v48, 12288, v48
    v_add_u32 v48, s68, v48
L_lp_42:
    buffer_load_dword v49, v48, s[28:31], 0 offen offset:1020 sc1
    s_waitcnt vmcnt(0)
    v_cmp_eq_u32 vcc, -1, v49
    s_nop 0
    s_cbranch_vccz L_lpd_43
    s_sub_u32 s55, s55, 1
    s_cbranch_scc0 L_lp_42
L_lpd_43:
    s_add_u32 s98, s48, 0
    s_lshl_b32 s98, s98, 12
    s_add_u32 s98, s98, s14
    buffer_load_dwordx4 a[0:3], v10, s[28:31], s98 offen sc1
    s_add_u32 s98, s98, 12288
    buffer_load_dwordx4 a[4:7], v10, s[28:31], s98 offen sc1
    s_add_u32 s98, s98, 12288
    buffer_load_dwordx4 a[8:11], v10, s[28:31], s98 offen sc1
    s_add_u32 s98, s98, 12288
    buffer_load_dwordx4 a[12:15], v10, s[28:31], s98 offen sc1
    s_add_u32 s98, s98, 12288
    buffer_load_dwordx4 a[16:19], v10, s[28:31], s98 offen sc1
    s_add_u32 s98, s98, 12288
    buffer_load_dwordx4 a[20:23], v10, s[28:31], s98 offen sc1
    s_add_u32 s98, s98, 12288
    buffer_load_dwordx4 a[24:27], v10, s[28:31], s98 offen sc1
    s_lshl_b32 s68, s48, 12
    s_add_u32 s68, s68, s14
    s_add_u32 s68, s68, 88064
    v_min_u32 v48, 6, v1
    v_mul_u32_u24 v48, 12288, v48
    v_add_u32 v48, s68, v48
L_lp_44:
    buffer_load_dword v49, v48, s[28:31], 0 offen offset:1020 sc1
    s_waitcnt vmcnt(0)
    v_cmp_eq_u32 vcc, -1, v49
    s_nop 0
    s_cbranch_vccz L_lpd_45
    s_sub_u32 s55, s55, 1
    s_cbranch_scc0 L_lp_44
L_lpd_45:
    s_add_u32 s98, s48, 0
    s_lshl_b32 s98, s98, 12
    s_add_u32 s98, s98, s14
    buffer_load_dwordx4 a[28:31], v9, s[28:31], s98 offen sc1
    s_add_u32 s98, s98, 12288
    buffer_load_dwordx4 a[32:35], v9, s[28:31], s98 offen sc1
    s_add_u32 s98, s98, 12288
    buffer_load_dwordx4 a[36:39], v9, s[28:31], s98 offen sc1
    s_add_u32 s98, s98, 12288
    buffer_load_dwordx4 a[40:43], v9, s[28:31], s98 offen sc1
    s_add_u32 s98, s98, 12288
    buffer_load_dwordx4 a[44:47], v9, s[28:31], s98 offen sc1
    s_add_u32 s98, s98, 12288
    buffer_load_dwordx4 a[48:51], v9, s[28:31], s98 offen sc1
    s_add_u32 s98, s98, 12288
    buffer_load_dwordx4 a[52:55], v9, s[28:31], s98 offen sc1
    s_lshl_b32 s68, s8, 12
    s_add_u32 s68, s68, s14
    s_add_u32 s68, s68, 0
    v_min_u32 v48, 6, v1
    v_mul_u32_u24 v48, 12288, v48
    v_add_u32 v48, s68, v48
L_lp_46:
    buffer_load_dword v49, v48, s[28:31], 0 offen offset:1020 sc1
    s_waitcnt vmcnt(0)
    v_cmp_eq_u32 vcc, -1, v49
    s_nop 0
    s_cbranch_vccz L_lpd_47
    s_sub_u32 s55, s55, 1
    s_cbranch_scc0 L_lp_46
L_lpd_47:
    s_add_u32 s98, s8, 0
    s_lshl_b32 s98, s98, 12
    s_add_u32 s98, s98, s14
    buffer_load_dwordx4 a[56:59], v10, s[28:31], s98 offen sc1
    s_add_u32 s98, s98, 12288
    buffer_load_dwordx4 a[60:63], v10, s[28:31], s98 offen sc1
    s_add_u32 s98, s98, 12288
    buffer_load_dwordx4 a[64:67], v10, s[28:31], s98 offen sc1
    s_lshl_b32 s68, s8, 12
    s_add_u32 s68, s68, s14
    s_add_u32 s68, s68, 88064
    v_min_u32 v48, 6, v1
    v_mul_u32_u24 v48, 12288, v48
    v_add_u32 v48, s68, v48
L_lp_48:
    buffer_load_dword v49, v48, s[28:31], 0 offen offset:1020 sc1
    s_waitcnt vmcnt(0)
    v_cmp_eq_u32 vcc, -1, v49
    s_nop 0
    s_cbranch_vccz L_lpd_49
    s_sub_u32 s55, s55, 1
    s_cbranch_scc0 L_lp_48
L_lpd_49:
    s_branch L_gemm2
L_again_0_24:
    s_mov_b32 s55, 20000
L_ag_50:
    s_lshl_b32 s68, s48, 12
    s_add_u32 s68, s68, s14
    s_add_u32 s68, s68, 0
    v_min_u32 v48, 6, v1
    v_mul_u32_u24 v48, 12288, v48
    v_add_u32 v48, s68, v48
L_lp_51:
    buffer_load_dword v49, v48, s[28:31], 0 offen offset:1020 sc1
    s_waitcnt vmcnt(0)
    v_cmp_eq_u32 vcc, -1, v49
    s_nop 0
    s_cbranch_vccz L_lpd_52
    s_sub_u32 s55, s55, 1
    s_cbranch_scc0 L_lp_51
    s_branch L_clean_0_25
L_lpd_52:
    s_add_u32 s68, s48, 0
    s_lshl_b32 s68, s68, 12
    s_add_u32 s68, s68, s14
    buffer_load_dwordx4 a[0:3], v10, s[28:31], s68 offen sc1
    s_add_u32 s68, s68, 12288
    buffer_load_dwordx4 a[4:7], v10, s[28:31], s68 offen sc1
    s_add_u32 s68, s68, 12288
    buffer_load_dwordx4 a[8:11], v10, s[28:31], s68 offen sc1
    s_add_u32 s68, s68, 12288
    buffer_load_dwordx4 a[12:15], v10, s[28:31], s68 offen sc1
    s_add_u32 s68, s68, 12288
    buffer_load_dwordx4 a[16:19], v10, s[28:31], s68 offen sc1
    s_add_u32 s68, s68, 12288
    buffer_load_dwordx4 a[20:23], v10, s[28:31], s68 offen sc1
    s_add_u32 s68, s68, 12288
    buffer_load_dwordx4 a[24:27], v10, s[28:31], s68 offen sc1
    s_waitcnt vmcnt(6)
    v_mfma_f32_32x32x16_bf16 v[64:79], a[128:131], a[0:3], 0
    v_mfma_f32_32x32x16_bf16 v[80:95], a[132:135], a[0:3], 0
    s_waitcnt vmcnt(5)
    v_mfma_f32_32x32x16_bf16 v[64:79], a[136:139], a[4:7], v[64:79]
    v_mfma_f32_32x32x16_bf16 v[80:95], a[140:143], a[4:7], v[80:95]
    s_waitcnt vmcnt(4)
    v_mfma_f32_32x32x16_bf16 v[64:79], a[144:147], a[8:11], v[64:79]
    v_mfma_f32_32x32x16_bf16 v[80:95], a[148:151], a[8:11], v[80:95]
    s_waitcnt vmcnt(3)
    v_mfma_f32_32x32x16_bf16 v[64:79], a[152:155], a[12:15], v[64:79]
    v_mfma_f32_32x32x16_bf16 v[80:95], a[156:159], a[12:15], v[80:95]
    s_waitcnt vmcnt(2)
    v_mfma_f32_32x32x16_bf16 v[64:79], a[160:163], a[16:19], v[64:79]
    v_mfma_f32_32x32x16_bf16 v[80:95], a[164:167], a[16:19], v[80:95]
    s_waitcnt vmcnt(1)
    v_mfma_f32_32x32x16_bf16 v[64:79], a[168:171], a[20:23], v[64:79]
    v_mfma_f32_32x32x16_bf16 v[80:95], a[172:175], a[20:23], v[80:95]
    s_waitcnt vmcnt(0)
    v_mfma_f32_32x32x16_bf16 v[64:79], a[176:179], a[24:27], v[64:79]
    v_mfma_f32_32x32x16_bf16 v[80:95], a[180:183], a[24:27], v[80:95]
    s_nop 10
    v_cmp_u_f32 vcc, v64, v64
    s_nop 0
    s_cbranch_vccz L_clean_0_25
    s_sub_u32 s55, s55, 1
    s_cbranch_scc0 L_ag_50
    s_branch L_clean_0_25
L_again_1_26:
    s_mov_b32 s55, 20000
L_ag_53:
    s_lshl_b32 s68, s48, 12
    s_add_u32 s68, s68, s14
    s_add_u32 s68, s68, 88064
    v_min_u32 v48, 6, v1
    v_mul_u32_u24 v48, 12288, v48
    v_add_u32 v48, s68, v48
L_lp_54:
    buffer_load_dword v49, v48, s[28:31], 0 offen offset:1020 sc1
    s_waitcnt vmcnt(0)
    v_cmp_eq_u32 vcc, -1, v49
    s_nop 0
    s_cbranch_vccz L_lpd_55
    s_sub_u32 s55, s55, 1
    s_cbranch_scc0 L_lp_54
    s_branch L_clean_1_27
L_lpd_55:
    s_add_u32 s68, s48, 0
    s_lshl_b32 s68, s68, 12
    s_add_u32 s68, s68, s14
    buffer_load_dwordx4 a[28:31], v9, s[28:31], s68 offen sc1
    s_add_u32 s68, s68, 12288
    buffer_load_dwordx4 a[32:35], v9, s[28:31], s68 offen sc1
    s_add_u32 s68, s68, 12288
    buffer_load_dwordx4 a[36:39], v9, s[28:31], s68 offen sc1
    s_add_u32 s68, s68, 12288
    buffer_load_dwordx4 a[40:43], v9, s[28:31], s68 offen sc1
    s_add_u32 s68, s68, 12288
    buffer_load_dwordx4 a[44:47], v9, s[28:31], s68 offen sc1
    s_add_u32 s68, s68, 12288
    buffer_load_dwordx4 a[48:51], v9, s[28:31], s68 offen sc1
    s_add_u32 s68, s68, 12288
    buffer_load_dwordx4 a[52:55], v9, s[28:31], s68 offen sc1
    s_waitcnt vmcnt(6)
    v_mfma_f32_32x32x16_bf16 v[96:111], a[128:131], a[28:31], 0
    v_mfma_f32_32x32x16_bf16 v[112:127], a[132:135], a[28:31], 0
    s_waitcnt vmcnt(5)
    v_mfma_f32_32x32x16_bf16 v[96:111], a[136:139], a[32:35], v[96:111]
    v_mfma_f32_32x32x16_bf16 v[112:127], a[140:143], a[32:35], v[112:127]
    s_waitcnt vmcnt(4)
    v_mfma_f32_32x32x16_bf16 v[96:111], a[144:147], a[36:39], v[96:111]
    v_mfma_f32_32x32x16_bf16 v[112:127], a[148:151], a[36:39], v[112:127]
    s_waitcnt vmcnt(3)
    v_mfma_f32_32x32x16_bf16 v[96:111], a[152:155], a[40:43], v[96:111]
    v_mfma_f32_32x32x16_bf16 v[112:127], a[156:159], a[40:43], v[112:127]
    s_waitcnt vmcnt(2)
    v_mfma_f32_32x32x16_bf16 v[96:111], a[160:163], a[44:47], v[96:111]
    v_mfma_f32_32x32x16_bf16 v[112:127], a[164:167], a[44:47], v[112:127]
    s_waitcnt vmcnt(1)
    v_mfma_f32_32x32x16_bf16 v[96:111], a[168:171], a[48:51], v[96:111]
    v_mfma_f32_32x32x16_bf16 v[112:127], a[172:175], a[48:51], v[112:127]
    s_waitcnt vmcnt(0)
    v_mfma_f32_32x32x16_bf16 v[96:111], a[176:179], a[52:55], v[96:111]
    v_mfma_f32_32x32x16_bf16 v[112:127], a[180:183], a[52:55], v[112:127]
    s_nop 10
    v_cmp_u_f32 vcc, v96, v96
    s_nop 0
    s_cbranch_vccz L_clean_1_27
    s_sub_u32 s55, s55, 1
    s_cbranch_scc0 L_ag_53
    s_branch L_clean_1_27
L_again_2_28:
    s_mov_b32 s55, 20000
L_ag_56:
    s_lshl_b32 s68, s8, 12
    s_add_u32 s68, s68, s14
    s_add_u32 s68, s68, 0
    v_min_u32 v48, 6, v1
    v_mul_u32_u24 v48, 12288, v48
    v_add_u32 v48, s68, v48
L_lp_57:
    buffer_load_dword v49, v48, s[28:31], 0 offen offset:1020 sc1
    s_waitcnt vmcnt(0)
    v_cmp_eq_u32 vcc, -1, v49
    s_nop 0
    s_cbranch_vccz L_lpd_58
    s_sub_u32 s55, s55, 1
    s_cbranch_scc0 L_lp_57
    s_branch L_clean_2_29
L_lpd_58:
    s_add_u32 s68, s8, 0
    s_lshl_b32 s68, s68, 12
    s_add_u32 s68, s68, s14
    buffer_load_dwordx4 a[56:59], v10, s[28:31], s68 offen sc1
    s_add_u32 s68, s68, 12288
    buffer_load_dwordx4 a[60:63], v10, s[28:31], s68 offen sc1
    s_add_u32 s68, s68, 12288
    buffer_load_dwordx4 a[64:67], v10, s[28:31], s68 offen sc1
    s_add_u32 s68, s68, 12288
    buffer_load_dwordx4 a[68:71], v10, s[28:31], s68 offen sc1
    s_add_u32 s68, s68, 12288
    buffer_load_dwordx4 a[72:75], v10, s[28:31], s68 offen sc1
    s_add_u32 s68, s68, 12288
    buffer_load_dwordx4 a[76:79], v10, s[28:31], s68 offen sc1
    s_add_u32 s68, s68, 12288
    buffer_load_dwordx4 a[80:83], v10, s[28:31], s68 offen sc1
    v_mov_b64 v[64:65], v[128:129]
    v_mov_b64 v[66:67], v[130:131]
    v_mov_b64 v[68:69], v[132:133]
    v_mov_b64 v[70:71], v[134:135]
    v_mov_b64 v[72:73], v[136:137]
    v_mov_b64 v[74:75], v[138:139]
    v_mov_b64 v[76:77], v[140:141]
    v_mov_b64 v[78:79], v[142:143]
    v_mov_b64 v[80:81], v[144:145]
    v_mov_b64 v[82:83], v[146:147]
    v_mov_b64 v[84:85], v[148:149]
    v_mov_b64 v[86:87], v[150:151]
    v_mov_b64 v[88:89], v[152:153]
    v_mov_b64 v[90:91], v[154:155]
    v_mov_b64 v[92:93], v[156:157]
    v_mov_b64 v[94:95], v[158:159]
    s_waitcnt vmcnt(6)
    v_mfma_f32_32x32x16_bf16 v[64:79], a[184:187], a[56:59], v[64:79]
    v_mfma_f32_32x32x16_bf16 v[80:95], a[188:191], a[56:59], v[80:95]
    s_waitcnt vmcnt(5)
    v_mfma_f32_32x32x16_bf16 v[64:79], a[192:195], a[60:63], v[64:79]
    v_mfma_f32_32x32x16_bf16 v[80:95], a[196:199], a[60:63], v[80:95]
    s_waitcnt vmcnt(4)
    v_mfma_f32_32x32x16_bf16 v[64:79], a[200:203], a[64:67], v[64:79]
    v_mfma_f32_32x32x16_bf16 v[80:95], a[204:207], a[64:67], v[80:95]
    s_waitcnt vmcnt(3)
    v_mfma_f32_32x32x16_bf16 v[64:79], a[208:211], a[68:71], v[64:79]
    v_mfma_f32_32x32x16_bf16 v[80:95], a[212:215], a[68:71], v[80:95]
    s_waitcnt vmcnt(2)
    v_mfma_f32_32x32x16_bf16 v[64:79], a[216:219], a[72:75], v[64:79]
    v_mfma_f32_32x32x16_bf16 v[80:95], a[220:223], a[72:75], v[80:95]
    s_waitcnt vmcnt(1)
    v_mfma_f32_32x32x16_bf16 v[64:79], a[224:227], a[76:79], v[64:79]
    v_mfma_f32_32x32x16_bf16 v[80:95], a[228:231], a[76:79], v[80:95]
    s_waitcnt vmcnt(0)
    v_mfma_f32_32x32x16_bf16 v[64:79], a[232:235], a[80:83], v[64:79]
    v_mfma_f32_32x32x16_bf16 v[80:95], a[236:239], a[80:83], v[80:95]
    s_nop 10
    v_cmp_u_f32 vcc, v64, v64
    s_nop 0
    s_cbranch_vccz L_clean_2_29
    s_sub_u32 s55, s55, 1
    s_cbranch_scc0 L_ag_56
    s_branch L_clean_2_29
L_again_3_30:
    s_mov_b32 s55, 20000
L_ag_59:
    s_lshl_b32 s68, s8, 12
    s_add_u32 s68, s68, s14
    s_add_u32 s68, s68, 88064
    v_min_u32 v48, 6, v1
    v_mul_u32_u24 v48, 12288, v48
    v_add_u32 v48, s68, v48
L_lp_60:
    buffer_load_dword v49, v48, s[28:31], 0 offen offset:1020 sc1
    s_waitcnt vmcnt(0)
    v_cmp_eq_u32 vcc, -1, v49
    s_nop 0
    s_cbranch_vccz L_lpd_61
    s_sub_u32 s55, s55, 1
    s_cbranch_scc0 L_lp_60
    s_branch L_clean_3_31
L_lpd_61:
    s_add_u32 s68, s8, 0
    s_lshl_b32 s68, s68, 12
    s_add_u32 s68, s68, s14
    buffer_load_dwordx4 a[84:87], v9, s[28:31], s68 offen sc1
    s_add_u32 s68, s68, 12288
    buffer_load_dwordx4 a[88:91], v9, s[28:31], s68 offen sc1
    s_add_u32 s68, s68, 12288
    buffer_load_dwordx4 a[92:95], v9, s[28:31], s68 offen sc1
    s_add_u32 s68, s68, 12288
    buffer_load_dwordx4 a[96:99], v9, s[28:31], s68 offen sc1
    s_add_u32 s68, s68, 12288
    buffer_load_dwordx4 a[100:103], v9, s[28:31], s68 offen sc1
    s_add_u32 s68, s68, 12288
    buffer_load_dwordx4 a[104:107], v9, s[28:31], s68 offen sc1
    s_add_u32 s68, s68, 12288
    buffer_load_dwordx4 a[108:111], v9, s[28:31], s68 offen sc1
    v_mov_b64 v[96:97], v[160:161]
    v_mov_b64 v[98:99], v[162:163]
    v_mov_b64 v[100:101], v[164:165]
    v_mov_b64 v[102:103], v[166:167]
    v_mov_b64 v[104:105], v[168:169]
    v_mov_b64 v[106:107], v[170:171]
    v_mov_b64 v[108:109], v[172:173]
    v_mov_b64 v[110:111], v[174:175]
    v_mov_b64 v[112:113], v[176:177]
    v_mov_b64 v[114:115], v[178:179]
    v_mov_b64 v[116:117], v[180:181]
    v_mov_b64 v[118:119], v[182:183]
    v_mov_b64 v[120:121], v[184:185]
    v_mov_b64 v[122:123], v[186:187]
    v_mov_b64 v[124:125], v[188:189]
    v_mov_b64 v[126:127], v[190:191]
    s_waitcnt vmcnt(6)
    v_mfma_f32_32x32x16_bf16 v[96:111], a[184:187], a[84:87], v[96:111]
    v_mfma_f32_32x32x16_bf16 v[112:127], a[188:191], a[84:87], v[112:127]
    s_waitcnt vmcnt(5)
    v_mfma_f32_32x32x16_bf16 v[96:111], a[192:195], a[88:91], v[96:111]
    v_mfma_f32_32x32x16_bf16 v[112:127], a[196:199], a[88:91], v[112:127]
    s_waitcnt vmcnt(4)
    v_mfma_f32_32x32x16_bf16 v[96:111], a[200:203], a[92:95], v[96:111]
    v_mfma_f32_32x32x16_bf16 v[112:127], a[204:207], a[92:95], v[112:127]
    s_waitcnt vmcnt(3)
    v_mfma_f32_32x32x16_bf16 v[96:111], a[208:211], a[96:99], v[96:111]
    v_mfma_f32_32x32x16_bf16 v[112:127], a[212:215], a[96:99], v[112:127]
    s_waitcnt vmcnt(2)
    v_mfma_f32_32x32x16_bf16 v[96:111], a[216:219], a[100:103], v[96:111]
    v_mfma_f32_32x32x16_bf16 v[112:127], a[220:223], a[100:103], v[112:127]
    s_waitcnt vmcnt(1)
    v_mfma_f32_32x32x16_bf16 v[96:111], a[224:227], a[104:107], v[96:111]
    v_mfma_f32_32x32x16_bf16 v[112:127], a[228:231], a[104:107], v[112:127]
    s_waitcnt vmcnt(0)
    v_mfma_f32_32x32x16_bf16 v[96:111], a[232:235], a[108:111], v[96:111]
    v_mfma_f32_32x32x16_bf16 v[112:127], a[236:239], a[108:111], v[112:127]
    s_nop 10
    v_cmp_u_f32 vcc, v96, v96
    s_nop 0
    s_cbranch_vccz L_clean_3_31
    s_sub_u32 s55, s55, 1
    s_cbranch_scc0 L_ag_59
    s_branch L_clean_3_31
L_again_4_32:
    s_mov_b32 s55, 20000
L_ag_62:
    s_lshl_b32 s68, s9, 12
    s_add_u32 s68, s68, s14
    s_add_u32 s68, s68, 0
    v_min_u32 v48, 6, v1
    v_mul_u32_u24 v48, 12288, v48
    v_add_u32 v48, s68, v48
    s_add_u32 s68, s14, 86016
    s_cmp_gt_u32 s6, 1
    s_cselect_b32 s68, 2146435072, s68
    v_writelane_b32 v48, s68, 7
L_lp_63:
    buffer_load_dword v49, v48, s[28:31], 0 offen offset:1020 sc1
    s_waitcnt vmcnt(0)
    v_cmp_eq_u32 vcc, -1, v49
    s_nop 0
    s_cbranch_vccz L_lpd_64
    s_sub_u32 s55, s55, 1
    s_cbranch_scc0 L_lp_63
    s_branch L_clean_4_33
L_lpd_64:
    s_add_u32 s68, s9, 0
    s_lshl_b32 s68, s68, 12
    s_add_u32 s68, s68, s14
    buffer_load_dwordx4 a[0:3], v10, s[28:31], s68 offen sc1
    s_add_u32 s68, s68, 12288
    buffer_load_dwordx4 a[4:7], v10, s[28:31], s68 offen sc1
    s_add_u32 s68, s68, 12288
    buffer_load_dwordx4 a[8:11], v10, s[28:31], s68 offen sc1
    s_add_u32 s68, s68, 12288
    buffer_load_dwordx4 a[12:15], v10, s[28:31], s68 offen sc1
    s_add_u32 s68, s68, 12288
    buffer_load_dwordx4 a[16:19], v10, s[28:31], s68 offen sc1
    s_add_u32 s68, s68, 12288
    buffer_load_dwordx4 a[20:23], v10, s[28:31], s68 offen sc1
    s_add_u32 s68, s68, 12288
    buffer_load_dwordx4 a[24:27], v10, s[28:31], s68 offen sc1
    s_add_u32 s68, s14, 86016
    s_cmp_gt_u32 s6, 1
    s_cselect_b32 s68, 2146435072, s68
    buffer_load_dwordx4 a[28:31], v10, s[28:31], s68 offen sc1
    v_mov_b64 v[64:65], v[128:129]
    v_mov_b64 v[66:67], v[130:131]
    v_mov_b64 v[68:69], v[132:133]
    v_mov_b64 v[70:71], v[134:135]
    v_mov_b64 v[72:73], v[136:137]
    v_mov_b64 v[74:75], v[138:139]
    v_mov_b64 v[76:77], v[140:141]
    v_mov_b64 v[78:79], v[142:143]
    v_mov_b64 v[80:81], v[144:145]
    v_mov_b64 v[82:83], v[146:147]
    v_mov_b64 v[84:85], v[148:149]
    v_mov_b64 v[86:87], v[150:151]
    v_mov_b64 v[88:89], v[152:153]
    v_mov_b64 v[90:91], v[154:155]
    v_mov_b64 v[92:93], v[156:157]
    v_mov_b64 v[94:95], v[158:159]
    s_waitcnt vmcnt(7)
    v_mfma_f32_32x32x16_bf16 v[64:79], a[240:243], a[0:3], v[64:79]
    v_mfma_f32_32x32x16_bf16 v[80:95], a[244:247], a[0:3], v[80:95]
    s_waitcnt vmcnt(6)
    v_mfma_f32_32x32x16_bf16 v[64:79], a[248:251], a[4:7], v[64:79]
    v_mfma_f32_32x32x16_bf16 v[80:95], a[252:255], a[4:7], v[80:95]
    s_waitcnt vmcnt(5)
    v_mfma_f32_32x32x16_bf16 v[64:79], v[192:195], a[8:11], v[64:79]
    v_mfma_f32_32x32x16_bf16 v[80:95], v[196:199], a[8:11], v[80:95]
    s_waitcnt vmcnt(4)
    v_mfma_f32_32x32x16_bf16 v[64:79], v[200:203], a[12:15], v[64:79]
    v_mfma_f32_32x32x16_bf16 v[80:95], v[204:207], a[12:15], v[80:95]
    s_waitcnt vmcnt(3)
    v_mfma_f32_32x32x16_bf16 v[64:79], v[208:211], a[16:19], v[64:79]
    v_mfma_f32_32x32x16_bf16 v[80:95], v[212:215], a[16:19], v[80:95]
    s_waitcnt vmcnt(2)
    v_mfma_f32_32x32x16_bf16 v[64:79], v[216:219], a[20:23], v[64:79]
    v_mfma_f32_32x32x16_bf16 v[80:95], v[220:223], a[20:23], v[80:95]
    s_waitcnt vmcnt(1)
    v_mfma_f32_32x32x16_bf16 v[64:79], v[224:227], a[24:27], v[64:79]
    v_mfma_f32_32x32x16_bf16 v[80:95], v[228:231], a[24:27], v[80:95]
    s_waitcnt vmcnt(0)
    v_mfma_f32_32x32x16_bf16 v[64:79], v[232:235], a[28:31], v[64:79]
    v_mfma_f32_32x32x16_bf16 v[80:95], v[236:239], a[28:31], v[80:95]
    s_nop 10
    v_cmp_u_f32 vcc, v64, v64
    s_nop 0
    s_cbranch_vccz L_clean_4_33
    s_sub_u32 s55, s55, 1
    s_cbranch_scc0 L_ag_62
    s_branch L_clean_4_33
L_again_5_34:
    s_mov_b32 s55, 20000
L_ag_65:
    s_lshl_b32 s68, s9, 12
    s_add_u32 s68, s68, s14
    s_add_u32 s68, s68, 88064
    v_min_u32 v48, 6, v1
    v_mul_u32_u24 v48, 12288, v48
    v_add_u32 v48, s68, v48
    s_add_u32 s68, s14, 174080
    s_cmp_gt_u32 s6, 1
    s_cselect_b32 s68, 2146435072, s68
    v_writelane_b32 v48, s68, 7
L_lp_66:
    buffer_load_dword v49, v48, s[28:31], 0 offen offset:1020 sc1
    s_waitcnt vmcnt(0)
    v_cmp_eq_u32 vcc, -1, v49
    s_nop 0
    s_cbranch_vccz L_lpd_67
    s_sub_u32 s55, s55, 1
    s_cbranch_scc0 L_lp_66
    s_branch L_clean_5_35
L_lpd_67:
    s_add_u32 s68, s9, 0
    s_lshl_b32 s68, s68, 12
    s_add_u32 s68, s68, s14
    buffer_load_dwordx4 a[32:35], v9, s[28:31], s68 offen sc1
    s_add_u32 s68, s68, 12288
    buffer_load_dwordx4 a[36:39], v9, s[28:31], s68 offen sc1
    s_add_u32 s68, s68, 12288
    buffer_load_dwordx4 a[40:43], v9, s[28:31], s68 offen sc1
    s_add_u32 s68, s68, 12288
    buffer_load_dwordx4 a[44:47], v9, s[28:31], s68 offen sc1
    s_add_u32 s68, s68, 12288
    buffer_load_dwordx4 a[48:51], v9, s[28:31], s68 offen sc1
    s_add_u32 s68, s68, 12288
    buffer_load_dwordx4 a[52:55], v9, s[28:31], s68 offen sc1
    s_add_u32 s68, s68, 12288
    buffer_load_dwordx4 a[56:59], v9, s[28:31], s68 offen sc1
    s_add_u32 s68, s14, 86016
    s_cmp_gt_u32 s6, 1
    s_cselect_b32 s68, 2146435072, s68
    buffer_load_dwordx4 a[60:63], v9, s[28:31], s68 offen sc1
    v_mov_b64 v[96:97], v[160:161]
    v_mov_b64 v[98:99], v[162:163]
    v_mov_b64 v[100:101], v[164:165]
    v_mov_b64 v[102:103], v[166:167]
    v_mov_b64 v[104:105], v[168:169]
    v_mov_b64 v[106:107], v[170:171]
    v_mov_b64 v[108:109], v[172:173]
    v_mov_b64 v[110:111], v[174:175]
    v_mov_b64 v[112:113], v[176:177]
    v_mov_b64 v[114:115], v[178:179]
    v_mov_b64 v[116:117], v[180:181]
    v_mov_b64 v[118:119], v[182:183]
    v_mov_b64 v[120:121], v[184:185]
    v_mov_b64 v[122:123], v[186:187]
    v_mov_b64 v[124:125], v[188:189]
    v_mov_b64 v[126:127], v[190:191]
    s_waitcnt vmcnt(7)
    v_mfma_f32_32x32x16_bf16 v[96:111], a[240:243], a[32:35], v[96:111]
    v_mfma_f32_32x32x16_bf16 v[112:127], a[244:247], a[32:35], v[112:127]
    s_waitcnt vmcnt(6)
    v_mfma_f32_32x32x16_bf16 v[96:111], a[248:251], a[36:39], v[96:111]
    v_mfma_f32_32x32x16_bf16 v[112:127], a[252:255], a[36:39], v[112:127]
    s_waitcnt vmcnt(5)
    v_mfma_f32_32x32x16_bf16 v[96:111], v[192:195], a[40:43], v[96:111]
    v_mfma_f32_32x32x16_bf16 v[112:127], v[196:199], a[40:43], v[112:127]
    s_waitcnt vmcnt(4)
    v_mfma_f32_32x32x16_bf16 v[96:111], v[200:203], a[44:47], v[96:111]
    v_mfma_f32_32x32x16_bf16 v[112:127], v[204:207], a[44:47], v[112:127]
    s_waitcnt vmcnt(3)
    v_mfma_f32_32x32x16_bf16 v[96:111], v[208:211], a[48:51], v[96:111]
    v_mfma_f32_32x32x16_bf16 v[112:127], v[212:215], a[48:51], v[112:127]
    s_waitcnt vmcnt(2)
    v_mfma_f32_32x32x16_bf16 v[96:111], v[216:219], a[52:55], v[96:111]
    v_mfma_f32_32x32x16_bf16 v[112:127], v[220:223], a[52:55], v[112:127]
    s_waitcnt vmcnt(1)
    v_mfma_f32_32x32x16_bf16 v[96:111], v[224:227], a[56:59], v[96:111]
    v_mfma_f32_32x32x16_bf16 v[112:127], v[228:231], a[56:59], v[112:127]
    s_waitcnt vmcnt(0)
    v_mfma_f32_32x32x16_bf16 v[96:111], v[232:235], a[60:63], v[96:111]
    v_mfma_f32_32x32x16_bf16 v[112:127], v[236:239], a[60:63], v[112:127]
    s_nop 10
    v_cmp_u_f32 vcc, v96, v96
    s_nop 0
    s_cbranch_vccz L_clean_5_35
    s_sub_u32 s55, s55, 1
    s_cbranch_scc0 L_ag_65
    s_branch L_clean_5_35
L_slow_p1_12:
    s_mov_b32 s55, 200000
L_sl_68:
    s_mov_b64 exec, vcc
    buffer_load_dword v3, v2, s[28:31], 0 offen sc1
    s_waitcnt vmcnt(0)
    v_cmp_ne_u32 vcc, s40, v3
    s_nop 0
    s_cbranch_vccz L_slx_69
    s_sub_u32 s55, s55, 1
    s_cbranch_scc0 L_sl_68
L_slx_69:
    s_mov_b64 exec, -1
    s_nop 3
    s_branch L_ok_p1_13
L_slow_pm_15:
    s_mov_b32 s55, 200000
L_sl_70:
    s_mov_b64 exec, vcc
    buffer_load_dword v3, v15, s[28:31], 0 offen sc1
    s_waitcnt vmcnt(0)
    v_cmp_ne_u32 vcc, s40, v3
    s_nop 0
    s_cbranch_vccz L_slx_71
    s_sub_u32 s55, s55, 1
    s_cbranch_scc0 L_sl_70
L_slx_71:
    s_mov_b64 exec, -1
    s_nop 3
    s_branch L_ok_pm_16
L_slow_p3_20:
    s_mov_b32 s55, 200000
L_sl_72:
    s_mov_b64 exec, vcc
    buffer_load_dword v3, v2, s[28:31], 0 offen sc1
    s_waitcnt vmcnt(0)
    v_cmp_ne_u32 vcc, s40, v3
    s_nop 0
    s_cbranch_vccz L_slx_73
    s_sub_u32 s55, s55, 1
    s_cbranch_scc0 L_sl_72
L_slx_73:
    s_mov_b64 exec, -1
    s_nop 3
    s_branch L_ok_p3_21
L_slow_pa_22:
    s_mov_b32 s55, 200000
L_sl_74:
    s_mov_b64 exec, vcc
    buffer_load_dword v31, v17, s[28:31], 0 offen sc1
    s_waitcnt vmcnt(0)
    v_cmp_ne_u32 vcc, s40, v31
    s_nop 0
    s_cbranch_vccz L_slx_75
    s_sub_u32 s55, s55, 1
    s_cbranch_scc0 L_sl_74
L_slx_75:
    s_mov_b64 exec, -1
    s_nop 3
    s_branch L_ok_pa_23
.p2align 8
L_table:
.long 0x3f803f80, 0x3f803f80, 0x3f803f80, 0x3f803f80, 0x3f6d3f80, 0x3ec43f35, 0xbec4248d, 0xbf6dbf35
.long 0x3f353f80, 0xbf35248d, 0xbf35bf80, 0x3f35a554, 0x3ec43f80, 0xbf6dbf35, 0x3f6da554, 0xbec43f35
.long 0x3f803f80, 0x3f803f80, 0x3f803f80, 0x3f803f80, 0x3f6d3f80, 0x3ec43f35, 0xbec4a654, 0xbf6dbf35
.long 0x3f353f80, 0xbf35261f, 0xbf35bf80, 0x3f35a777, 0x3ec43f80, 0xbf6dbf35, 0x3f6da754, 0xbec43f35
.long 0x248d3f80, 0xa554bf80, 0x25b03f80, 0xa5f7bf80, 0xbec43f80, 0x3f6dbf35, 0xbf6d25b0, 0x3ec43f35
.long 0xbf353f80, 0x3f35a554, 0x3f35bf80, 0xbf35261f, 0xbf6d3f80, 0xbec43f35, 0x3ec4a5f7, 0x3f6dbf35
.long 0x25b03f80, 0xa742bf80, 0xa58e3f80, 0xa78dbf80, 0xbec43f80, 0x3f6dbf35, 0xbf6da60d, 0x3ec43f35
.long 0xbf353f80, 0x3f35a731, 0x3f35bf80, 0xbf35258d, 0xbf6d3f80, 0xbec43f35, 0x3ec4a765, 0x3f6dbf35
.long 0xbf803f80, 0xbf803f80, 0xbf803f80, 0xbf803f80, 0xbf6d3f80, 0xbec43f35, 0x3ec4261f, 0x3f6dbf35
.long 0xbf353f80, 0x3f3525b0, 0x3f35bf80, 0xbf35a742, 0xbec43f80, 0x3f6dbf35, 0xbf6da731, 0x3ec43f35
.long 0xbf803f80, 0xbf803f80, 0xbf803f80, 0xbf803f80, 0xbf6d3f80, 0xbec43f35, 0x3ec4a58e, 0x3f6dbf35
.long 0xbf353f80, 0x3f35a68d, 0x3f35bf80, 0xbf35a796, 0xbec43f80, 0x3f6dbf35, 0xbf6da777, 0x3ec43f35
.long 0xa5543f80, 0x261fbf80, 0xa7423f80, 0xa60dbf80, 0x3ec43f80, 0xbf6dbf35, 0x3f6da68d, 0xbec43f35
.long 0x3f353f80, 0xbf35a5f7, 0xbf35bf80, 0x3f35a60d, 0x3f6d3f80, 0x3ec43f35, 0xbec4a742, 0xbf6dbf35
.long 0xa5f73f80, 0xa60dbf80, 0xa78d3f80, 0x2816bf80, 0x3ec43f80, 0xbf6dbf35, 0x3f6da137, 0xbec43f35
.long 0x3f353f80, 0xbf35a742, 0xbf35bf80, 0x3f35268d, 0x3f6d3f80, 0x3ec43f35, 0xbec4a784, 0xbf6dbf35
.long 0x3f803f80, 0x3f803f80, 0x3f803f80, 0x3f803f80, 0x3f553f7b, 0x3e483f0e, 0xbf0ebe48, 0xbf7bbf55
.long 0x3ec43f6d, 0xbf6dbec4, 0xbec4bf6d, 0x3f6d3ec4, 0xbe483f55, 0xbf0ebf7b, 0x3f7b3f0e, 0xbf553e48
.long 0xbf80bf80, 0xbf80bf80, 0xbf80bf80, 0xbf80bf80, 0xbf55bf7b, 0xbe48bf0e, 0x3f0e3e48, 0x3f7b3f55
.long 0xbec4bf6d, 0x3f6d3ec4, 0x3ec43f6d, 0xbf6dbec4, 0x3e48bf55, 0x3f0e3f7b, 0xbf7bbf0e, 0x3f55be48
.long 0xbf353f35, 0x3f35bf35, 0xbf353f35, 0x3f35bf35, 0xbf7b3f0e, 0x3f553e48, 0xbe48bf55, 0xbf0e3f7b
.long 0xbf6d3ec4, 0xbec43f6d, 0x3f6dbec4, 0x3ec4bf6d, 0xbf0e3e48, 0xbf7b3f55, 0xbf553f7b, 0xbe483f0e
.long 0x3f35bf35, 0xbf353f35, 0x3f35bf35, 0xbf353f35, 0x3f7bbf0e, 0xbf55be48, 0x3e483f55, 0x3f0ebf7b
.long 0x3f6dbec4, 0x3ec4bf6d, 0xbf6d3ec4, 0xbec43f6d, 0x3f0ebe48, 0x3f7bbf55, 0x3f55bf7b, 0x3e48bf0e
.long 0xa554248d, 0xa5f725b0, 0xa731261f, 0xa742a68d, 0x3f0ebe48, 0x3f7bbf55, 0x3f55bf7b, 0x3e48bf0e
.long 0x3f6dbec4, 0x3ec4bf6d, 0xbf6d3ec4, 0xbec43f6d, 0x3f7bbf0e, 0xbf55be48, 0x3e483f55, 0x3f0ebf7b
.long 0x261fa554, 0xa60da742, 0x258da777, 0x268da796, 0xbf0e3e48, 0xbf7b3f55, 0xbf553f7b, 0xbe483f0e
.long 0xbf6d3ec4, 0xbec43f6d, 0x3f6dbec4, 0x3ec4bf6d, 0xbf7b3f0e, 0x3f553e48, 0xbe48bf55, 0xbf0e3f7b
.long 0x3f35bf35, 0xbf353f35, 0x3f35bf35, 0xbf353f35, 0x3e48bf55, 0x3f0e3f7b, 0xbf7bbf0e, 0x3f55be48
.long 0xbec4bf6d, 0x3f6d3ec4, 0x3ec43f6d, 0xbf6dbec4, 0xbf55bf7b, 0xbe48bf0e, 0x3f0e3e48, 0x3f7b3f55
.long 0xbf353f35, 0x3f35bf35, 0xbf353f35, 0x3f35bf35, 0xbe483f55, 0xbf0ebf7b, 0x3f7b3f0e, 0xbf553e48
.long 0x3ec43f6d, 0xbf6dbec4, 0xbec4bf6d, 0x3f6d3ec4, 0x3f553f7b, 0x3e483f0e, 0xbf0ebe48, 0xbf7bbf55
.long 0x3f803f80, 0x3f803f80, 0x3f803f80, 0x3f803f80, 0xbf6dbf80, 0xbec4bf35, 0x3ec4a554, 0x3f6d3f35
.long 0x3f353f80, 0xbf3525b0, 0xbf35bf80, 0x3f35a5f7, 0xbec4bf80, 0x3f6d3f35, 0xbf6d261f, 0x3ec4bf35
.long 0x3f803f80, 0x3f803f80, 0x3f803f80, 0x3f803f80, 0xbf6dbf80, 0xbec4bf35, 0x3ec4a7b1, 0x3f6d3f35
.long 0x3f353f80, 0xbf35268d, 0xbf35bf80, 0x3f3526d4, 0xbec4bf80, 0x3f6d3f35, 0xbf6d281f, 0x3ec4bf35
.long 0x261f3f80, 0xa731bf80, 0xa68d3f80, 0xa742bf80, 0x3ec4bf80, 0xbf6d3f35, 0x3f6da742, 0xbec4bf35
.long 0xbf353f80, 0x3f35a742, 0x3f35bf80, 0xbf35a60d, 0x3f6dbf80, 0x3ec4bf35, 0xbec4a60d, 0xbf6d3f35
.long 0x268d3f80, 0x270dbf80, 0x28283f80, 0xa7e5bf80, 0x3ec4bf80, 0xbf6d3f35, 0x3f6d26d4, 0xbec4bf35
.long 0xbf353f80, 0x3f35270d, 0x3f35bf80, 0xbf352754, 0x3f6dbf80, 0x3ec4bf35, 0xbec42730, 0xbf6d3f35
.long 0xbf803f80, 0xbf803f80, 0xbf803f80, 0xbf803f80, 0x3f6dbf80, 0x3ec4bf35, 0xbec4a777, 0xbf6d3f35
.long 0xbf353f80, 0x3f35a58e, 0x3f35bf80, 0xbf35a78d, 0x3ec4bf80, 0xbf6d3f35, 0x3f6d258d, 0xbec4bf35
.long 0xbf803f80, 0xbf803f80, 0xbf803f80, 0xbf803f80, 0x3f6dbf80, 0x3ec4bf35, 0xbec4a7e5, 0xbf6d3f35
.long 0xbf353f80, 0x3f352828, 0x3f35bf80, 0xbf35a804, 0x3ec4bf80, 0xbf6d3f35, 0x3f6d2839, 0xbec4bf35
.long 0xa7773f80, 0x258dbf80, 0xa7963f80, 0x268dbf80, 0xbec4bf80, 0x3f6d3f35, 0xbf6da796, 0x3ec4bf35
.long 0x3f353f80, 0xbf35a78d, 0xbf35bf80, 0x3f352816, 0xbf6dbf80, 0xbec4bf35, 0x3ec4268d, 0x3f6d3f35
.long 0x26d43f80, 0x2754bf80, 0xa8043f80, 0xa731bf80, 0xbec4bf80, 0x3f6d3f35, 0xbf6da880, 0x3ec4bf35
.long 0x3f353f80, 0xbf35a7e5, 0xbf35bf80, 0x3f35a731, 0xbf6dbf80, 0xbec4bf35, 0x3ec428a3, 0x3f6d3f35
.long 0x3f803f80, 0x3f803f80, 0x3f803f80, 0x3f803f80, 0xbf55bf7b, 0xbe48bf0e, 0x3f0e3e48, 0x3f7b3f55
.long 0x3ec43f6d, 0xbf6dbec4, 0xbec4bf6d, 0x3f6d3ec4, 0x3e48bf55, 0x3f0e3f7b, 0xbf7bbf0e, 0x3f55be48
.long 0xbf80bf80, 0xbf80bf80, 0xbf80bf80, 0xbf80bf80, 0x3f553f7b, 0x3e483f0e, 0xbf0ebe48, 0xbf7bbf55
.long 0xbec4bf6d, 0x3f6d3ec4, 0x3ec43f6d, 0xbf6dbec4, 0xbe483f55, 0xbf0ebf7b, 0x3f7b3f0e, 0xbf553e48
.long 0xbf353f35, 0x3f35bf35, 0xbf353f35, 0x3f35bf35, 0x3f7bbf0e, 0xbf55be48, 0x3e483f55, 0x3f0ebf7b
.long 0xbf6d3ec4, 0xbec43f6d, 0x3f6dbec4, 0x3ec4bf6d, 0x3f0ebe48, 0x3f7bbf55, 0x3f55bf7b, 0x3e48bf0e
.long 0x3f35bf35, 0xbf353f35, 0x3f35bf35, 0xbf353f35, 0xbf7b3f0e, 0x3f553e48, 0xbe48bf55, 0xbf0e3f7b
.long 0x3f6dbec4, 0x3ec4bf6d, 0xbf6d3ec4, 0xbec43f6d, 0xbf0e3e48, 0xbf7b3f55, 0xbf553f7b, 0xbe483f0e
.long 0xa754a654, 0xa765a60d, 0xa777a58e, 0xa784a137, 0xbf0e3e48, 0xbf7b3f55, 0xbf553f7b, 0xbe483f0e
.long 0x3f6dbec4, 0x3ec4bf6d, 0xbf6d3ec4, 0xbec43f6d, 0xbf7b3f0e, 0x3f553e48, 0xbe48bf55, 0xbf0e3f7b
.long 0x281fa7b1, 0x273026d4, 0x2839a7e5, 0x28a3a880, 0x3f0ebe48, 0x3f7bbf55, 0x3f55bf7b, 0x3e48bf0e
.long 0xbf6d3ec4, 0xbec43f6d, 0x3f6dbec4, 0x3ec4bf6d, 0x3f7bbf0e, 0xbf55be48, 0x3e483f55, 0x3f0ebf7b
.long 0x3f35bf35, 0xbf353f35, 0x3f35bf35, 0xbf353f35, 0xbe483f55, 0xbf0ebf7b, 0x3f7b3f0e, 0xbf553e48
.long 0xbec4bf6d, 0x3f6d3ec4, 0x3ec43f6d, 0xbf6dbec4, 0x3f553f7b, 0x3e483f0e, 0xbf0ebe48, 0xbf7bbf55
.long 0xbf353f35, 0x3f35bf35, 0xbf353f35, 0x3f35bf35, 0x3e48bf55, 0x3f0e3f7b, 0xbf7bbf0e, 0x3f55be48
.long 0x3ec43f6d, 0xbf6dbec4, 0xbec4bf6d, 0x3f6d3ec4, 0xbf55bf7b, 0xbe48bf0e, 0x3f0e3e48, 0x3f7b3f55
.long 0x00000000, 0x00000000, 0x00000000, 0x00000000, 0x3ec40000, 0x3f6d3f35, 0x3f6d3f80, 0x3ec43f35
.long 0x3f350000, 0x3f353f80, 0xbf35250d, 0xbf35bf80, 0x3f6d0000, 0xbec43f35, 0xbec4bf80, 0x3f6d3f35
.long 0xa58d0000, 0xa654a60d, 0xa6b0a68d, 0xa6f7a6d4, 0x3ec40000, 0x3f6d3f35, 0x3f6d3f80, 0x3ec43f35
.long 0x3f350000, 0x3f353f80, 0xbf35269f, 0xbf35bf80, 0x3f6d0000, 0xbec43f35, 0xbec4bf80, 0x3f6d3f35
.long 0x3f800000, 0xbf80250d, 0x3f80a58d, 0xbf8025d4, 0x3f6d0000, 0xbec4bf35, 0xbec43f80, 0x3f6dbf35
.long 0x3f350000, 0x3f35bf80, 0xbf3525d4, 0xbf353f80, 0x3ec40000, 0x3f6dbf35, 0x3f6dbf80, 0x3ec4bf35
.long 0x3f800000, 0xbf802630, 0x3f80a6b0, 0xbf8027c2, 0x3f6d0000, 0xbec4bf35, 0xbec43f80, 0x3f6dbf35
.long 0x3f350000, 0x3f35bf80, 0xbf3527b1, 0xbf353f80, 0x3ec40000, 0x3f6dbf35, 0x3f6dbf80, 0x3ec4bf35
.long 0x250d0000, 0x25d4a58d, 0x2630a60d, 0x2677a654, 0xbec40000, 0xbf6d3f35, 0xbf6d3f80, 0xbec43f35
.long 0xbf350000, 0xbf353f80, 0x3f352630, 0x3f35bf80, 0xbf6d0000, 0x3ec43f35, 0x3ec4bf80, 0xbf6d3f35
.long 0x25d40000, 0x269fa654, 0x27c2a6d4, 0xa68da71f, 0xbec40000, 0xbf6d3f35, 0xbf6d3f80, 0xbec43f35
.long 0xbf350000, 0xbf353f80, 0x3f35a70d, 0x3f35bf80, 0xbf6d0000, 0x3ec43f35, 0x3ec4bf80, 0xbf6d3f35
.long 0xbf800000, 0x3f8025d4, 0xbf80a654, 0x3f80269f, 0xbf6d0000, 0x3ec4bf35, 0x3ec43f80, 0xbf6dbf35
.long 0xbf350000, 0xbf35bf80, 0x3f352677, 0x3f353f80, 0xbec40000, 0xbf6dbf35, 0xbf6dbf80, 0xbec4bf35
.long 0xbf800000, 0x3f802677, 0xbf80a6f7, 0x3f80a68d, 0xbf6d0000, 0x3ec4bf35, 0x3ec43f80, 0xbf6dbf35
.long 0xbf350000, 0xbf35bf80, 0x3f3527c2, 0x3f353f80, 0xbec40000, 0xbf6dbf35, 0xbf6dbf80, 0xbec4bf35
.long 0x00000000, 0x00000000, 0x00000000, 0x00000000, 0x3f0e3e48, 0x3f7b3f55, 0x3f553f7b, 0x3e483f0e
.long 0x3f6d3ec4, 0x3ec43f6d, 0xbf6dbec4, 0xbec4bf6d, 0x3f7b3f0e, 0xbf553e48, 0x3e48bf55, 0x3f0e3f7b
.long 0x25d4250d, 0x26772630, 0x27b1269f, 0x27c2a70d, 0xbf0ebe48, 0xbf7bbf55, 0xbf55bf7b, 0xbe48bf0e
.long 0xbf6dbec4, 0xbec4bf6d, 0x3f6d3ec4, 0x3ec43f6d, 0xbf7bbf0e, 0x3f55be48, 0xbe483f55, 0xbf0ebf7b
.long 0x3f353f35, 0xbf35bf35, 0x3f353f35, 0xbf35bf35, 0x3e483f55, 0x3f0ebf7b, 0xbf7b3f0e, 0x3f553e48
.long 0xbec43f6d, 0x3f6dbec4, 0x3ec4bf6d, 0xbf6d3ec4, 0xbf553f7b, 0xbe483f0e, 0x3f0ebe48, 0x3f7bbf55
.long 0xbf35bf35, 0x3f353f35, 0xbf35bf35, 0x3f353f35, 0xbe48bf55, 0xbf0e3f7b, 0x3f7bbf0e, 0xbf55be48
.long 0x3ec4bf6d, 0xbf6d3ec4, 0xbec43f6d, 0x3f6dbec4, 0x3f55bf7b, 0x3e48bf0e, 0xbf0e3e48, 0xbf7b3f55
.long 0xbf803f80, 0xbf803f80, 0xbf803f80, 0xbf803f80, 0xbf553f7b, 0xbe483f0e, 0x3f0ebe48, 0x3f7bbf55
.long 0xbec43f6d, 0x3f6dbec4, 0x3ec4bf6d, 0xbf6d3ec4, 0x3e483f55, 0x3f0ebf7b, 0xbf7b3f0e, 0x3f553e48
.long 0x3f80bf80, 0x3f80bf80, 0x3f80bf80, 0x3f80bf80, 0x3f55bf7b, 0x3e48bf0e, 0xbf0e3e48, 0xbf7b3f55
.long 0x3ec4bf6d, 0xbf6d3ec4, 0xbec43f6d, 0x3f6dbec4, 0xbe48bf55, 0xbf0e3f7b, 0x3f7bbf0e, 0xbf55be48
.long 0x3f353f35, 0xbf35bf35, 0x3f353f35, 0xbf35bf35, 0x3f7b3f0e, 0xbf553e48, 0x3e48bf55, 0x3f0e3f7b
.long 0x3f6d3ec4, 0x3ec43f6d, 0xbf6dbec4, 0xbec4bf6d, 0x3f0e3e48, 0x3f7b3f55, 0x3f553f7b, 0x3e483f0e
.long 0xbf35bf35, 0x3f353f35, 0xbf35bf35, 0x3f353f35, 0xbf7bbf0e, 0x3f55be48, 0xbe483f55, 0xbf0ebf7b
.long 0xbf6dbec4, 0xbec4bf6d, 0x3f6d3ec4, 0x3ec43f6d, 0xbf0ebe48, 0xbf7bbf55, 0xbf55bf7b, 0xbe48bf0e
.long 0x00000000, 0x00000000, 0x00000000, 0x00000000, 0xbec4250d, 0xbf6dbf35, 0xbf6dbf80, 0xbec4bf35
.long 0x3f35a58d, 0x3f353f80, 0xbf3525d4, 0xbf35bf80, 0xbf6d25d4, 0x3ec4bf35, 0x3ec43f80, 0xbf6dbf35
.long 0xa71fa70d, 0xa831a730, 0x278da754, 0xa842a777, 0xbec4a6d4, 0xbf6dbf35, 0xbf6dbf80, 0xbec4bf35
.long 0x3f35a71f, 0x3f353f80, 0xbf3527f7, 0xbf35bf80, 0xbf6d27d4, 0x3ec4bf35, 0x3ec43f80, 0xbf6dbf35
.long 0x3f80a60d, 0xbf802630, 0x3f80a654, 0xbf802677, 0xbf6d2630, 0x3ec43f35, 0x3ec4bf80, 0xbf6d3f35
.long 0x3f35a654, 0x3f35bf80, 0xbf35269f, 0xbf353f80, 0xbec42677, 0xbf6d3f35, 0xbf6d3f80, 0xbec43f35
.long 0x3f80a730, 0xbf80a60e, 0x3f80a842, 0xbf80280d, 0xbf6da68d, 0x3ec43f35, 0x3ec4bf80, 0xbf6d3f35
.long 0x3f35a831, 0x3f35bf80, 0xbf35260d, 0xbf353f80, 0xbec427e5, 0xbf6d3f35, 0xbf6d3f80, 0xbec43f35
.long 0x269fa68d, 0x27b1a6b0, 0xa70da6d4, 0x27c2a6f7, 0x3ec4269f, 0x3f6dbf35, 0x3f6dbf80, 0x3ec4bf35
.long 0xbf35a6b0, 0xbf353f80, 0x3f3527c2, 0x3f35bf80, 0x3f6d27b1, 0xbec4bf35, 0xbec43f80, 0x3f6dbf35
.long 0x27f7a754, 0x260da842, 0x2816a79f, 0x270d270d, 0x3ec4a60e, 0x3f6dbf35, 0x3f6dbf80, 0x3ec4bf35
.long 0xbf35278d, 0xbf353f80, 0x3f352816, 0x3f35bf80, 0x3f6d27f7, 0xbec4bf35, 0xbec43f80, 0x3f6dbf35
.long 0xbf80a6d4, 0x3f8027c2, 0xbf80a71f, 0x3f80a68d, 0x3f6da70d, 0xbec43f35, 0xbec4bf80, 0x3f6d3f35
.long 0xbf35a6f7, 0xbf35bf80, 0x3f35a68d, 0x3f353f80, 0x3ec427c2, 0x3f6d3f35, 0x3f6d3f80, 0x3ec43f35
.long 0xbf80a777, 0x3f80280d, 0xbf80270d, 0x3f802896, 0x3f6da1b7, 0xbec43f35, 0xbec4bf80, 0x3f6d3f35
.long 0xbf35a842, 0xbf35bf80, 0x3f35270d, 0x3f353f80, 0x3ec42804, 0x3f6d3f35, 0x3f6d3f80, 0x3ec43f35
.long 0x00000000, 0x00000000, 0x00000000, 0x00000000, 0xbf0ebe48, 0xbf7bbf55, 0xbf55bf7b, 0xbe48bf0e
.long 0x3f6d3ec4, 0x3ec43f6d, 0xbf6dbec4, 0xbec4bf6d, 0xbf7bbf0e, 0x3f55be48, 0xbe483f55, 0xbf0ebf7b
.long 0x27d4a6d4, 0x27e5a68d, 0x27f7a60e, 0x2804a1b7, 0x3f0e3e48, 0x3f7b3f55, 0x3f553f7b, 0x3e483f0e
.long 0xbf6dbec4, 0xbec4bf6d, 0x3f6d3ec4, 0x3ec43f6d, 0x3f7b3f0e, 0xbf553e48, 0x3e48bf55, 0x3f0e3f7b
.long 0x3f353f35, 0xbf35bf35, 0x3f353f35, 0xbf35bf35, 0xbe48bf55, 0xbf0e3f7b, 0x3f7bbf0e, 0xbf55be48
.long 0xbec43f6d, 0x3f6dbec4, 0x3ec4bf6d, 0xbf6d3ec4, 0x3f55bf7b, 0x3e48bf0e, 0xbf0e3e48, 0xbf7b3f55
.long 0xbf35bf35, 0x3f353f35, 0xbf35bf35, 0x3f353f35, 0x3e483f55, 0x3f0ebf7b, 0xbf7b3f0e, 0x3f553e48
.long 0x3ec4bf6d, 0xbf6d3ec4, 0xbec43f6d, 0x3f6dbec4, 0xbf553f7b, 0xbe483f0e, 0x3f0ebe48, 0x3f7bbf55
.long 0xbf803f80, 0xbf803f80, 0xbf803f80, 0xbf803f80, 0x3f55bf7b, 0x3e48bf0e, 0xbf0e3e48, 0xbf7b3f55
.long 0xbec43f6d, 0x3f6dbec4, 0x3ec4bf6d, 0xbf6d3ec4, 0xbe48bf55, 0xbf0e3f7b, 0x3f7bbf0e, 0xbf55be48
.long 0x3f80bf80, 0x3f80bf80, 0x3f80bf80, 0x3f80bf80, 0xbf553f7b, 0xbe483f0e, 0x3f0ebe48, 0x3f7bbf55
.long 0x3ec4bf6d, 0xbf6d3ec4, 0xbec43f6d, 0x3f6dbec4, 0x3e483f55, 0x3f0ebf7b, 0xbf7b3f0e, 0x3f553e48
.long 0x3f353f35, 0xbf35bf35, 0x3f353f35, 0xbf35bf35, 0xbf7bbf0e, 0x3f55be48, 0xbe483f55, 0xbf0ebf7b
.long 0x3f6d3ec4, 0x3ec43f6d, 0xbf6dbec4, 0xbec4bf6d, 0xbf0ebe48, 0xbf7bbf55, 0xbf55bf7b, 0xbe48bf0e
.long 0xbf35bf35, 0x3f353f35, 0xbf35bf35, 0x3f353f35, 0x3f7b3f0e, 0xbf553e48, 0x3e48bf55, 0x3f0e3f7b
.long 0xbf6dbec4, 0xbec4bf6d, 0x3f6d3ec4, 0x3ec43f6d, 0x3f0e3e48, 0x3f7b3f55, 0x3f553f7b, 0x3e483f0e
.long 0x80008000, 0x80008000, 0x80008000, 0x80008000, 0xbec48000, 0xbf6dbf35, 0xbf6dbf80, 0xbec4bf35
.long 0xbf358000, 0xbf35bf80, 0x3f35a50d, 0x3f353f80, 0xbf6d8000, 0x3ec4bf35, 0x3ec43f80, 0xbf6dbf35
.long 0x258d8000, 0x2654260d, 0x26b0268d, 0x26f726d4, 0xbec48000, 0xbf6dbf35, 0xbf6dbf80, 0xbec4bf35
.long 0xbf358000, 0xbf35bf80, 0x3f35a69f, 0x3f353f80, 0xbf6d8000, 0x3ec4bf35, 0x3ec43f80, 0xbf6dbf35
.long 0xbf808000, 0x3f80a50d, 0xbf80258d, 0x3f80a5d4, 0xbf6d8000, 0x3ec43f35, 0x3ec4bf80, 0xbf6d3f35
.long 0xbf358000, 0xbf353f80, 0x3f35a5d4, 0x3f35bf80, 0xbec48000, 0xbf6d3f35, 0xbf6d3f80, 0xbec43f35
.long 0xbf808000, 0x3f80a630, 0xbf8026b0, 0x3f80a7c2, 0xbf6d8000, 0x3ec43f35, 0x3ec4bf80, 0xbf6d3f35
.long 0xbf358000, 0xbf353f80, 0x3f35a7b1, 0x3f35bf80, 0xbec48000, 0xbf6d3f35, 0xbf6d3f80, 0xbec43f35
.long 0xa50d8000, 0xa5d4258d, 0xa630260d, 0xa6772654, 0x3ec48000, 0x3f6dbf35, 0x3f6dbf80, 0x3ec4bf35
.long 0x3f358000, 0x3f35bf80, 0xbf35a630, 0xbf353f80, 0x3f6d8000, 0xbec4bf35, 0xbec43f80, 0x3f6dbf35
.long 0xa5d48000, 0xa69f2654, 0xa7c226d4, 0x268d271f, 0x3ec48000, 0x3f6dbf35, 0x3f6dbf80, 0x3ec4bf35
.long 0x3f358000, 0x3f35bf80, 0xbf35270d, 0xbf353f80, 0x3f6d8000, 0xbec4bf35, 0xbec43f80, 0x3f6dbf35
.long 0x3f808000, 0xbf80a5d4, 0x3f802654, 0xbf80a69f, 0x3f6d8000, 0xbec43f35, 0xbec4bf80, 0x3f6d3f35
.long 0x3f358000, 0x3f353f80, 0xbf35a677, 0xbf35bf80, 0x3ec48000, 0x3f6d3f35, 0x3f6d3f80, 0x3ec43f35
.long 0x3f808000, 0xbf80a677, 0x3f8026f7, 0xbf80268d, 0x3f6d8000, 0xbec43f35, 0xbec4bf80, 0x3f6d3f35
.long 0x3f358000, 0x3f353f80, 0xbf35a7c2, 0xbf35bf80, 0x3ec48000, 0x3f6d3f35, 0x3f6d3f80, 0x3ec43f35
.long 0x80008000, 0x80008000, 0x80008000, 0x80008000, 0xbf0ebe48, 0xbf7bbf55, 0xbf55bf7b, 0xbe48bf0e
.long 0xbf6dbec4, 0xbec4bf6d, 0x3f6d3ec4, 0x3ec43f6d, 0xbf7bbf0e, 0x3f55be48, 0xbe483f55, 0xbf0ebf7b
.long 0xa5d4a50d, 0xa677a630, 0xa7b1a69f, 0xa7c2270d, 0x3f0e3e48, 0x3f7b3f55, 0x3f553f7b, 0x3e483f0e
.long 0x3f6d3ec4, 0x3ec43f6d, 0xbf6dbec4, 0xbec4bf6d, 0x3f7b3f0e, 0xbf553e48, 0x3e48bf55, 0x3f0e3f7b
.long 0xbf35bf35, 0x3f353f35, 0xbf35bf35, 0x3f353f35, 0xbe48bf55, 0xbf0e3f7b, 0x3f7bbf0e, 0xbf55be48
.long 0x3ec4bf6d, 0xbf6d3ec4, 0xbec43f6d, 0x3f6dbec4, 0x3f55bf7b, 0x3e48bf0e, 0xbf0e3e48, 0xbf7b3f55
.long 0x3f353f35, 0xbf35bf35, 0x3f353f35, 0xbf35bf35, 0x3e483f55, 0x3f0ebf7b, 0xbf7b3f0e, 0x3f553e48
.long 0xbec43f6d, 0x3f6dbec4, 0x3ec4bf6d, 0xbf6d3ec4, 0xbf553f7b, 0xbe483f0e, 0x3f0ebe48, 0x3f7bbf55
.long 0x3f80bf80, 0x3f80bf80, 0x3f80bf80, 0x3f80bf80, 0x3f55bf7b, 0x3e48bf0e, 0xbf0e3e48, 0xbf7b3f55
.long 0x3ec4bf6d, 0xbf6d3ec4, 0xbec43f6d, 0x3f6dbec4, 0xbe48bf55, 0xbf0e3f7b, 0x3f7bbf0e, 0xbf55be48
.long 0xbf803f80, 0xbf803f80, 0xbf803f80, 0xbf803f80, 0xbf553f7b, 0xbe483f0e, 0x3f0ebe48, 0x3f7bbf55
.long 0xbec43f6d, 0x3f6dbec4, 0x3ec4bf6d, 0xbf6d3ec4, 0x3e483f55, 0x3f0ebf7b, 0xbf7b3f0e, 0x3f553e48
.long 0xbf35bf35, 0x3f353f35, 0xbf35bf35, 0x3f353f35, 0xbf7bbf0e, 0x3f55be48, 0xbe483f55, 0xbf0ebf7b
.long 0xbf6dbec4, 0xbec4bf6d, 0x3f6d3ec4, 0x3ec43f6d, 0xbf0ebe48, 0xbf7bbf55, 0xbf55bf7b, 0xbe48bf0e
.long 0x3f353f35, 0xbf35bf35, 0x3f353f35, 0xbf35bf35, 0x3f7b3f0e, 0xbf553e48, 0x3e48bf55, 0x3f0e3f7b
.long 0x3f6d3ec4, 0x3ec43f6d, 0xbf6dbec4, 0xbec4bf6d, 0x3f0e3e48, 0x3f7b3f55, 0x3f553f7b, 0x3e483f0e
.long 0x80008000, 0x80008000, 0x80008000, 0x80008000, 0x3ec4a50d, 0x3f6d3f35, 0x3f6d3f80, 0x3ec43f35
.long 0xbf35258d, 0xbf35bf80, 0x3f35a5d4, 0x3f353f80, 0x3f6da5d4, 0xbec43f35, 0xbec4bf80, 0x3f6d3f35
.long 0x271f270d, 0x28312730, 0xa78d2754, 0x28422777, 0x3ec426d4, 0x3f6d3f35, 0x3f6d3f80, 0x3ec43f35
.long 0xbf35271f, 0xbf35bf80, 0x3f35a7f7, 0x3f353f80, 0x3f6da7d4, 0xbec43f35, 0xbec4bf80, 0x3f6d3f35
.long 0xbf80260d, 0x3f80a630, 0xbf802654, 0x3f80a677, 0x3f6da630, 0xbec4bf35, 0xbec43f80, 0x3f6dbf35
.long 0xbf352654, 0xbf353f80, 0x3f35a69f, 0x3f35bf80, 0x3ec4a677, 0x3f6dbf35, 0x3f6dbf80, 0x3ec4bf35
.long 0xbf802730, 0x3f80260e, 0xbf802842, 0x3f80a80d, 0x3f6d268d, 0xbec4bf35, 0xbec43f80, 0x3f6dbf35
.long 0xbf352831, 0xbf353f80, 0x3f35a60d, 0x3f35bf80, 0x3ec4a7e5, 0x3f6dbf35, 0x3f6dbf80, 0x3ec4bf35
.long 0xa69f268d, 0xa7b126b0, 0x270d26d4, 0xa7c226f7, 0xbec4a69f, 0xbf6d3f35, 0xbf6d3f80, 0xbec43f35
.long 0x3f3526b0, 0x3f35bf80, 0xbf35a7c2, 0xbf353f80, 0xbf6da7b1, 0x3ec43f35, 0x3ec4bf80, 0xbf6d3f35
.long 0xa7f72754, 0xa60d2842, 0xa816279f, 0xa70da70d, 0xbec4260e, 0xbf6d3f35, 0xbf6d3f80, 0xbec43f35
.long 0x3f35a78d, 0x3f35bf80, 0xbf35a816, 0xbf353f80, 0xbf6da7f7, 0x3ec43f35, 0x3ec4bf80, 0xbf6d3f35
.long 0x3f8026d4, 0xbf80a7c2, 0x3f80271f, 0xbf80268d, 0xbf6d270d, 0x3ec4bf35, 0x3ec43f80, 0xbf6dbf35
.long 0x3f3526f7, 0x3f353f80, 0xbf35268d, 0xbf35bf80, 0xbec4a7c2, 0xbf6dbf35, 0xbf6dbf80, 0xbec4bf35
.long 0x3f802777, 0xbf80a80d, 0x3f80a70d, 0xbf80a896, 0xbf6d21b7, 0x3ec4bf35, 0x3ec43f80, 0xbf6dbf35
.long 0x3f352842, 0x3f353f80, 0xbf35a70d, 0xbf35bf80, 0xbec4a804, 0xbf6dbf35, 0xbf6dbf80, 0xbec4bf35
.long 0x80008000, 0x80008000, 0x80008000, 0x80008000, 0x3f0e3e48, 0x3f7b3f55, 0x3f553f7b, 0x3e483f0e
.long 0xbf6dbec4, 0xbec4bf6d, 0x3f6d3ec4, 0x3ec43f6d, 0x3f7b3f0e, 0xbf553e48, 0x3e48bf55, 0x3f0e3f7b
.long 0xa7d426d4, 0xa7e5268d, 0xa7f7260e, 0xa80421b7, 0xbf0ebe48, 0xbf7bbf55, 0xbf55bf7b, 0xbe48bf0e
.long 0x3f6d3ec4, 0x3ec43f6d, 0xbf6dbec4, 0xbec4bf6d, 0xbf7bbf0e, 0x3f55be48, 0xbe483f55, 0xbf0ebf7b
.long 0xbf35bf35, 0x3f353f35, 0xbf35bf35, 0x3f353f35, 0x3e483f55, 0x3f0ebf7b, 0xbf7b3f0e, 0x3f553e48
.long 0x3ec4bf6d, 0xbf6d3ec4, 0xbec43f6d, 0x3f6dbec4, 0xbf553f7b, 0xbe483f0e, 0x3f0ebe48, 0x3f7bbf55
.long 0x3f353f35, 0xbf35bf35, 0x3f353f35, 0xbf35bf35, 0xbe48bf55, 0xbf0e3f7b, 0x3f7bbf0e, 0xbf55be48
.long 0xbec43f6d, 0x3f6dbec4, 0x3ec4bf6d, 0xbf6d3ec4, 0x3f55bf7b, 0x3e48bf0e, 0xbf0e3e48, 0xbf7b3f55
.long 0x3f80bf80, 0x3f80bf80, 0x3f80bf80, 0x3f80bf80, 0xbf553f7b, 0xbe483f0e, 0x3f0ebe48, 0x3f7bbf55
.long 0x3ec4bf6d, 0xbf6d3ec4, 0xbec43f6d, 0x3f6dbec4, 0x3e483f55, 0x3f0ebf7b, 0xbf7b3f0e, 0x3f553e48
.long 0xbf803f80, 0xbf803f80, 0xbf803f80, 0xbf803f80, 0x3f55bf7b, 0x3e48bf0e, 0xbf0e3e48, 0xbf7b3f55
.long 0xbec43f6d, 0x3f6dbec4, 0x3ec4bf6d, 0xbf6d3ec4, 0xbe48bf55, 0xbf0e3f7b, 0x3f7bbf0e, 0xbf55be48
.long 0xbf35bf35, 0x3f353f35, 0xbf35bf35, 0x3f353f35, 0x3f7b3f0e, 0xbf553e48, 0x3e48bf55, 0x3f0e3f7b
.long 0xbf6dbec4, 0xbec4bf6d, 0x3f6d3ec4, 0x3ec43f6d, 0x3f0e3e48, 0x3f7b3f55, 0x3f553f7b, 0x3e483f0e
.long 0x3f353f35, 0xbf35bf35, 0x3f353f35, 0xbf35bf35, 0xbf7bbf0e, 0x3f55be48, 0xbe483f55, 0xbf0ebf7b
.long 0x3f6d3ec4, 0x3ec43f6d, 0xbf6dbec4, 0xbec4bf6d, 0xbf0ebe48, 0xbf7bbf55, 0xbf55bf7b, 0xbe48bf0e
.long 0x3f800000, 0x3f800000, 0x3f800000, 0x3f800000, 0x3f800000, 0x3f7ffb11, 0x3f7fec43, 0x3f7fd397
.long 0x3f800000, 0x3f7fec43, 0x3f7fb10f, 0x3f7f4e6d, 0x3f800000, 0x3f7fd397, 0x3f7f4e6d, 0x3f7e70b0
.long 0x3f800000, 0x3f7b14be, 0x3f6c835e, 0x3f54db31, 0x3f800000, 0x3f7a7302, 0x3f6a09a7, 0x3f4f7a1f
.long 0x3f800000, 0x3f79c79d, 0x3f676bd8, 0x3f49d112, 0x3f800000, 0x3f791298, 0x3f64aa59, 0x3f43e200
.long 0x3f800000, 0x3f7fb10f, 0x3f7ec46d, 0x3f7d3aac, 0x3f800000, 0x3f7f84ab, 0x3f7e1324, 0x3f7baccd
.long 0x3f800000, 0x3f7f4e6d, 0x3f7d3aac, 0x3f79c79d, 0x3f800000, 0x3f7f0e58, 0x3f7c3b28, 0x3f778bc5
.long 0x3f800000, 0x3f7853f8, 0x3f61c598, 0x3f3daef9, 0x3f800000, 0x3f778bc5, 0x3f5ebe05, 0x3f373a23
.long 0x3f800000, 0x3f76ba07, 0x3f5b941a, 0x3f3085bb, 0x3f800000, 0x3f75dec6, 0x3f584853, 0x3f299415
.long 0x3f800000, 0x3f7ec46d, 0x3f7b14be, 0x3f74fa0b, 0x3f800000, 0x3f7e70b0, 0x3f79c79d, 0x3f721352
.long 0x3f800000, 0x3f7e1324, 0x3f7853f8, 0x3f6ed89e, 0x3f800000, 0x3f7dabcc, 0x3f76ba07, 0x3f6b4b0c
.long 0x3f800000, 0x3f74fa0b, 0x3f54db31, 0x3f226799, 0x3f800000, 0x3f740bdd, 0x3f514d3d, 0x3f1b02c6
.long 0x3f800000, 0x3f731447, 0x3f4d9f02, 0x3f13682a, 0x3f800000, 0x3f721352, 0x3f49d112, 0x3f0b9a6b
.long 0x3f800000, 0x3f7d3aac, 0x3f74fa0b, 0x3f676bd8, 0x3f800000, 0x3f7cbfc9, 0x3f731447, 0x3f633c5a
.long 0x3f800000, 0x3f7c3b28, 0x3f710908, 0x3f5ebe05, 0x3f800000, 0x3f7baccd, 0x3f6ed89e, 0x3f59f26a
.long 0x3f800000, 0x3f710908, 0x3f45e403, 0x3f039c3d, 0x3f800000, 0x3f6ff573, 0x3f41d870, 0x3ef6e0cb
.long 0x3f800000, 0x3f6ed89e, 0x3f3daef9, 0x3ee63375, 0x3f800000, 0x3f6db293, 0x3f396842, 0x3ed53641
.long 0x3f800000, 0x3f800000, 0x3f800000, 0x3f800000, 0x3f7fb10f, 0x3f7f84ab, 0x3f7f4e6d, 0x3f7f0e58
.long 0x3f7ec46d, 0x3f7e1324, 0x3f7d3aac, 0x3f7c3b28, 0x3f7d3aac, 0x3f7baccd, 0x3f79c79d, 0x3f778bc5
.long 0x3f3504f3, 0x3f0e39da, 0x3ec3ef15, 0x3e47c5c2, 0x3f2beb4a, 0x3f00e7e4, 0x3ea09ae5, 0x3de1bc2e
.long 0x3f226799, 0x3ee63375, 0x3e78cfcc, 0x3cc90ab0, 0x3f187fc0, 0x3ec9b953, 0x3e2f10a2, 0xbd7b2b74
.long 0x3f7b14be, 0x3f7853f8, 0x3f74fa0b, 0x3f710908, 0x3f7853f8, 0x3f740bdd, 0x3f6ed89e, 0x3f68bf3c
.long 0x3f74fa0b, 0x3f6ed89e, 0x3f676bd8, 0x3f5ebe05, 0x3f710908, 0x3f68bf3c, 0x3f5ebe05, 0x3f531849
.long 0x3f0e39da, 0x3eac7cd4, 0x3dc8bd36, 0xbe164083, 0x3f039c3d, 0x3e8e9a22, 0x3cc90ab0, 0xbe6c9a7f
.long 0x3ef15aea, 0x3e605c13, 0xbd48fb30, 0xbea09ae5, 0x3edae880, 0x3e22abb6, 0xbdfab273, 0xbec9b953
.long 0x3f6c835e, 0x3f61c598, 0x3f54db31, 0x3f45e403, 0x3f676bd8, 0x3f59f26a, 0x3f49d112, 0x3f373a23
.long 0x3f61c598, 0x3f514d3d, 0x3f3daef9, 0x3f273656, 0x3f5b941a, 0x3f47de65, 0x3f3085bb, 0x3f15f6d9
.long 0x3ec3ef15, 0x3dc8bd36, 0xbe47c5c2, 0xbef15aea, 0x3eac7cd4, 0x3d16c32c, 0xbe888e93, 0xbf0b9a6b
.long 0x3e94a031, 0xbcc90ab0, 0xbeac7cd4, 0xbf1d7fd1, 0x3e78cfcc, 0xbdafb680, 0xbecf7bca, 0xbf2e3bde
.long 0x3f54db31, 0x3f3daef9, 0x3f226799, 0x3f039c3d, 0x3f4d9f02, 0x3f32c8c9, 0x3f13682a, 0x3ee0924f
.long 0x3f45e403, 0x3f273656, 0x3f039c3d, 0x3eb8442a, 0x3f3daef9, 0x3f1b02c6, 0x3ee63375, 0x3e8e9a22
.long 0x3e47c5c2, 0xbe164083, 0xbef15aea, 0xbf3daef9, 0x3e164083, 0xbe541501, 0xbf08f59b, 0xbf4bbbf8
.long 0x3dc8bd36, 0xbe888e93, 0xbf187fc0, 0xbf584853, 0x3d48fb30, 0xbea68f12, 0xbf273656, 0xbf633c5a
.long 0x3f800000, 0x3f800000, 0x3f800000, 0x3f800000, 0x3f7ec46d, 0x3f7e70b0, 0x3f7e1324, 0x3f7dabcc
.long 0x3f7b14be, 0x3f79c79d, 0x3f7853f8, 0x3f76ba07, 0x3f74fa0b, 0x3f721352, 0x3f6ed89e, 0x3f6b4b0c
.long 0x248d3132, 0xbe47c5c2, 0xbec3ef15, 0xbf0e39da, 0xbdc8bd36, 0xbe9aa086, 0xbefc5d27, 0xbf299415
.long 0xbe47c5c2, 0xbecf7bca, 0xbf187fc0, 0xbf41d870, 0xbe94a031, 0xbf00e7e4, 0xbf3085bb, 0xbf5695e5
.long 0x3f6c835e, 0x3f676bd8, 0x3f61c598, 0x3f5b941a, 0x3f61c598, 0x3f59f26a, 0x3f514d3d, 0x3f47de65
.long 0x3f54db31, 0x3f49d112, 0x3f3daef9, 0x3f3085bb, 0x3f45e403, 0x3f373a23, 0x3f273656, 0x3f15f6d9
.long 0xbec3ef15, 0xbf187fc0, 0xbf45e403, 0xbf676bd8, 0xbef15aea, 0xbf2e3bde, 0xbf584853, 0xbf740bdd
.long 0xbf0e39da, 0xbf41d870, 0xbf676bd8, 0xbf7c3b28, 0xbf226799, 0xbf531849, 0xbf731447, 0xbf7fd397
.long 0x3f3504f3, 0x3f226799, 0x3f0e39da, 0x3ef15aea, 0x3f226799, 0x3f0b9a6b, 0x3ee63375, 0x3eb263ef
.long 0x3f0e39da, 0x3ee63375, 0x3eac7cd4, 0x3e605c13, 0x3ef15aea, 0x3eb263ef, 0x3e605c13, 0x3dafb680
.long 0xbf3504f3, 0xbf61c598, 0xbf7b14be, 0xbf7ec46d, 0xbf45e403, 0xbf6db293, 0xbf7f4e6d, 0xbf791298
.long 0xbf54db31, 0xbf76ba07, 0xbf7fb10f, 0xbf6ed89e, 0xbf61c598, 0xbf7cbfc9, 0xbf7c3b28, 0xbf604621
.long 0x3ec3ef15, 0x3e78cfcc, 0x3dc8bd36, 0xbd48fb30, 0x3e94a031, 0x3e09cf86, 0xbcc90ab0, 0xbe3b6ecf
.long 0x3e47c5c2, 0x3cc90ab0, 0xbe164083, 0xbea09ae5, 0x3dc8bd36, 0xbdafb680, 0xbe888e93, 0xbee0924f
.long 0xbf6c835e, 0xbf7fb10f, 0xbf74fa0b, 0xbf4d9f02, 0xbf74fa0b, 0xbf7f84ab, 0xbf6a09a7, 0xbf373a23
.long 0xbf7b14be, 0xbf7c3b28, 0xbf5b941a, 0xbf1d7fd1, 0xbf7ec46d, 0xbf75dec6, 0xbf49d112, 0xbf00e7e4
.long 0x3f800000, 0x3f800000, 0x3f800000, 0x3f800000, 0x3f7d3aac, 0x3f7cbfc9, 0x3f7c3b28, 0x3f7baccd
.long 0x3f74fa0b, 0x3f731447, 0x3f710908, 0x3f6ed89e, 0x3f676bd8, 0x3f633c5a, 0x3f5ebe05, 0x3f59f26a
.long 0xbf3504f3, 0xbf54db31, 0xbf6c835e, 0xbf7b14be, 0xbf4d9f02, 0xbf68bf3c, 0xbf79c79d, 0xbf7ffb11
.long 0xbf61c598, 0xbf76ba07, 0xbf7fb10f, 0xbf7c3b28, 0xbf710908, 0xbf7e70b0, 0xbf7e1324, 0xbf6ff573
.long 0x3f54db31, 0x3f4d9f02, 0x3f45e403, 0x3f3daef9, 0x3f3daef9, 0x3f32c8c9, 0x3f273656, 0x3f1b02c6
.long 0x3f226799, 0x3f13682a, 0x3f039c3d, 0x3ee63375, 0x3f039c3d, 0x3ee0924f, 0x3eb8442a, 0x3e8e9a22
.long 0xbf7b14be, 0xbf7fb10f, 0xbf74fa0b, 0xbf5b941a, 0xbf7fb10f, 0xbf7a7302, 0xbf64aa59, 0xbf3fc767
.long 0xbf7ec46d, 0xbf6ed89e, 0xbf4d9f02, 0xbf1d7fd1, 0xbf7853f8, 0xbf5d2d53, 0xbf3085bb, 0xbeebcbbb
.long 0x3ec3ef15, 0x3e94a031, 0x3e47c5c2, 0x3dc8bd36, 0x3e78cfcc, 0x3e09cf86, 0x3cc90ab0, 0xbdafb680
.long 0x3dc8bd36, 0xbcc90ab0, 0xbe164083, 0xbe888e93, 0xbd48fb30, 0xbe3b6ecf, 0xbea09ae5, 0xbee0924f
.long 0xbf6c835e, 0xbf45e403, 0xbf0e39da, 0xbe94a031, 0xbf5b941a, 0xbf299415, 0xbecf7bca, 0xbde1bc2e
.long 0xbf45e403, 0xbf08f59b, 0xbe78cfcc, 0x3d96a905, 0xbf2beb4a, 0xbec9b953, 0xbd96a905, 0x3e827dc0
.long 0xbe47c5c2, 0xbeac7cd4, 0xbef15aea, 0xbf187fc0, 0xbeac7cd4, 0xbef6e0cb, 0xbf1d7fd1, 0xbf3b8f3b
.long 0xbef15aea, 0xbf1d7fd1, 0xbf3daef9, 0xbf584853, 0xbf187fc0, 0xbf3b8f3b, 0xbf584853, 0xbf6db293
.long 0xbf0e39da, 0xbe78cfcc, 0x3dc8bd36, 0x3edae880, 0xbedae880, 0xbdafb680, 0x3e888e93, 0x3f15f6d9
.long 0xbe94a031, 0x3d96a905, 0x3edae880, 0x3f396842, 0xbe164083, 0x3e6c9a7f, 0x3f13682a, 0x3f5695e5
.long 0x00000000, 0x00000000, 0x00000000, 0x00000000, 0x00000000, 0x3c490e90, 0x3cc90ab0, 0x3d16c32c
.long 0x00000000, 0x3cc90ab0, 0x3d48fb30, 0x3d96a905, 0x00000000, 0x3d16c32c, 0x3d96a905, 0x3de1bc2e
.long 0x00000000, 0x3e47c5c2, 0x3ec3ef15, 0x3f0e39da, 0x00000000, 0x3e541501, 0x3ecf7bca, 0x3f15f6d9
.long 0x00000000, 0x3e605c13, 0x3edae880, 0x3f1d7fd1, 0x00000000, 0x3e6c9a7f, 0x3ee63375, 0x3f24d225
.long 0x00000000, 0x3d48fb30, 0x3dc8bd36, 0x3e164083, 0x00000000, 0x3d7b2b74, 0x3dfab273, 0x3e3b6ecf
.long 0x00000000, 0x3d96a905, 0x3e164083, 0x3e605c13, 0x00000000, 0x3dafb680, 0x3e2f10a2, 0x3e827dc0
.long 0x00000000, 0x3e78cfcc, 0x3ef15aea, 0x3f2beb4a, 0x00000000, 0x3e827dc0, 0x3efc5d27, 0x3f32c8c9
.long 0x00000000, 0x3e888e93, 0x3f039c3d, 0x3f396842, 0x00000000, 0x3e8e9a22, 0x3f08f59b, 0x3f3fc767
.long 0x00000000, 0x3dc8bd36, 0x3e47c5c2, 0x3e94a031, 0x00000000, 0x3de1bc2e, 0x3e605c13, 0x3ea68f12
.long 0x00000000, 0x3dfab273, 0x3e78cfcc, 0x3eb8442a, 0x00000000, 0x3e09cf86, 0x3e888e93, 0x3ec9b953
.long 0x00000000, 0x3e94a031, 0x3f0e39da, 0x3f45e403, 0x00000000, 0x3e9aa086, 0x3f13682a, 0x3f4bbbf8
.long 0x00000000, 0x3ea09ae5, 0x3f187fc0, 0x3f514d3d, 0x00000000, 0x3ea68f12, 0x3f1d7fd1, 0x3f5695e5
.long 0x00000000, 0x3e164083, 0x3e94a031, 0x3edae880, 0x00000000, 0x3e22abb6, 0x3ea09ae5, 0x3eebcbbb
.long 0x00000000, 0x3e2f10a2, 0x3eac7cd4, 0x3efc5d27, 0x00000000, 0x3e3b6ecf, 0x3eb8442a, 0x3f064b82
.long 0x00000000, 0x3eac7cd4, 0x3f226799, 0x3f5b941a, 0x00000000, 0x3eb263ef, 0x3f273656, 0x3f604621
.long 0x00000000, 0x3eb8442a, 0x3f2beb4a, 0x3f64aa59, 0x00000000, 0x3ebe1d4a, 0x3f3085bb, 0x3f68bf3c
.long 0x00000000, 0x00000000, 0x00000000, 0x00000000, 0x3d48fb30, 0x3d7b2b74, 0x3d96a905, 0x3dafb680
.long 0x3dc8bd36, 0x3dfab273, 0x3e164083, 0x3e2f10a2, 0x3e164083, 0x3e3b6ecf, 0x3e605c13, 0x3e827dc0
.long 0x3f3504f3, 0x3f54db31, 0x3f6c835e, 0x3f7b14be, 0x3f3daef9, 0x3f5d2d53, 0x3f731447, 0x3f7e70b0
.long 0x3f45e403, 0x3f64aa59, 0x3f7853f8, 0x3f7fec43, 0x3f4d9f02, 0x3f6b4b0c, 0x3f7c3b28, 0x3f7f84ab
.long 0x3e47c5c2, 0x3e78cfcc, 0x3e94a031, 0x3eac7cd4, 0x3e78cfcc, 0x3e9aa086, 0x3eb8442a, 0x3ed53641
.long 0x3e94a031, 0x3eb8442a, 0x3edae880, 0x3efc5d27, 0x3eac7cd4, 0x3ed53641, 0x3efc5d27, 0x3f10d3cd
.long 0x3f54db31, 0x3f710908, 0x3f7ec46d, 0x3f7d3aac, 0x3f5b941a, 0x3f75dec6, 0x3f7fec43, 0x3f791298
.long 0x3f61c598, 0x3f79c79d, 0x3f7fb10f, 0x3f731447, 0x3f676bd8, 0x3f7cbfc9, 0x3f7e1324, 0x3f6b4b0c
.long 0x3ec3ef15, 0x3ef15aea, 0x3f0e39da, 0x3f226799, 0x3edae880, 0x3f064b82, 0x3f1d7fd1, 0x3f32c8c9
.long 0x3ef15aea, 0x3f13682a, 0x3f2beb4a, 0x3f41d870, 0x3f039c3d, 0x3f1ff6cb, 0x3f396842, 0x3f4f7a1f
.long 0x3f6c835e, 0x3f7ec46d, 0x3f7b14be, 0x3f61c598, 0x3f710908, 0x3f7fd397, 0x3f76ba07, 0x3f5695e5
.long 0x3f74fa0b, 0x3f7fec43, 0x3f710908, 0x3f49d112, 0x3f7853f8, 0x3f7f0e58, 0x3f6a09a7, 0x3f3b8f3b
.long 0x3f0e39da, 0x3f2beb4a, 0x3f45e403, 0x3f5b941a, 0x3f187fc0, 0x3f373a23, 0x3f514d3d, 0x3f660f88
.long 0x3f226799, 0x3f41d870, 0x3f5b941a, 0x3f6ed89e, 0x3f2beb4a, 0x3f4bbbf8, 0x3f64aa59, 0x3f75dec6
.long 0x3f7b14be, 0x3f7d3aac, 0x3f61c598, 0x3f2beb4a, 0x3f7d3aac, 0x3f7a7302, 0x3f584853, 0x3f1b02c6
.long 0x3f7ec46d, 0x3f76ba07, 0x3f4d9f02, 0x3f08f59b, 0x3f7fb10f, 0x3f721352, 0x3f41d870, 0x3eebcbbb
.long 0x00000000, 0x00000000, 0x00000000, 0x00000000, 0x3dc8bd36, 0x3de1bc2e, 0x3dfab273, 0x3e09cf86
.long 0x3e47c5c2, 0x3e605c13, 0x3e78cfcc, 0x3e888e93, 0x3e94a031, 0x3ea68f12, 0x3eb8442a, 0x3ec9b953
.long 0x3f800000, 0x3f7b14be, 0x3f6c835e, 0x3f54db31, 0x3f7ec46d, 0x3f740bdd, 0x3f5ebe05, 0x3f3fc767
.long 0x3f7b14be, 0x3f6a09a7, 0x3f4d9f02, 0x3f273656, 0x3f74fa0b, 0x3f5d2d53, 0x3f396842, 0x3f0b9a6b
.long 0x3ec3ef15, 0x3edae880, 0x3ef15aea, 0x3f039c3d, 0x3ef15aea, 0x3f064b82, 0x3f13682a, 0x3f1ff6cb
.long 0x3f0e39da, 0x3f1d7fd1, 0x3f2beb4a, 0x3f396842, 0x3f226799, 0x3f32c8c9, 0x3f41d870, 0x3f4f7a1f
.long 0x3f6c835e, 0x3f4d9f02, 0x3f226799, 0x3edae880, 0x3f61c598, 0x3f3b8f3b, 0x3f08f59b, 0x3e9aa086
.long 0x3f54db31, 0x3f273656, 0x3edae880, 0x3e2f10a2, 0x3f45e403, 0x3f10d3cd, 0x3ea09ae5, 0x3d16c32c
.long 0x3f3504f3, 0x3f45e403, 0x3f54db31, 0x3f61c598, 0x3f45e403, 0x3f5695e5, 0x3f64aa59, 0x3f6ff573
.long 0x3f54db31, 0x3f64aa59, 0x3f710908, 0x3f79c79d, 0x3f61c598, 0x3f6ff573, 0x3f79c79d, 0x3f7f0e58
.long 0x3f3504f3, 0x3ef15aea, 0x3e47c5c2, 0xbdc8bd36, 0x3f226799, 0x3ebe1d4a, 0x3d96a905, 0xbe6c9a7f
.long 0x3f0e39da, 0x3e888e93, 0xbd48fb30, 0xbeb8442a, 0x3ef15aea, 0x3e22abb6, 0xbe2f10a2, 0xbef6e0cb
.long 0x3f6c835e, 0x3f7853f8, 0x3f7ec46d, 0x3f7fb10f, 0x3f74fa0b, 0x3f7dabcc, 0x3f7fec43, 0x3f7baccd
.long 0x3f7b14be, 0x3f7fec43, 0x3f7d3aac, 0x3f731447, 0x3f7ec46d, 0x3f7f0e58, 0x3f76ba07, 0x3f660f88
.long 0x3ec3ef15, 0x3d48fb30, 0xbe94a031, 0xbf187fc0, 0x3e94a031, 0xbd7b2b74, 0xbecf7bca, 0xbf32c8c9
.long 0x3e47c5c2, 0xbe2f10a2, 0xbf039c3d, 0xbf49d112, 0x3dc8bd36, 0xbe8e9a22, 0xbf1d7fd1, 0xbf5d2d53
.long 0x00000000, 0x00000000, 0x00000000, 0x00000000, 0x3e164083, 0x3e22abb6, 0x3e2f10a2, 0x3e3b6ecf
.long 0x3e94a031, 0x3ea09ae5, 0x3eac7cd4, 0x3eb8442a, 0x3edae880, 0x3eebcbbb, 0x3efc5d27, 0x3f064b82
.long 0x3f3504f3, 0x3f0e39da, 0x3ec3ef15, 0x3e47c5c2, 0x3f187fc0, 0x3ed53641, 0x3e605c13, 0x3c490e90
.long 0x3ef15aea, 0x3e888e93, 0x3d48fb30, 0xbe2f10a2, 0x3eac7cd4, 0x3de1bc2e, 0xbdfab273, 0xbeb263ef
.long 0x3f0e39da, 0x3f187fc0, 0x3f226799, 0x3f2beb4a, 0x3f2beb4a, 0x3f373a23, 0x3f41d870, 0x3f4bbbf8
.long 0x3f45e403, 0x3f514d3d, 0x3f5b941a, 0x3f64aa59, 0x3f5b941a, 0x3f660f88, 0x3f6ed89e, 0x3f75dec6
.long 0x3e47c5c2, 0xbd48fb30, 0xbe94a031, 0xbf039c3d, 0x3d48fb30, 0xbe541501, 0xbee63375, 0xbf299415
.long 0xbdc8bd36, 0xbeb8442a, 0xbf187fc0, 0xbf49d112, 0xbe78cfcc, 0xbf00e7e4, 0xbf396842, 0xbf633c5a
.long 0x3f6c835e, 0x3f74fa0b, 0x3f7b14be, 0x3f7ec46d, 0x3f7853f8, 0x3f7dabcc, 0x3f7fec43, 0x3f7f0e58
.long 0x3f7ec46d, 0x3f7fec43, 0x3f7d3aac, 0x3f76ba07, 0x3f7fb10f, 0x3f7baccd, 0x3f731447, 0x3f660f88
.long 0xbec3ef15, 0xbf226799, 0xbf54db31, 0xbf74fa0b, 0xbf039c3d, 0xbf3fc767, 0xbf6a09a7, 0xbf7e70b0
.long 0xbf226799, 0xbf584853, 0xbf7853f8, 0xbf7f4e6d, 0xbf3daef9, 0xbf6b4b0c, 0xbf7f4e6d, 0xbf778bc5
.long 0x3f7b14be, 0x3f710908, 0x3f61c598, 0x3f4d9f02, 0x3f710908, 0x3f604621, 0x3f49d112, 0x3f2e3bde
.long 0x3f61c598, 0x3f49d112, 0x3f2beb4a, 0x3f08f59b, 0x3f4d9f02, 0x3f2e3bde, 0x3f08f59b, 0x3ebe1d4a
.long 0xbf54db31, 0xbf7853f8, 0xbf7ec46d, 0xbf676bd8, 0xbf676bd8, 0xbf7f0e58, 0xbf76ba07, 0xbf4f7a1f
.long 0xbf74fa0b, 0xbf7f4e6d, 0xbf676bd8, 0xbf3085bb, 0xbf7d3aac, 0xbf791298, 0xbf514d3d, 0xbf0b9a6b
.long 0x3f803f80, 0x3f803f80, 0x3f803f80, 0x3f803f80, 0x3f6d3f80, 0x3ec43f35, 0xbf6dbf80, 0xbec4bf35
.long 0x3f353f80, 0xbf35248d, 0x3f353f80, 0xbf3525b0, 0x3ec43f80, 0xbf6dbf35, 0xbec4bf80, 0x3f6d3f35
.long 0x248d3f80, 0xa554bf80, 0x261f3f80, 0xa731bf80, 0xbec43f80, 0x3f6dbf35, 0x3ec4bf80, 0xbf6d3f35
.long 0xbf353f80, 0x3f35a554, 0xbf353f80, 0x3f35a742, 0xbf6d3f80, 0xbec43f35, 0x3f6dbf80, 0x3ec4bf35
.long 0xbf803f80, 0xbf803f80, 0xbf803f80, 0xbf803f80, 0xbf6d3f80, 0xbec43f35, 0x3f6dbf80, 0x3ec4bf35
.long 0xbf353f80, 0x3f3525b0, 0xbf353f80, 0x3f35a58e, 0xbec43f80, 0x3f6dbf35, 0x3ec4bf80, 0xbf6d3f35
.long 0xa5543f80, 0x261fbf80, 0xa7773f80, 0x258dbf80, 0x3ec43f80, 0xbf6dbf35, 0xbec4bf80, 0x3f6d3f35
.long 0x3f353f80, 0xbf35a5f7, 0x3f353f80, 0xbf35a78d, 0x3f6d3f80, 0x3ec43f35, 0xbf6dbf80, 0xbec4bf35
.long 0x00000000, 0x00000000, 0x00000000, 0x00000000, 0x00000000, 0x00000000, 0x00000000, 0x00000000
.long 0x00000000, 0x00000000, 0x00000000, 0x00000000, 0x00000000, 0x00000000, 0x00000000, 0x00000000
.long 0x00000000, 0x00000000, 0x00000000, 0x00000000, 0x00000000, 0x00000000, 0x00000000, 0x00000000
.long 0x00000000, 0x00000000, 0x00000000, 0x00000000, 0x00000000, 0x00000000, 0x00000000, 0x00000000
.long 0x00000000, 0x00000000, 0x00000000, 0x00000000, 0x00000000, 0x00000000, 0x00000000, 0x00000000
.long 0x00000000, 0x00000000, 0x00000000, 0x00000000, 0x00000000, 0x00000000, 0x00000000, 0x00000000
.long 0x00000000, 0x00000000, 0x00000000, 0x00000000, 0x00000000, 0x00000000, 0x00000000, 0x00000000
.long 0x00000000, 0x00000000, 0x00000000, 0x00000000, 0x00000000, 0x00000000, 0x00000000, 0x00000000
.long 0x3f803f80, 0x3f803f80, 0x3f803f80, 0x3f803f80, 0xbec4248d, 0xbf6dbf35, 0x3ec4a554, 0x3f6d3f35
.long 0xbf35bf80, 0x3f35a554, 0xbf35bf80, 0x3f35a5f7, 0x3f6da554, 0xbec43f35, 0xbf6d261f, 0x3ec4bf35
.long 0x25b03f80, 0xa5f7bf80, 0xa68d3f80, 0xa742bf80, 0xbf6d25b0, 0x3ec43f35, 0x3f6da742, 0xbec4bf35
.long 0x3f35bf80, 0xbf35261f, 0x3f35bf80, 0xbf35a60d, 0x3ec4a5f7, 0x3f6dbf35, 0xbec4a60d, 0xbf6d3f35
.long 0xbf803f80, 0xbf803f80, 0xbf803f80, 0xbf803f80, 0x3ec4261f, 0x3f6dbf35, 0xbec4a777, 0xbf6d3f35
.long 0x3f35bf80, 0xbf35a742, 0x3f35bf80, 0xbf35a78d, 0xbf6da731, 0x3ec43f35, 0x3f6d258d, 0xbec4bf35
.long 0xa7423f80, 0xa60dbf80, 0xa7963f80, 0x268dbf80, 0x3f6da68d, 0xbec43f35, 0xbf6da796, 0x3ec4bf35
.long 0xbf35bf80, 0x3f35a60d, 0xbf35bf80, 0x3f352816, 0xbec4a742, 0xbf6dbf35, 0x3ec4268d, 0x3f6d3f35
.long 0x00000000, 0x00000000, 0x00000000, 0x00000000, 0x00000000, 0x00000000, 0x00000000, 0x00000000
.long 0x00000000, 0x00000000, 0x00000000, 0x00000000, 0x00000000, 0x00000000, 0x00000000, 0x00000000
.long 0x00000000, 0x00000000, 0x00000000, 0x00000000, 0x00000000, 0x00000000, 0x00000000, 0x00000000
.long 0x00000000, 0x00000000, 0x00000000, 0x00000000, 0x00000000, 0x00000000, 0x00000000, 0x00000000
.long 0x00000000, 0x00000000, 0x00000000, 0x00000000, 0x00000000, 0x00000000, 0x00000000, 0x00000000
.long 0x00000000, 0x00000000, 0x00000000, 0x00000000, 0x00000000, 0x00000000, 0x00000000, 0x00000000
.long 0x00000000, 0x00000000, 0x00000000, 0x00000000, 0x00000000, 0x00000000, 0x00000000, 0x00000000
.long 0x00000000, 0x00000000, 0x00000000, 0x00000000, 0x00000000, 0x00000000, 0x00000000, 0x00000000
.long 0x00000000, 0x00000000, 0x00000000, 0x00000000, 0x3ec40000, 0x3f6d3f35, 0xbec4250d, 0xbf6dbf35
.long 0x3f350000, 0x3f353f80, 0x3f35a58d, 0x3f353f80, 0x3f6d0000, 0xbec43f35, 0xbf6d25d4, 0x3ec4bf35
.long 0x3f800000, 0xbf80250d, 0x3f80a60d, 0xbf802630, 0x3f6d0000, 0xbec4bf35, 0xbf6d2630, 0x3ec43f35
.long 0x3f350000, 0x3f35bf80, 0x3f35a654, 0x3f35bf80, 0x3ec40000, 0x3f6dbf35, 0xbec42677, 0xbf6d3f35
.long 0x250d0000, 0x25d4a58d, 0x269fa68d, 0x27b1a6b0, 0xbec40000, 0xbf6d3f35, 0x3ec4269f, 0x3f6dbf35
.long 0xbf350000, 0xbf353f80, 0xbf35a6b0, 0xbf353f80, 0xbf6d0000, 0x3ec43f35, 0x3f6d27b1, 0xbec4bf35
.long 0xbf800000, 0x3f8025d4, 0xbf80a6d4, 0x3f8027c2, 0xbf6d0000, 0x3ec4bf35, 0x3f6da70d, 0xbec43f35
.long 0xbf350000, 0xbf35bf80, 0xbf35a6f7, 0xbf35bf80, 0xbec40000, 0xbf6dbf35, 0x3ec427c2, 0x3f6d3f35
.long 0x00000000, 0x00000000, 0x00000000, 0x00000000, 0x00000000, 0x00000000, 0x00000000, 0x00000000
.long 0x00000000, 0x00000000, 0x00000000, 0x00000000, 0x00000000, 0x00000000, 0x00000000, 0x00000000
.long 0x00000000, 0x00000000, 0x00000000, 0x00000000, 0x00000000, 0x00000000, 0x00000000, 0x00000000
.long 0x00000000, 0x00000000, 0x00000000, 0x00000000, 0x00000000, 0x00000000, 0x00000000, 0x00000000
.long 0x00000000, 0x00000000, 0x00000000, 0x00000000, 0x00000000, 0x00000000, 0x00000000, 0x00000000
.long 0x00000000, 0x00000000, 0x00000000, 0x00000000, 0x00000000, 0x00000000, 0x00000000, 0x00000000
.long 0x00000000, 0x00000000, 0x00000000, 0x00000000, 0x00000000, 0x00000000, 0x00000000, 0x00000000
.long 0x00000000, 0x00000000, 0x00000000, 0x00000000, 0x00000000, 0x00000000, 0x00000000, 0x00000000
.long 0x00000000, 0x00000000, 0x00000000, 0x00000000, 0x3f6d3f80, 0x3ec43f35, 0xbf6dbf80, 0xbec4bf35
.long 0xbf35250d, 0xbf35bf80, 0xbf3525d4, 0xbf35bf80, 0xbec4bf80, 0x3f6d3f35, 0x3ec43f80, 0xbf6dbf35
.long 0x3f80a58d, 0xbf8025d4, 0x3f80a654, 0xbf802677, 0xbec43f80, 0x3f6dbf35, 0x3ec4bf80, 0xbf6d3f35
.long 0xbf3525d4, 0xbf353f80, 0xbf35269f, 0xbf353f80, 0x3f6dbf80, 0x3ec4bf35, 0xbf6d3f80, 0xbec43f35
.long 0x2630a60d, 0x2677a654, 0xa70da6d4, 0x27c2a6f7, 0xbf6d3f80, 0xbec43f35, 0x3f6dbf80, 0x3ec4bf35
.long 0x3f352630, 0x3f35bf80, 0x3f3527c2, 0x3f35bf80, 0x3ec4bf80, 0xbf6d3f35, 0xbec43f80, 0x3f6dbf35
.long 0xbf80a654, 0x3f80269f, 0xbf80a71f, 0x3f80a68d, 0x3ec43f80, 0xbf6dbf35, 0xbec4bf80, 0x3f6d3f35
.long 0x3f352677, 0x3f353f80, 0x3f35a68d, 0x3f353f80, 0xbf6dbf80, 0xbec4bf35, 0x3f6d3f80, 0x3ec43f35
.long 0x00000000, 0x00000000, 0x00000000, 0x00000000, 0x00000000, 0x00000000, 0x00000000, 0x00000000
.long 0x00000000, 0x00000000, 0x00000000, 0x00000000, 0x00000000, 0x00000000, 0x00000000, 0x00000000
.long 0x00000000, 0x00000000, 0x00000000, 0x00000000, 0x00000000, 0x00000000, 0x00000000, 0x00000000
.long 0x00000000, 0x00000000, 0x00000000, 0x00000000, 0x00000000, 0x00000000, 0x00000000, 0x00000000
.long 0x00000000, 0x00000000, 0x00000000, 0x00000000, 0x00000000, 0x00000000, 0x00000000, 0x00000000
.long 0x00000000, 0x00000000, 0x00000000, 0x00000000, 0x00000000, 0x00000000, 0x00000000, 0x00000000
.long 0x00000000, 0x00000000, 0x00000000, 0x00000000, 0x00000000, 0x00000000, 0x00000000, 0x00000000
.long 0x00000000, 0x00000000, 0x00000000, 0x00000000, 0x00000000, 0x00000000, 0x00000000, 0x00000000
.long 0x00000000, 0x00000000, 0x00000000, 0x00000000, 0x00000000, 0x00000000, 0x00000000, 0x00000000
.long 0x00000000, 0x00000000, 0x00000000, 0x00000000, 0x00000000, 0x00000000, 0x00000000, 0x00000000
.long 0x00000000, 0x00000000, 0x00000000, 0x00000000, 0x00000000, 0x00000000, 0x00000000, 0x00000000
.long 0x00000000, 0x00000000, 0x00000000, 0x00000000, 0x00000000, 0x00000000, 0x00000000, 0x00000000
.long 0x00000000, 0x00000000, 0x00000000, 0x00000000, 0x00000000, 0x00000000, 0x00000000, 0x00000000
.long 0x00000000, 0x00000000, 0x00000000, 0x00000000, 0x00000000, 0x00000000, 0x00000000, 0x00000000
.long 0x00000000, 0x00000000, 0x00000000, 0x00000000, 0x00000000, 0x00000000, 0x00000000, 0x00000000
.long 0x00000000, 0x00000000, 0x00000000, 0x00000000, 0x00000000, 0x00000000, 0x00000000, 0x00000000
.long 0x3f803f80, 0x3f803f80, 0x3f803f80, 0x3f803f80, 0x3f6d3f80, 0x3ec43f35, 0xbf6dbf80, 0xbec4bf35
.long 0x3f353f80, 0xbf35248d, 0x3f353f80, 0xbf3525b0, 0x3ec43f80, 0xbf6dbf35, 0xbec4bf80, 0x3f6d3f35
.long 0x248d3f80, 0xa554bf80, 0x261f3f80, 0xa731bf80, 0xbec43f80, 0x3f6dbf35, 0x3ec4bf80, 0xbf6d3f35
.long 0xbf353f80, 0x3f35a554, 0xbf353f80, 0x3f35a742, 0xbf6d3f80, 0xbec43f35, 0x3f6dbf80, 0x3ec4bf35
.long 0xbf803f80, 0xbf803f80, 0xbf803f80, 0xbf803f80, 0xbf6d3f80, 0xbec43f35, 0x3f6dbf80, 0x3ec4bf35
.long 0xbf353f80, 0x3f3525b0, 0xbf353f80, 0x3f35a58e, 0xbec43f80, 0x3f6dbf35, 0x3ec4bf80, 0xbf6d3f35
.long 0xa5543f80, 0x261fbf80, 0xa7773f80, 0x258dbf80, 0x3ec43f80, 0xbf6dbf35, 0xbec4bf80, 0x3f6d3f35
.long 0x3f353f80, 0xbf35a5f7, 0x3f353f80, 0xbf35a78d, 0x3f6d3f80, 0x3ec43f35, 0xbf6dbf80, 0xbec4bf35
.long 0x00000000, 0x00000000, 0x00000000, 0x00000000, 0x00000000, 0x00000000, 0x00000000, 0x00000000
.long 0x00000000, 0x00000000, 0x00000000, 0x00000000, 0x00000000, 0x00000000, 0x00000000, 0x00000000
.long 0x00000000, 0x00000000, 0x00000000, 0x00000000, 0x00000000, 0x00000000, 0x00000000, 0x00000000
.long 0x00000000, 0x00000000, 0x00000000, 0x00000000, 0x00000000, 0x00000000, 0x00000000, 0x00000000
.long 0x00000000, 0x00000000, 0x00000000, 0x00000000, 0x00000000, 0x00000000, 0x00000000, 0x00000000
.long 0x00000000, 0x00000000, 0x00000000, 0x00000000, 0x00000000, 0x00000000, 0x00000000, 0x00000000
.long 0x00000000, 0x00000000, 0x00000000, 0x00000000, 0x00000000, 0x00000000, 0x00000000, 0x00000000
.long 0x00000000, 0x00000000, 0x00000000, 0x00000000, 0x00000000, 0x00000000, 0x00000000, 0x00000000
.long 0x3f803f80, 0x3f803f80, 0x3f803f80, 0x3f803f80, 0xbec4248d, 0xbf6dbf35, 0x3ec4a554, 0x3f6d3f35
.long 0xbf35bf80, 0x3f35a554, 0xbf35bf80, 0x3f35a5f7, 0x3f6da554, 0xbec43f35, 0xbf6d261f, 0x3ec4bf35
.long 0x25b03f80, 0xa5f7bf80, 0xa68d3f80, 0xa742bf80, 0xbf6d25b0, 0x3ec43f35, 0x3f6da742, 0xbec4bf35
.long 0x3f35bf80, 0xbf35261f, 0x3f35bf80, 0xbf35a60d, 0x3ec4a5f7, 0x3f6dbf35, 0xbec4a60d, 0xbf6d3f35
.long 0xbf803f80, 0xbf803f80, 0xbf803f80, 0xbf803f80, 0x3ec4261f, 0x3f6dbf35, 0xbec4a777, 0xbf6d3f35
.long 0x3f35bf80, 0xbf35a742, 0x3f35bf80, 0xbf35a78d, 0xbf6da731, 0x3ec43f35, 0x3f6d258d, 0xbec4bf35
.long 0xa7423f80, 0xa60dbf80, 0xa7963f80, 0x268dbf80, 0x3f6da68d, 0xbec43f35, 0xbf6da796, 0x3ec4bf35
.long 0xbf35bf80, 0x3f35a60d, 0xbf35bf80, 0x3f352816, 0xbec4a742, 0xbf6dbf35, 0x3ec4268d, 0x3f6d3f35
.long 0x00000000, 0x00000000, 0x00000000, 0x00000000, 0x00000000, 0x00000000, 0x00000000, 0x00000000
.long 0x00000000, 0x00000000, 0x00000000, 0x00000000, 0x00000000, 0x00000000, 0x00000000, 0x00000000
.long 0x00000000, 0x00000000, 0x00000000, 0x00000000, 0x00000000, 0x00000000, 0x00000000, 0x00000000
.long 0x00000000, 0x00000000, 0x00000000, 0x00000000, 0x00000000, 0x00000000, 0x00000000, 0x00000000
.long 0x00000000, 0x00000000, 0x00000000, 0x00000000, 0x00000000, 0x00000000, 0x00000000, 0x00000000
.long 0x00000000, 0x00000000, 0x00000000, 0x00000000, 0x00000000, 0x00000000, 0x00000000, 0x00000000
.long 0x00000000, 0x00000000, 0x00000000, 0x00000000, 0x00000000, 0x00000000, 0x00000000, 0x00000000
.long 0x00000000, 0x00000000, 0x00000000, 0x00000000, 0x00000000, 0x00000000, 0x00000000, 0x00000000
.long 0x00000000, 0x00000000, 0x00000000, 0x00000000, 0x3ec40000, 0x3f6d3f35, 0xbec4250d, 0xbf6dbf35
.long 0x3f350000, 0x3f353f80, 0x3f35a58d, 0x3f353f80, 0x3f6d0000, 0xbec43f35, 0xbf6d25d4, 0x3ec4bf35
.long 0x3f800000, 0xbf80250d, 0x3f80a60d, 0xbf802630, 0x3f6d0000, 0xbec4bf35, 0xbf6d2630, 0x3ec43f35
.long 0x3f350000, 0x3f35bf80, 0x3f35a654, 0x3f35bf80, 0x3ec40000, 0x3f6dbf35, 0xbec42677, 0xbf6d3f35
.long 0x250d0000, 0x25d4a58d, 0x269fa68d, 0x27b1a6b0, 0xbec40000, 0xbf6d3f35, 0x3ec4269f, 0x3f6dbf35
.long 0xbf350000, 0xbf353f80, 0xbf35a6b0, 0xbf353f80, 0xbf6d0000, 0x3ec43f35, 0x3f6d27b1, 0xbec4bf35
.long 0xbf800000, 0x3f8025d4, 0xbf80a6d4, 0x3f8027c2, 0xbf6d0000, 0x3ec4bf35, 0x3f6da70d, 0xbec43f35
.long 0xbf350000, 0xbf35bf80, 0xbf35a6f7, 0xbf35bf80, 0xbec40000, 0xbf6dbf35, 0x3ec427c2, 0x3f6d3f35
.long 0x00000000, 0x00000000, 0x00000000, 0x00000000, 0x00000000, 0x00000000, 0x00000000, 0x00000000
.long 0x00000000, 0x00000000, 0x00000000, 0x00000000, 0x00000000, 0x00000000, 0x00000000, 0x00000000
.long 0x00000000, 0x00000000, 0x00000000, 0x00000000, 0x00000000, 0x00000000, 0x00000000, 0x00000000
.long 0x00000000, 0x00000000, 0x00000000, 0x00000000, 0x00000000, 0x00000000, 0x00000000, 0x00000000
.long 0x00000000, 0x00000000, 0x00000000, 0x00000000, 0x00000000, 0x00000000, 0x00000000, 0x00000000
.long 0x00000000, 0x00000000, 0x00000000, 0x00000000, 0x00000000, 0x00000000, 0x00000000, 0x00000000
.long 0x00000000, 0x00000000, 0x00000000, 0x00000000, 0x00000000, 0x00000000, 0x00000000, 0x00000000
.long 0x00000000, 0x00000000, 0x00000000, 0x00000000, 0x00000000, 0x00000000, 0x00000000, 0x00000000
.long 0x00000000, 0x00000000, 0x00000000, 0x00000000, 0x3f6d3f80, 0x3ec43f35, 0xbf6dbf80, 0xbec4bf35
.long 0xbf35250d, 0xbf35bf80, 0xbf3525d4, 0xbf35bf80, 0xbec4bf80, 0x3f6d3f35, 0x3ec43f80, 0xbf6dbf35
.long 0x3f80a58d, 0xbf8025d4, 0x3f80a654, 0xbf802677, 0xbec43f80, 0x3f6dbf35, 0x3ec4bf80, 0xbf6d3f35
.long 0xbf3525d4, 0xbf353f80, 0xbf35269f, 0xbf353f80, 0x3f6dbf80, 0x3ec4bf35, 0xbf6d3f80, 0xbec43f35
.long 0x2630a60d, 0x2677a654, 0xa70da6d4, 0x27c2a6f7, 0xbf6d3f80, 0xbec43f35, 0x3f6dbf80, 0x3ec4bf35
.long 0x3f352630, 0x3f35bf80, 0x3f3527c2, 0x3f35bf80, 0x3ec4bf80, 0xbf6d3f35, 0xbec43f80, 0x3f6dbf35
.long 0xbf80a654, 0x3f80269f, 0xbf80a71f, 0x3f80a68d, 0x3ec43f80, 0xbf6dbf35, 0xbec4bf80, 0x3f6d3f35
.long 0x3f352677, 0x3f353f80, 0x3f35a68d, 0x3f353f80, 0xbf6dbf80, 0xbec4bf35, 0x3f6d3f80, 0x3ec43f35
.long 0x3f803f80, 0x3f803f80, 0x3f803f80, 0x3f803f80, 0xbf803f80, 0xbf803f80, 0xbf803f80, 0xbf803f80
.long 0x3f7f3f80, 0x3f753f7b, 0x3f623f6d, 0x3f463f55, 0xbdc9248d, 0xbe95be48, 0xbef1bec4, 0xbf22bf0e
.long 0x3f7b3f80, 0x3f553f6d, 0x3f0e3f35, 0x3e483ec4, 0xbe48248d, 0xbf0ebec4, 0xbf55bf35, 0xbf7bbf6d
.long 0x3f753f80, 0x3f223f55, 0x3dc93ec4, 0xbef1be48, 0xbe95248d, 0xbf46bf0e, 0xbf7fbf6d, 0xbf62bf7b
.long 0x3f6d3f80, 0x3ec43f35, 0xbec4248d, 0xbf6dbf35, 0xbec4248d, 0xbf6dbf35, 0xbf6dbf80, 0xbec4bf35
.long 0x3f623f80, 0x3dc93f0e, 0xbf46bec4, 0xbf75bf7b, 0xbef1248d, 0xbf7fbf55, 0xbf22bf6d, 0x3e95be48
.long 0x3f553f80, 0xbe483ec4, 0xbf7bbf35, 0xbf0ebf6d, 0xbf0e248d, 0xbf7bbf6d, 0xbe48bf35, 0x3f553ec4
.long 0x3f463f80, 0xbef13e48, 0xbf75bf6d, 0x3dc9bf0e, 0xbf22248d, 0xbf62bf7b, 0x3e95bec4, 0x3f7f3f55
.long 0x3f803f80, 0x3f803f80, 0x3f803f80, 0x3f803f80, 0xbf803f80, 0xbf803f80, 0xbf803f80, 0xbf803f80
.long 0x3f223f35, 0x3ef13f0e, 0x3e953ec4, 0x3dc93e48, 0xbf46bf35, 0xbf62bf55, 0xbf75bf6d, 0xbf7fbf7b
.long 0xbe48248d, 0xbf0ebec4, 0xbf55bf35, 0xbf7bbf6d, 0xbf7bbf80, 0xbf55bf6d, 0xbf0ebf35, 0xbe48bec4
.long 0xbf62bf35, 0xbf7fbf7b, 0xbf46bf6d, 0xbe95bf0e, 0xbef1bf35, 0x3dc9be48, 0x3f223ec4, 0x3f753f55
.long 0xbf6dbf80, 0xbec4bf35, 0x3ec4a554, 0x3f6d3f35, 0x3ec4a554, 0x3f6d3f35, 0x3f6d3f80, 0x3ec43f35
.long 0xbe95bf35, 0x3f223e48, 0x3f7f3f6d, 0x3ef13f55, 0x3f753f35, 0x3f463f7b, 0xbdc93ec4, 0xbf62bf0e
.long 0x3f0ea554, 0x3f7b3f6d, 0x3e483f35, 0xbf55bec4, 0x3f553f80, 0xbe483ec4, 0xbf7bbf35, 0xbf0ebf6d
.long 0x3f7f3f35, 0x3e953f55, 0xbf62bec4, 0xbf22bf7b, 0x3dc93f35, 0xbf75bf0e, 0xbef1bf6d, 0x3f463e48
.long 0x3f803f80, 0x3f803f80, 0x3f803f80, 0x3f803f80, 0xbf803f80, 0xbf803f80, 0xbf803f80, 0xbf803f80
.long 0xbdc9248d, 0xbe95be48, 0xbef1bec4, 0xbf22bf0e, 0xbf7fbf80, 0xbf75bf7b, 0xbf62bf6d, 0xbf46bf55
.long 0xbf7bbf80, 0xbf55bf6d, 0xbf0ebf35, 0xbe48bec4, 0x3e48a554, 0x3f0e3ec4, 0x3f553f35, 0x3f7b3f6d
.long 0x3e95a554, 0x3f463f0e, 0x3f7f3f6d, 0x3f623f7b, 0x3f753f80, 0x3f223f55, 0x3dc93ec4, 0xbef1be48
.long 0x3f6d3f80, 0x3ec43f35, 0xbec425b0, 0xbf6dbf35, 0xbec425b0, 0xbf6dbf35, 0xbf6dbf80, 0xbec4bf35
.long 0xbef125b0, 0xbf7fbf55, 0xbf22bf6d, 0x3e95be48, 0xbf62bf80, 0xbdc9bf0e, 0x3f463ec4, 0x3f753f7b
.long 0xbf55bf80, 0x3e48bec4, 0x3f7b3f35, 0x3f0e3f6d, 0x3f0ea5f7, 0x3f7b3f6d, 0x3e483f35, 0xbf55bec4
.long 0x3f22a5f7, 0x3f623f7b, 0xbe953ec4, 0xbf7fbf55, 0x3f463f80, 0xbef13e48, 0xbf75bf6d, 0x3dc9bf0e
.long 0x3f803f80, 0x3f803f80, 0x3f803f80, 0x3f803f80, 0xbf803f80, 0xbf803f80, 0xbf803f80, 0xbf803f80
.long 0xbf46bf35, 0xbf62bf55, 0xbf75bf6d, 0xbf7fbf7b, 0xbf22bf35, 0xbef1bf0e, 0xbe95bec4, 0xbdc9be48
.long 0x3e48a554, 0x3f0e3ec4, 0x3f553f35, 0x3f7b3f6d, 0x3f7b3f80, 0x3f553f6d, 0x3f0e3f35, 0x3e483ec4
.long 0x3ef13f35, 0xbdc93e48, 0xbf22bec4, 0xbf75bf55, 0xbf62bf35, 0xbf7fbf7b, 0xbf46bf6d, 0xbe95bf0e
.long 0xbf6dbf80, 0xbec4bf35, 0x3ec4a5f7, 0x3f6d3f35, 0x3ec4a5f7, 0x3f6d3f35, 0x3f6d3f80, 0x3ec43f35
.long 0x3f753f35, 0x3f463f7b, 0xbdc93ec4, 0xbf62bf0e, 0x3e953f35, 0xbf22be48, 0xbf7fbf6d, 0xbef1bf55
.long 0xbf0e261f, 0xbf7bbf6d, 0xbe48bf35, 0x3f553ec4, 0xbf55bf80, 0x3e48bec4, 0x3f7b3f35, 0x3f0e3f6d
.long 0xbdc9bf35, 0x3f753f0e, 0x3ef13f6d, 0xbf46be48, 0x3f7f3f35, 0x3e953f55, 0xbf62bec4, 0xbf22bf7b
.long 0x3f803f80, 0x3f803f80, 0x3f803f80, 0x3f803f80, 0xbf803f80, 0xbf803f80, 0xbf803f80, 0xbf803f80
.long 0xbf7fbf80, 0xbf75bf7b, 0xbf62bf6d, 0xbf46bf55, 0x3dc9a554, 0x3e953e48, 0x3ef13ec4, 0x3f223f0e
.long 0x3f7b3f80, 0x3f553f6d, 0x3f0e3f35, 0x3e483ec4, 0xbe4825b0, 0xbf0ebec4, 0xbf55bf35, 0xbf7bbf6d
.long 0xbf75bf80, 0xbf22bf55, 0xbdc9bec4, 0x3ef13e48, 0x3e95a5f7, 0x3f463f0e, 0x3f7f3f6d, 0x3f623f7b
.long 0x3f6d3f80, 0x3ec43f35, 0xbec4261f, 0xbf6dbf35, 0xbec4261f, 0xbf6dbf35, 0xbf6dbf80, 0xbec4bf35
.long 0xbf62bf80, 0xbdc9bf0e, 0x3f463ec4, 0x3f753f7b, 0x3ef1a731, 0x3f7f3f55, 0x3f223f6d, 0xbe953e48
.long 0x3f553f80, 0xbe483ec4, 0xbf7bbf35, 0xbf0ebf6d, 0xbf0ea68d, 0xbf7bbf6d, 0xbe48bf35, 0x3f553ec4
.long 0xbf46bf80, 0x3ef1be48, 0x3f753f6d, 0xbdc93f0e, 0x3f22a742, 0x3f623f7b, 0xbe953ec4, 0xbf7fbf55
.long 0x3f803f80, 0x3f803f80, 0x3f803f80, 0x3f803f80, 0xbf803f80, 0xbf803f80, 0xbf803f80, 0xbf803f80
.long 0xbf22bf35, 0xbef1bf0e, 0xbe95bec4, 0xbdc9be48, 0x3f463f35, 0x3f623f55, 0x3f753f6d, 0x3f7f3f7b
.long 0xbe4825b0, 0xbf0ebec4, 0xbf55bf35, 0xbf7bbf6d, 0xbf7bbf80, 0xbf55bf6d, 0xbf0ebf35, 0xbe48bec4
.long 0x3f623f35, 0x3f7f3f7b, 0x3f463f6d, 0x3e953f0e, 0x3ef13f35, 0xbdc93e48, 0xbf22bec4, 0xbf75bf55
.long 0xbf6dbf80, 0xbec4bf35, 0x3ec4a731, 0x3f6d3f35, 0x3ec4a731, 0x3f6d3f35, 0x3f6d3f80, 0x3ec43f35
.long 0x3e953f35, 0xbf22be48, 0xbf7fbf6d, 0xbef1bf55, 0xbf75bf35, 0xbf46bf7b, 0x3dc9bec4, 0x3f623f0e
.long 0x3f0ea742, 0x3f7b3f6d, 0x3e483f35, 0xbf55bec4, 0x3f553f80, 0xbe483ec4, 0xbf7bbf35, 0xbf0ebf6d
.long 0xbf7fbf35, 0xbe95bf55, 0x3f623ec4, 0x3f223f7b, 0xbdc9bf35, 0x3f753f0e, 0x3ef13f6d, 0xbf46be48
.long 0x3f803f80, 0x3f803f80, 0x3f803f80, 0x3f803f80, 0xbf803f80, 0xbf803f80, 0xbf803f80, 0xbf803f80
.long 0x3dc9a554, 0x3e953e48, 0x3ef13ec4, 0x3f223f0e, 0x3f7f3f80, 0x3f753f7b, 0x3f623f6d, 0x3f463f55
.long 0xbf7bbf80, 0xbf55bf6d, 0xbf0ebf35, 0xbe48bec4, 0x3e48a5f7, 0x3f0e3ec4, 0x3f553f35, 0x3f7b3f6d
.long 0xbe95261f, 0xbf46bf0e, 0xbf7fbf6d, 0xbf62bf7b, 0xbf75bf80, 0xbf22bf55, 0xbdc9bec4, 0x3ef13e48
.long 0x3f6d3f80, 0x3ec43f35, 0xbec4a68d, 0xbf6dbf35, 0xbec4a68d, 0xbf6dbf35, 0xbf6dbf80, 0xbec4bf35
.long 0x3ef1a742, 0x3f7f3f55, 0x3f223f6d, 0xbe953e48, 0x3f623f80, 0x3dc93f0e, 0xbf46bec4, 0xbf75bf7b
.long 0xbf55bf80, 0x3e48bec4, 0x3f7b3f35, 0x3f0e3f6d, 0x3f0ea754, 0x3f7b3f6d, 0x3e483f35, 0xbf55bec4
.long 0xbf22a60d, 0xbf62bf7b, 0x3e95bec4, 0x3f7f3f55, 0xbf46bf80, 0x3ef1be48, 0x3f753f6d, 0xbdc93f0e
.long 0x3f803f80, 0x3f803f80, 0x3f803f80, 0x3f803f80, 0xbf803f80, 0xbf803f80, 0xbf803f80, 0xbf803f80
.long 0x3f463f35, 0x3f623f55, 0x3f753f6d, 0x3f7f3f7b, 0x3f223f35, 0x3ef13f0e, 0x3e953ec4, 0x3dc93e48
.long 0x3e48a5f7, 0x3f0e3ec4, 0x3f553f35, 0x3f7b3f6d, 0x3f7b3f80, 0x3f553f6d, 0x3f0e3f35, 0x3e483ec4
.long 0xbef1bf35, 0x3dc9be48, 0x3f223ec4, 0x3f753f55, 0x3f623f35, 0x3f7f3f7b, 0x3f463f6d, 0x3e953f0e
.long 0xbf6dbf80, 0xbec4bf35, 0x3ec4a742, 0x3f6d3f35, 0x3ec4a742, 0x3f6d3f35, 0x3f6d3f80, 0x3ec43f35
.long 0xbf75bf35, 0xbf46bf7b, 0x3dc9bec4, 0x3f623f0e, 0xbe95bf35, 0x3f223e48, 0x3f7f3f6d, 0x3ef13f55
.long 0xbf0ea60d, 0xbf7bbf6d, 0xbe48bf35, 0x3f553ec4, 0xbf55bf80, 0x3e48bec4, 0x3f7b3f35, 0x3f0e3f6d
.long 0x3dc93f35, 0xbf75bf0e, 0xbef1bf6d, 0x3f463e48, 0xbf7fbf35, 0xbe95bf55, 0x3f623ec4, 0x3f223f7b
.long 0x3f353f80, 0xbf35248d, 0xbf35bf80, 0x3f35a554, 0xbf35248d, 0xbf35bf80, 0x3f35a554, 0x3f353f80
.long 0x3f223f80, 0xbf62be48, 0xbe95bf6d, 0x3f7f3f0e, 0xbf46248d, 0xbef1bf7b, 0x3f753ec4, 0x3dc93f55
.long 0x3f0e3f80, 0xbf7bbec4, 0x3e48bf35, 0x3f553f6d, 0xbf55248d, 0xbe48bf6d, 0x3f7b3f35, 0xbf0e3ec4
.long 0x3ef13f80, 0xbf7fbf0e, 0x3f22bec4, 0x3e953f7b, 0xbf62248d, 0x3dc9bf55, 0x3f463f6d, 0xbf75be48
.long 0x3ec43f80, 0xbf6dbf35, 0x3f6da554, 0xbec43f35, 0xbf6d248d, 0x3ec4bf35, 0x3ec43f80, 0xbf6dbf35
.long 0x3e953f80, 0xbf46bf55, 0x3f7f3ec4, 0xbf623e48, 0xbf75248d, 0x3f22bf0e, 0xbdc93f6d, 0xbef1bf7b
.long 0x3e483f80, 0xbf0ebf6d, 0x3f553f35, 0xbf7bbec4, 0xbf7b248d, 0x3f55bec4, 0xbf0e3f35, 0x3e48bf6d
.long 0x3dc93f80, 0xbe95bf7b, 0x3ef13f6d, 0xbf22bf55, 0xbf7f248d, 0x3f75be48, 0xbf623ec4, 0x3f46bf0e
.long 0x3f353f80, 0xbf3525b0, 0xbf35bf80, 0x3f35a5f7, 0xbf3525b0, 0xbf35bf80, 0x3f35a5f7, 0x3f353f80
.long 0xbdc93f35, 0xbf75bf55, 0x3ef1bec4, 0x3f463f7b, 0xbf7fbf35, 0x3e95bf0e, 0x3f623f6d, 0xbf223e48
.long 0xbf5525b0, 0xbe48bf6d, 0x3f7b3f35, 0xbf0e3ec4, 0xbf0ebf80, 0x3f7b3ec4, 0xbe483f35, 0xbf55bf6d
.long 0xbf75bf35, 0x3f46be48, 0x3dc93f6d, 0xbf62bf55, 0x3e95bf35, 0x3f223f7b, 0xbf7fbec4, 0x3ef1bf0e
.long 0xbec4bf80, 0x3f6d3f35, 0xbf6d261f, 0x3ec4bf35, 0x3f6da5f7, 0xbec43f35, 0xbec4bf80, 0x3f6d3f35
.long 0x3ef1bf35, 0x3dc93f7b, 0xbf22bf6d, 0x3f753f0e, 0x3f623f35, 0xbf7fbe48, 0x3f46bec4, 0xbe953f55
.long 0x3f7ba5f7, 0xbf553ec4, 0x3f0ebf35, 0xbe483f6d, 0x3e483f80, 0xbf0ebf6d, 0x3f553f35, 0xbf7bbec4
.long 0x3f463f35, 0xbf62bf0e, 0x3f753ec4, 0xbf7fbe48, 0xbf223f35, 0x3ef1bf55, 0xbe953f6d, 0x3dc9bf7b
.long 0x3f353f80, 0xbf35261f, 0xbf35bf80, 0x3f35a731, 0xbf35261f, 0xbf35bf80, 0x3f35a731, 0x3f353f80
.long 0xbf46261f, 0xbef1bf7b, 0x3f753ec4, 0x3dc93f55, 0xbf22bf80, 0x3f623e48, 0x3e953f6d, 0xbf7fbf0e
.long 0xbf0ebf80, 0x3f7b3ec4, 0xbe483f35, 0xbf55bf6d, 0x3f55a731, 0x3e483f6d, 0xbf7bbf35, 0x3f0ebec4
.long 0x3f62a731, 0xbdc93f55, 0xbf46bf6d, 0x3f753e48, 0x3ef13f80, 0xbf7fbf0e, 0x3f22bec4, 0x3e953f7b
.long 0x3ec43f80, 0xbf6dbf35, 0x3f6da742, 0xbec43f35, 0xbf6da68d, 0x3ec4bf35, 0x3ec43f80, 0xbf6dbf35
.long 0xbf75a68d, 0x3f22bf0e, 0xbdc93f6d, 0xbef1bf7b, 0xbe95bf80, 0x3f463f55, 0xbf7fbec4, 0x3f62be48
.long 0xbe48bf80, 0x3f0e3f6d, 0xbf55bf35, 0x3f7b3ec4, 0x3f7ba742, 0xbf553ec4, 0x3f0ebf35, 0xbe483f6d
.long 0x3f7fa742, 0xbf753e48, 0x3f62bec4, 0xbf463f0e, 0x3dc93f80, 0xbe95bf7b, 0x3ef13f6d, 0xbf22bf55
.long 0x3f353f80, 0xbf35a68d, 0xbf35bf80, 0x3f35a742, 0xbf35a68d, 0xbf35bf80, 0x3f35a742, 0x3f353f80
.long 0xbf7fbf35, 0x3e95bf0e, 0x3f623f6d, 0xbf223e48, 0x3dc9bf35, 0x3f753f55, 0xbef13ec4, 0xbf46bf7b
.long 0x3f55a742, 0x3e483f6d, 0xbf7bbf35, 0x3f0ebec4, 0x3f0e3f80, 0xbf7bbec4, 0x3e48bf35, 0x3f553f6d
.long 0xbe953f35, 0xbf22bf7b, 0x3f7f3ec4, 0xbef13f0e, 0xbf75bf35, 0x3f46be48, 0x3dc93f6d, 0xbf62bf55
.long 0xbec4bf80, 0x3f6d3f35, 0xbf6da60d, 0x3ec4bf35, 0x3f6da754, 0xbec43f35, 0xbec4bf80, 0x3f6d3f35
.long 0x3f623f35, 0xbf7fbe48, 0x3f46bec4, 0xbe953f55, 0xbef13f35, 0xbdc9bf7b, 0x3f223f6d, 0xbf75bf0e
.long 0xbf7ba60d, 0x3f55bec4, 0xbf0e3f35, 0x3e48bf6d, 0xbe48bf80, 0x3f0e3f6d, 0xbf55bf35, 0x3f7b3ec4
.long 0x3f22bf35, 0xbef13f55, 0x3e95bf6d, 0xbdc93f7b, 0x3f463f35, 0xbf62bf0e, 0x3f753ec4, 0xbf7fbe48
.long 0x3f353f80, 0xbf35a654, 0xbf35bf80, 0x3f35a754, 0xbf35a654, 0xbf35bf80, 0x3f35a754, 0x3f353f80
.long 0xbf22bf80, 0x3f623e48, 0x3e953f6d, 0xbf7fbf0e, 0x3f46a754, 0x3ef13f7b, 0xbf75bec4, 0xbdc9bf55
.long 0x3f0e3f80, 0xbf7bbec4, 0x3e48bf35, 0x3f553f6d, 0xbf55a60d, 0xbe48bf6d, 0x3f7b3f35, 0xbf0e3ec4
.long 0xbef1bf80, 0x3f7f3f0e, 0xbf223ec4, 0xbe95bf7b, 0x3f62a765, 0xbdc93f55, 0xbf46bf6d, 0x3f753e48
.long 0x3ec43f80, 0xbf6dbf35, 0x3f6da777, 0xbec43f35, 0xbf6da58e, 0x3ec4bf35, 0x3ec43f80, 0xbf6dbf35
.long 0xbe95bf80, 0x3f463f55, 0xbf7fbec4, 0x3f62be48, 0x3f75a777, 0xbf223f0e, 0x3dc9bf6d, 0x3ef13f7b
.long 0x3e483f80, 0xbf0ebf6d, 0x3f553f35, 0xbf7bbec4, 0xbf7ba137, 0x3f55bec4, 0xbf0e3f35, 0x3e48bf6d
.long 0xbdc9bf80, 0x3e953f7b, 0xbef1bf6d, 0x3f223f55, 0x3f7fa784, 0xbf753e48, 0x3f62bec4, 0xbf463f0e
.long 0x3f353f80, 0xbf35a60d, 0xbf35bf80, 0x3f35a765, 0xbf35a60d, 0xbf35bf80, 0x3f35a765, 0x3f353f80
.long 0x3dc9bf35, 0x3f753f55, 0xbef13ec4, 0xbf46bf7b, 0x3f7f3f35, 0xbe953f0e, 0xbf62bf6d, 0x3f22be48
.long 0xbf55a58e, 0xbe48bf6d, 0x3f7b3f35, 0xbf0e3ec4, 0xbf0ebf80, 0x3f7b3ec4, 0xbe483f35, 0xbf55bf6d
.long 0x3f753f35, 0xbf463e48, 0xbdc9bf6d, 0x3f623f55, 0xbe953f35, 0xbf22bf7b, 0x3f7f3ec4, 0xbef13f0e
.long 0xbec4bf80, 0x3f6d3f35, 0xbf6d258d, 0x3ec4bf35, 0x3f6da784, 0xbec43f35, 0xbec4bf80, 0x3f6d3f35
.long 0xbef13f35, 0xbdc9bf7b, 0x3f223f6d, 0xbf75bf0e, 0xbf62bf35, 0x3f7f3e48, 0xbf463ec4, 0x3e95bf55
.long 0x3f7ba78d, 0xbf553ec4, 0x3f0ebf35, 0xbe483f6d, 0x3e483f80, 0xbf0ebf6d, 0x3f553f35, 0xbf7bbec4
.long 0xbf46bf35, 0x3f623f0e, 0xbf75bec4, 0x3f7f3e48, 0x3f22bf35, 0xbef13f55, 0x3e95bf6d, 0xbdc93f7b
.long 0x3f353f80, 0xbf35a58e, 0xbf35bf80, 0x3f35a777, 0xbf35a58e, 0xbf35bf80, 0x3f35a777, 0x3f353f80
.long 0x3f46a777, 0x3ef13f7b, 0xbf75bec4, 0xbdc9bf55, 0x3f223f80, 0xbf62be48, 0xbe95bf6d, 0x3f7f3f0e
.long 0xbf0ebf80, 0x3f7b3ec4, 0xbe483f35, 0xbf55bf6d, 0x3f55a784, 0x3e483f6d, 0xbf7bbf35, 0x3f0ebec4
.long 0xbf62258d, 0x3dc9bf55, 0x3f463f6d, 0xbf75be48, 0xbef1bf80, 0x3f7f3f0e, 0xbf223ec4, 0xbe95bf7b
.long 0x3ec43f80, 0xbf6dbf35, 0x3f6da796, 0xbec43f35, 0xbf6d260d, 0x3ec4bf35, 0x3ec43f80, 0xbf6dbf35
.long 0x3f75a796, 0xbf223f0e, 0x3dc9bf6d, 0x3ef13f7b, 0x3e953f80, 0xbf46bf55, 0x3f7f3ec4, 0xbf623e48
.long 0xbe48bf80, 0x3f0e3f6d, 0xbf55bf35, 0x3f7b3ec4, 0x3f7ba79f, 0xbf553ec4, 0x3f0ebf35, 0xbe483f6d
.long 0xbf7f268d, 0x3f75be48, 0xbf623ec4, 0x3f46bf0e, 0xbdc9bf80, 0x3e953f7b, 0xbef1bf6d, 0x3f223f55
.long 0x3f353f80, 0xbf35a137, 0xbf35bf80, 0x3f35a784, 0xbf35a137, 0xbf35bf80, 0x3f35a784, 0x3f353f80
.long 0x3f7f3f35, 0xbe953f0e, 0xbf62bf6d, 0x3f22be48, 0xbdc93f35, 0xbf75bf55, 0x3ef1bec4, 0x3f463f7b
.long 0x3f55a78d, 0x3e483f6d, 0xbf7bbf35, 0x3f0ebec4, 0x3f0e3f80, 0xbf7bbec4, 0x3e48bf35, 0x3f553f6d
.long 0x3e95bf35, 0x3f223f7b, 0xbf7fbec4, 0x3ef1bf0e, 0x3f753f35, 0xbf463e48, 0xbdc9bf6d, 0x3f623f55
.long 0xbec4bf80, 0x3f6d3f35, 0xbf6d268d, 0x3ec4bf35, 0x3f6da79f, 0xbec43f35, 0xbec4bf80, 0x3f6d3f35
.long 0xbf62bf35, 0x3f7f3e48, 0xbf463ec4, 0x3e95bf55, 0x3ef1bf35, 0x3dc93f7b, 0xbf22bf6d, 0x3f753f0e
.long 0xbf7b2816, 0x3f55bec4, 0xbf0e3f35, 0x3e48bf6d, 0xbe48bf80, 0x3f0e3f6d, 0xbf55bf35, 0x3f7b3ec4
.long 0xbf223f35, 0x3ef1bf55, 0xbe953f6d, 0x3dc9bf7b, 0xbf46bf35, 0x3f623f0e, 0xbf75bec4, 0x3f7f3e48
.long 0x248d3f80, 0xa554bf80, 0x25b03f80, 0xa5f7bf80, 0xbf80248d, 0x3f80a554, 0xbf8025b0, 0x3f80a5f7
.long 0xbdc93f80, 0x3e95bf7b, 0xbef13f6d, 0x3f22bf55, 0xbf7f248d, 0x3f753e48, 0xbf62bec4, 0x3f463f0e
.long 0xbe483f80, 0x3f0ebf6d, 0xbf553f35, 0x3f7bbec4, 0xbf7b248d, 0x3f553ec4, 0xbf0ebf35, 0x3e483f6d
.long 0xbe953f80, 0x3f46bf55, 0xbf7f3ec4, 0x3f623e48, 0xbf75248d, 0x3f223f0e, 0xbdc9bf6d, 0xbef13f7b
.long 0xbec43f80, 0x3f6dbf35, 0xbf6d25b0, 0x3ec43f35, 0xbf6d248d, 0x3ec43f35, 0x3ec4bf80, 0xbf6d3f35
.long 0xbef13f80, 0x3f7fbf0e, 0xbf22bec4, 0xbe953f7b, 0xbf62248d, 0x3dc93f55, 0x3f46bf6d, 0xbf753e48
.long 0xbf0e3f80, 0x3f7bbec4, 0xbe48bf35, 0xbf553f6d, 0xbf55248d, 0xbe483f6d, 0x3f7bbf35, 0xbf0ebec4
.long 0xbf223f80, 0x3f62be48, 0x3e95bf6d, 0xbf7f3f0e, 0xbf46248d, 0xbef13f7b, 0x3f75bec4, 0x3dc9bf55
.long 0x261f3f80, 0xa731bf80, 0xa68d3f80, 0xa742bf80, 0xbf80261f, 0x3f80a731, 0xbf80a68d, 0x3f80a742
.long 0xbf463f35, 0x3f62bf0e, 0xbf753ec4, 0x3f7fbe48, 0xbf22bf35, 0x3ef13f55, 0xbe95bf6d, 0x3dc93f7b
.long 0xbf7b261f, 0x3f553ec4, 0xbf0ebf35, 0x3e483f6d, 0x3e48bf80, 0xbf0e3f6d, 0x3f55bf35, 0xbf7b3ec4
.long 0xbef1bf35, 0xbdc93f7b, 0x3f22bf6d, 0xbf753f0e, 0x3f62bf35, 0xbf7f3e48, 0x3f463ec4, 0xbe95bf55
.long 0x3ec4bf80, 0xbf6d3f35, 0x3f6da742, 0xbec4bf35, 0x3f6da731, 0xbec4bf35, 0xbec43f80, 0x3f6dbf35
.long 0x3f75bf35, 0xbf46be48, 0xbdc93f6d, 0x3f62bf55, 0x3e953f35, 0x3f22bf7b, 0xbf7f3ec4, 0x3ef13f0e
.long 0x3f55a731, 0x3e48bf6d, 0xbf7b3f35, 0x3f0e3ec4, 0xbf0e3f80, 0x3f7bbec4, 0xbe48bf35, 0xbf553f6d
.long 0x3dc93f35, 0x3f75bf55, 0xbef1bec4, 0xbf463f7b, 0xbf7f3f35, 0x3e953f0e, 0x3f62bf6d, 0xbf22be48
.long 0xa6543f80, 0xa754bf80, 0xa60d3f80, 0xa765bf80, 0xbf80a654, 0x3f80a754, 0xbf80a60d, 0x3f80a765
.long 0xbf7fa654, 0x3f753e48, 0xbf62bec4, 0x3f463f0e, 0x3dc9bf80, 0xbe953f7b, 0x3ef1bf6d, 0xbf223f55
.long 0x3e48bf80, 0xbf0e3f6d, 0x3f55bf35, 0xbf7b3ec4, 0x3f7ba754, 0xbf55bec4, 0x3f0e3f35, 0xbe48bf6d
.long 0x3f75a754, 0xbf22bf0e, 0x3dc93f6d, 0x3ef1bf7b, 0xbe953f80, 0x3f46bf55, 0xbf7f3ec4, 0x3f623e48
.long 0xbec43f80, 0x3f6dbf35, 0xbf6da58e, 0x3ec43f35, 0xbf6da60d, 0x3ec43f35, 0x3ec4bf80, 0xbf6d3f35
.long 0xbf62a60d, 0x3dc93f55, 0x3f46bf6d, 0xbf753e48, 0x3ef1bf80, 0xbf7f3f0e, 0x3f223ec4, 0x3e95bf7b
.long 0x3f0ebf80, 0xbf7b3ec4, 0x3e483f35, 0x3f55bf6d, 0x3f55a765, 0x3e48bf6d, 0xbf7b3f35, 0x3f0e3ec4
.long 0x3f46a765, 0x3ef1bf7b, 0xbf753ec4, 0xbdc93f55, 0xbf223f80, 0x3f62be48, 0x3e95bf6d, 0xbf7f3f0e
.long 0xa58e3f80, 0xa777bf80, 0xa1373f80, 0xa784bf80, 0xbf80a58e, 0x3f80a777, 0xbf80a137, 0x3f80a784
.long 0xbf22bf35, 0x3ef13f55, 0xbe95bf6d, 0x3dc93f7b, 0x3f46bf35, 0xbf623f0e, 0x3f75bec4, 0xbf7f3e48
.long 0x3f7ba777, 0xbf55bec4, 0x3f0e3f35, 0xbe48bf6d, 0xbe483f80, 0x3f0ebf6d, 0xbf553f35, 0x3f7bbec4
.long 0xbf623f35, 0x3f7fbe48, 0xbf46bec4, 0x3e953f55, 0xbef1bf35, 0xbdc93f7b, 0x3f22bf6d, 0xbf753f0e
.long 0x3ec4bf80, 0xbf6d3f35, 0x3f6da78d, 0xbec4bf35, 0x3f6da784, 0xbec4bf35, 0xbec43f80, 0x3f6dbf35
.long 0x3e953f35, 0x3f22bf7b, 0xbf7f3ec4, 0x3ef13f0e, 0xbf753f35, 0x3f463e48, 0x3dc9bf6d, 0xbf623f55
.long 0xbf55258d, 0xbe483f6d, 0x3f7bbf35, 0xbf0ebec4, 0x3f0ebf80, 0xbf7b3ec4, 0x3e483f35, 0x3f55bf6d
.long 0x3f7fbf35, 0xbe95bf0e, 0xbf623f6d, 0x3f223e48, 0x3dc93f35, 0x3f75bf55, 0xbef1bec4, 0xbf463f7b
.long 0x258d3f80, 0xa78dbf80, 0x260d3f80, 0xa796bf80, 0xbf80258d, 0x3f80a78d, 0xbf80260d, 0x3f80a796
.long 0x3dc9bf80, 0xbe953f7b, 0x3ef1bf6d, 0xbf223f55, 0x3f7fa78d, 0xbf75be48, 0x3f623ec4, 0xbf46bf0e
.long 0xbe483f80, 0x3f0ebf6d, 0xbf553f35, 0x3f7bbec4, 0xbf7b260d, 0x3f553ec4, 0xbf0ebf35, 0x3e483f6d
.long 0x3e95bf80, 0xbf463f55, 0x3f7fbec4, 0xbf62be48, 0x3f75a796, 0xbf22bf0e, 0x3dc93f6d, 0x3ef1bf7b
.long 0xbec43f80, 0x3f6dbf35, 0xbf6d268d, 0x3ec43f35, 0xbf6d280d, 0x3ec43f35, 0x3ec4bf80, 0xbf6d3f35
.long 0x3ef1bf80, 0xbf7f3f0e, 0x3f223ec4, 0x3e95bf7b, 0x3f62a79f, 0xbdc9bf55, 0xbf463f6d, 0x3f75be48
.long 0xbf0e3f80, 0x3f7bbec4, 0xbe48bf35, 0xbf553f6d, 0xbf55268d, 0xbe483f6d, 0x3f7bbf35, 0xbf0ebec4
.long 0x3f22bf80, 0xbf623e48, 0xbe953f6d, 0x3f7fbf0e, 0x3f462731, 0x3ef1bf7b, 0xbf753ec4, 0xbdc93f55
.long 0x280d3f80, 0xa79fbf80, 0x268d3f80, 0x2731bf80, 0xbf80280d, 0x3f80a79f, 0xbf80268d, 0x3f802731
.long 0x3f46bf35, 0xbf623f0e, 0x3f75bec4, 0xbf7f3e48, 0x3f223f35, 0xbef1bf55, 0x3e953f6d, 0xbdc9bf7b
.long 0xbf7b268d, 0x3f553ec4, 0xbf0ebf35, 0x3e483f6d, 0x3e48bf80, 0xbf0e3f6d, 0x3f55bf35, 0xbf7b3ec4
.long 0x3ef13f35, 0x3dc9bf7b, 0xbf223f6d, 0x3f75bf0e, 0xbf623f35, 0x3f7fbe48, 0xbf46bec4, 0x3e953f55
.long 0x3ec4bf80, 0xbf6d3f35, 0x3f6d270d, 0xbec4bf35, 0x3f6da7b1, 0xbec4bf35, 0xbec43f80, 0x3f6dbf35
.long 0xbf753f35, 0x3f463e48, 0x3dc9bf6d, 0xbf623f55, 0xbe95bf35, 0xbf223f7b, 0x3f7fbec4, 0xbef1bf0e
.long 0x3f55270d, 0x3e48bf6d, 0xbf7b3f35, 0x3f0e3ec4, 0xbf0e3f80, 0x3f7bbec4, 0xbe48bf35, 0xbf553f6d
.long 0xbdc9bf35, 0xbf753f55, 0x3ef13ec4, 0x3f46bf7b, 0x3f7fbf35, 0xbe95bf0e, 0xbf623f6d, 0x3f223e48
.long 0x28163f80, 0xa7b1bf80, 0x26d43f80, 0x270dbf80, 0xbf802816, 0x3f80a7b1, 0xbf8026d4, 0x3f80270d
.long 0x3f7fa7b1, 0xbf75be48, 0x3f623ec4, 0xbf46bf0e, 0xbdc93f80, 0x3e95bf7b, 0xbef13f6d, 0x3f22bf55
.long 0x3e48bf80, 0xbf0e3f6d, 0x3f55bf35, 0xbf7b3ec4, 0x3f7b270d, 0xbf55bec4, 0x3f0e3f35, 0xbe48bf6d
.long 0xbf75281f, 0x3f223f0e, 0xbdc9bf6d, 0xbef13f7b, 0x3e95bf80, 0xbf463f55, 0x3f7fbec4, 0xbf62be48
.long 0xbec43f80, 0x3f6dbf35, 0xbf6d2828, 0x3ec43f35, 0xbf6d270d, 0x3ec43f35, 0x3ec4bf80, 0xbf6d3f35
.long 0x3f6226d4, 0xbdc9bf55, 0xbf463f6d, 0x3f75be48, 0xbef13f80, 0x3f7fbf0e, 0xbf22bec4, 0xbe953f7b
.long 0x3f0ebf80, 0xbf7b3ec4, 0x3e483f35, 0x3f55bf6d, 0x3f55a7d4, 0x3e48bf6d, 0xbf7b3f35, 0x3f0e3ec4
.long 0xbf462730, 0xbef13f7b, 0x3f75bec4, 0x3dc9bf55, 0x3f22bf80, 0xbf623e48, 0xbe953f6d, 0x3f7fbf0e
.long 0x281f3f80, 0xa7c2bf80, 0x270d3f80, 0x26d4bf80, 0xbf80281f, 0x3f80a7c2, 0xbf80270d, 0x3f8026d4
.long 0x3f223f35, 0xbef1bf55, 0x3e953f6d, 0xbdc9bf7b, 0xbf463f35, 0x3f62bf0e, 0xbf753ec4, 0x3f7fbe48
.long 0x3f7b26d4, 0xbf55bec4, 0x3f0e3f35, 0xbe48bf6d, 0xbe483f80, 0x3f0ebf6d, 0xbf553f35, 0x3f7bbec4
.long 0x3f62bf35, 0xbf7f3e48, 0x3f463ec4, 0xbe95bf55, 0x3ef13f35, 0x3dc9bf7b, 0xbf223f6d, 0x3f75bf0e
.long 0x3ec4bf80, 0xbf6d3f35, 0x3f6da7e5, 0xbec4bf35, 0x3f6d268d, 0xbec4bf35, 0xbec43f80, 0x3f6dbf35
.long 0xbe95bf35, 0xbf223f7b, 0x3f7fbec4, 0xbef1bf0e, 0x3f75bf35, 0xbf46be48, 0xbdc93f6d, 0x3f62bf55
.long 0xbf552754, 0xbe483f6d, 0x3f7bbf35, 0xbf0ebec4, 0x3f0ebf80, 0xbf7b3ec4, 0x3e483f35, 0x3f55bf6d
.long 0xbf7f3f35, 0x3e953f0e, 0x3f62bf6d, 0xbf22be48, 0xbdc9bf35, 0xbf753f55, 0x3ef13ec4, 0x3f46bf7b
.long 0xbf353f80, 0x3f35a554, 0x3f35bf80, 0xbf35261f, 0xbf35248d, 0xbf353f80, 0x3f35a5f7, 0x3f35bf80
.long 0xbf463f80, 0x3ef13e48, 0x3f75bf6d, 0xbdc9bf0e, 0xbf22248d, 0xbf623f7b, 0x3e953ec4, 0x3f7fbf55
.long 0xbf553f80, 0x3e483ec4, 0x3f7bbf35, 0x3f0ebf6d, 0xbf0e248d, 0xbf7b3f6d, 0xbe483f35, 0x3f55bec4
.long 0xbf623f80, 0xbdc93f0e, 0x3f46bec4, 0x3f75bf7b, 0xbef1248d, 0xbf7f3f55, 0xbf223f6d, 0x3e953e48
.long 0xbf6d3f80, 0xbec43f35, 0x3ec4a5f7, 0x3f6dbf35, 0xbec4248d, 0xbf6d3f35, 0xbf6d3f80, 0xbec43f35
.long 0xbf753f80, 0xbf223f55, 0xbdc93ec4, 0x3ef1be48, 0xbe95248d, 0xbf463f0e, 0xbf7f3f6d, 0xbf623f7b
.long 0xbf7b3f80, 0xbf553f6d, 0xbf0e3f35, 0xbe483ec4, 0xbe48248d, 0xbf0e3ec4, 0xbf553f35, 0xbf7b3f6d
.long 0xbf7f3f80, 0xbf753f7b, 0xbf623f6d, 0xbf463f55, 0xbdc9248d, 0xbe953e48, 0xbef13ec4, 0xbf223f0e
.long 0xbf353f80, 0x3f35a742, 0x3f35bf80, 0xbf35a60d, 0xbf35a68d, 0xbf353f80, 0x3f35a754, 0x3f35bf80
.long 0xbf7f3f35, 0xbe953f55, 0x3f62bec4, 0x3f22bf7b, 0x3dc9bf35, 0xbf753f0e, 0xbef13f6d, 0x3f46be48
.long 0xbf0ea68d, 0xbf7b3f6d, 0xbe483f35, 0x3f55bec4, 0x3f55bf80, 0xbe48bec4, 0xbf7b3f35, 0xbf0e3f6d
.long 0x3e95bf35, 0xbf223e48, 0xbf7f3f6d, 0xbef13f55, 0x3f75bf35, 0x3f46bf7b, 0xbdc9bec4, 0xbf623f0e
.long 0x3f6dbf80, 0x3ec4bf35, 0xbec4a60d, 0xbf6d3f35, 0x3ec4a742, 0x3f6dbf35, 0x3f6dbf80, 0x3ec4bf35
.long 0x3f62bf35, 0x3f7fbf7b, 0x3f46bf6d, 0x3e95bf0e, 0xbef13f35, 0x3dc93e48, 0x3f22bec4, 0x3f75bf55
.long 0x3e48a742, 0x3f0ebec4, 0x3f55bf35, 0x3f7bbf6d, 0xbf7b3f80, 0xbf553f6d, 0xbf0e3f35, 0xbe483ec4
.long 0xbf223f35, 0xbef13f0e, 0xbe953ec4, 0xbdc93e48, 0xbf463f35, 0xbf623f55, 0xbf753f6d, 0xbf7f3f7b
.long 0xbf353f80, 0x3f35a777, 0x3f35bf80, 0xbf35258d, 0xbf35a58e, 0xbf353f80, 0x3f35a784, 0x3f35bf80
.long 0xbf22a58e, 0xbf623f7b, 0x3e953ec4, 0x3f7fbf55, 0x3f46bf80, 0xbef1be48, 0xbf753f6d, 0x3dc93f0e
.long 0x3f55bf80, 0xbe48bec4, 0xbf7b3f35, 0xbf0e3f6d, 0x3f0ea777, 0x3f7bbf6d, 0x3e48bf35, 0xbf553ec4
.long 0x3ef1a777, 0x3f7fbf55, 0x3f22bf6d, 0xbe95be48, 0xbf623f80, 0xbdc93f0e, 0x3f46bec4, 0x3f75bf7b
.long 0xbf6d3f80, 0xbec43f35, 0x3ec4a78d, 0x3f6dbf35, 0xbec4a137, 0xbf6d3f35, 0xbf6d3f80, 0xbec43f35
.long 0xbe95a137, 0xbf463f0e, 0xbf7f3f6d, 0xbf623f7b, 0x3f75bf80, 0x3f22bf55, 0x3dc9bec4, 0xbef13e48
.long 0x3f7bbf80, 0x3f55bf6d, 0x3f0ebf35, 0x3e48bec4, 0x3e48a784, 0x3f0ebec4, 0x3f55bf35, 0x3f7bbf6d
.long 0x3dc9a784, 0x3e95be48, 0x3ef1bec4, 0x3f22bf0e, 0xbf7f3f80, 0xbf753f7b, 0xbf623f6d, 0xbf463f55
.long 0xbf353f80, 0x3f35a796, 0x3f35bf80, 0xbf35268d, 0xbf35260d, 0xbf353f80, 0x3f35a79f, 0x3f35bf80
.long 0x3dc9bf35, 0xbf753f0e, 0xbef13f6d, 0x3f46be48, 0x3f7fbf35, 0x3e95bf55, 0xbf623ec4, 0xbf223f7b
.long 0x3f0ea796, 0x3f7bbf6d, 0x3e48bf35, 0xbf553ec4, 0xbf553f80, 0x3e483ec4, 0x3f7bbf35, 0x3f0ebf6d
.long 0xbf753f35, 0xbf463f7b, 0x3dc93ec4, 0x3f62bf0e, 0x3e95bf35, 0xbf223e48, 0xbf7f3f6d, 0xbef13f55
.long 0x3f6dbf80, 0x3ec4bf35, 0xbec42816, 0xbf6d3f35, 0x3ec4a79f, 0x3f6dbf35, 0x3f6dbf80, 0x3ec4bf35
.long 0xbef13f35, 0x3dc93e48, 0x3f22bec4, 0x3f75bf55, 0xbf623f35, 0xbf7f3f7b, 0xbf463f6d, 0xbe953f0e
.long 0xbe48268d, 0xbf0e3ec4, 0xbf553f35, 0xbf7b3f6d, 0x3f7bbf80, 0x3f55bf6d, 0x3f0ebf35, 0x3e48bec4
.long 0x3f46bf35, 0x3f62bf55, 0x3f75bf6d, 0x3f7fbf7b, 0xbf223f35, 0xbef13f0e, 0xbe953ec4, 0xbdc93e48
.long 0xbf353f80, 0x3f35a7b1, 0x3f35bf80, 0xbf35281f, 0xbf352816, 0xbf353f80, 0x3f35270d, 0x3f35bf80
.long 0x3f46bf80, 0xbef1be48, 0xbf753f6d, 0x3dc93f0e, 0x3f22a7b1, 0x3f62bf7b, 0xbe95bec4, 0xbf7f3f55
.long 0xbf553f80, 0x3e483ec4, 0x3f7bbf35, 0x3f0ebf6d, 0xbf0e26d4, 0xbf7b3f6d, 0xbe483f35, 0x3f55bec4
.long 0x3f62bf80, 0x3dc9bf0e, 0xbf463ec4, 0xbf753f7b, 0x3ef1270d, 0x3f7fbf55, 0x3f22bf6d, 0xbe95be48
.long 0xbf6d3f80, 0xbec43f35, 0x3ec426d4, 0x3f6dbf35, 0xbec4281f, 0xbf6d3f35, 0xbf6d3f80, 0xbec43f35
.long 0x3f75bf80, 0x3f22bf55, 0x3dc9bec4, 0xbef13e48, 0x3e95a7c2, 0x3f46bf0e, 0x3f7fbf6d, 0x3f62bf7b
.long 0xbf7b3f80, 0xbf553f6d, 0xbf0e3f35, 0xbe483ec4, 0xbe48270d, 0xbf0e3ec4, 0xbf553f35, 0xbf7b3f6d
.long 0x3f7fbf80, 0x3f75bf7b, 0x3f62bf6d, 0x3f46bf55, 0x3dc926d4, 0x3e95be48, 0x3ef1bec4, 0x3f22bf0e
.long 0xbf353f80, 0x3f3526d4, 0x3f35bf80, 0xbf352730, 0xbf35270d, 0xbf353f80, 0x3f35a7d4, 0x3f35bf80
.long 0x3f7fbf35, 0x3e95bf55, 0xbf623ec4, 0xbf223f7b, 0xbdc93f35, 0x3f75bf0e, 0x3ef1bf6d, 0xbf463e48
.long 0xbf0e2828, 0xbf7b3f6d, 0xbe483f35, 0x3f55bec4, 0x3f55bf80, 0xbe48bec4, 0xbf7b3f35, 0xbf0e3f6d
.long 0xbe953f35, 0x3f22be48, 0x3f7fbf6d, 0x3ef1bf55, 0xbf753f35, 0xbf463f7b, 0x3dc93ec4, 0x3f62bf0e
.long 0x3f6dbf80, 0x3ec4bf35, 0xbec42754, 0xbf6d3f35, 0x3ec4268d, 0x3f6dbf35, 0x3f6dbf80, 0x3ec4bf35
.long 0xbf623f35, 0xbf7f3f7b, 0xbf463f6d, 0xbe953f0e, 0x3ef1bf35, 0xbdc9be48, 0xbf223ec4, 0xbf753f55
.long 0x3e48a7e5, 0x3f0ebec4, 0x3f55bf35, 0x3f7bbf6d, 0xbf7b3f80, 0xbf553f6d, 0xbf0e3f35, 0xbe483ec4
.long 0x3f22bf35, 0x3ef1bf0e, 0x3e95bec4, 0x3dc9be48, 0x3f46bf35, 0x3f62bf55, 0x3f75bf6d, 0x3f7fbf7b
.long 0xbf353f80, 0x3f35a7e5, 0x3f35bf80, 0xbf352839, 0xbf352831, 0xbf353f80, 0x3f35260e, 0x3f35bf80
.long 0x3f22a7e5, 0x3f62bf7b, 0xbe95bec4, 0xbf7f3f55, 0xbf463f80, 0x3ef13e48, 0x3f75bf6d, 0xbdc9bf0e
.long 0x3f55bf80, 0xbe48bec4, 0xbf7b3f35, 0xbf0e3f6d, 0x3f0e260e, 0x3f7bbf6d, 0x3e48bf35, 0xbf553ec4
.long 0xbef12839, 0xbf7f3f55, 0xbf223f6d, 0x3e953e48, 0x3f62bf80, 0x3dc9bf0e, 0xbf463ec4, 0xbf753f7b
.long 0xbf6d3f80, 0xbec43f35, 0x3ec4a804, 0x3f6dbf35, 0xbec42777, 0xbf6d3f35, 0xbf6d3f80, 0xbec43f35
.long 0x3e95a880, 0x3f46bf0e, 0x3f7fbf6d, 0x3f62bf7b, 0xbf753f80, 0xbf223f55, 0xbdc93ec4, 0x3ef1be48
.long 0x3f7bbf80, 0x3f55bf6d, 0x3f0ebf35, 0x3e48bec4, 0x3e48a804, 0x3f0ebec4, 0x3f55bf35, 0x3f7bbf6d
.long 0xbdc928a3, 0xbe953e48, 0xbef13ec4, 0xbf223f0e, 0x3f7fbf80, 0x3f75bf7b, 0x3f62bf6d, 0x3f46bf55
.long 0xbf353f80, 0x3f35a880, 0x3f35bf80, 0xbf3528a3, 0xbf352777, 0xbf353f80, 0x3f35a804, 0x3f35bf80
.long 0xbdc93f35, 0x3f75bf0e, 0x3ef1bf6d, 0xbf463e48, 0xbf7f3f35, 0xbe953f55, 0x3f62bec4, 0x3f22bf7b
.long 0x3f0ea804, 0x3f7bbf6d, 0x3e48bf35, 0xbf553ec4, 0xbf553f80, 0x3e483ec4, 0x3f7bbf35, 0x3f0ebf6d
.long 0x3f75bf35, 0x3f46bf7b, 0xbdc9bec4, 0xbf623f0e, 0xbe953f35, 0x3f22be48, 0x3f7fbf6d, 0x3ef1bf55
.long 0x3f6dbf80, 0x3ec4bf35, 0xbec4a731, 0xbf6d3f35, 0x3ec427e6, 0x3f6dbf35, 0x3f6dbf80, 0x3ec4bf35
.long 0x3ef1bf35, 0xbdc9be48, 0xbf223ec4, 0xbf753f55, 0x3f62bf35, 0x3f7fbf7b, 0x3f46bf6d, 0x3e95bf0e
.long 0xbe48a731, 0xbf0e3ec4, 0xbf553f35, 0xbf7b3f6d, 0x3f7bbf80, 0x3f55bf6d, 0x3f0ebf35, 0x3e48bec4
.long 0xbf463f35, 0xbf623f55, 0xbf753f6d, 0xbf7f3f7b, 0x3f22bf35, 0x3ef1bf0e, 0x3e95bec4, 0x3dc9be48
L_codeend:
.section .rodata,"a"
.p2align 6
.amdhsa_kernel adaLN_cond__spectral_fnet__swiglu_ffn__prompt_kernel
  .amdhsa_next_free_vgpr 512
  .amdhsa_next_free_sgpr 102
  .amdhsa_accum_offset 256
  .amdhsa_group_segment_fixed_size 0
  .amdhsa_kernarg_size 112
  .amdhsa_user_sgpr_count 2
  .amdhsa_user_sgpr_kernarg_segment_ptr 1
  .amdhsa_system_sgpr_workgroup_id_x 1
.end_amdhsa_kernel
```
